```python
import torch

def _softmax(x, axis=-1):
    return torch.softmax(x, dim=axis)
def _gelu(x):
    return torch.nn.functional.gelu(x, approximate="tanh")
def _silu(x):
    return torch.nn.functional.silu(x)
def _sigmoid(x):
    return torch.sigmoid(x)
def _layernorm(x, axis=-1, eps=1e-5):
    m = x.mean(dim=axis, keepdim=True)
    v = x.var(dim=axis, keepdim=True, unbiased=False)
    return (x - m) / torch.sqrt(v + eps)
def _scatter_add(tgt, idx, src, axis=0):
    return tgt.clone().index_add_(axis, idx, src)
def _segment_sum(src, seg, n):
    out = torch.zeros((n,) + src.shape[1:], dtype=src.dtype)
    return out.index_add_(0, seg, src)
def _pad(x, pw):
    flat = tuple(v for pair in reversed(pw) for v in pair)
    return torch.nn.functional.pad(x, flat)

kernel_name = 'sequential_preLN__sliding_local_dilated__dense_activation_silu__prompt'

def setup_inputs():

    _w = (lambda a: (lambda t: t.to(torch.bfloat16) if t.is_floating_point() else t)(torch.as_tensor(a)))
    def _A_setup():
        B, S, D = 1, 2048, 1024
        return {
            "x": _w((lambda *s: torch.randn(*s, dtype=torch.bfloat16) * 0.05)(B, S, D)),
            "wqkv": _w((lambda *s: torch.randn(*s, dtype=torch.bfloat16) * 0.05)(D, 3 * D)),
            "wo": _w((lambda *s: torch.randn(*s, dtype=torch.bfloat16) * 0.05)(D, D)),
        }
    _A_in = _A_setup()

    def _B_setup():
        B, S, D, F = 1, 2048, 1024, 3584
        return {
            "x": _w((lambda *s: torch.randn(*s, dtype=torch.bfloat16) * 0.05)(B, S, D)),
            "w1": _w((lambda *s: torch.randn(*s, dtype=torch.bfloat16) * 3.2)(D, F) * (D ** -0.5)),
            "w2": _w((lambda *s: torch.randn(*s, dtype=torch.bfloat16) * 0.4)(F, D) * (F ** -0.5)),
        }
    _B_in = _B_setup()

    return {
        "A_x": _A_in["x"],
        "A_wqkv": _A_in["wqkv"],
        "A_wo": _A_in["wo"],
        "B_x": _B_in["x"],
        "B_w1": _B_in["w1"],
        "B_w2": _B_in["w2"],
    }

def reference(A_x, A_wqkv, A_wo, B_x, B_w1, B_w2):
    def _A_ref(x, wqkv, wo):
        B, S, D = x.shape
        H = 32; Dh = D // H
        W, dil = 8, 2
        qkv = (lambda x, *d: x.permute(*d))((x @ wqkv).reshape(B, S, 3, H, Dh), 2, 0, 3, 1, 4)
        q, k, v = qkv[0], qkv[1], qkv[2]
        scale = Dh ** -0.5
        pos = torch.arange(S)
        off = torch.arange(W) * dil
        idx = pos[:, None] - off[None, :]
        mask = idx >= 0
        idx_c = torch.where(mask, idx, 0).reshape(-1)
        kg = k[:, :, idx_c, :].reshape(B, H, S, W, Dh)
        vg = v[:, :, idx_c, :].reshape(B, H, S, W, Dh)
        logits = torch.einsum("bhsd,bhswd->bhsw", q, kg) * scale
        logits = torch.where(mask[None, None, :, :], logits, -1e9)
        attn = _softmax(logits, axis=-1)
        o = torch.einsum("bhsw,bhswd->bhsd", attn, vg)
        return (lambda x, *d: x.permute(*d))(o, 0, 2, 1, 3).reshape(B, S, D) @ wo

    def _B_ref(x, w1, w2):
        h = torch.einsum("bsd,df->bsf", x, w1)
        h = _silu(h)
        out = torch.einsum("bsf,fd->bsd", h, w2)
        return out

    x = A_x
    h = x + _A_ref(_layernorm(x, axis=-1), A_wqkv, A_wo)
    h2 = h + _B_ref(_layernorm(h, axis=-1), B_w1, B_w2)
    return h2
```

```asm
; @launch grid=(256,1,1) block=(512,1,1) lds=163840
.amdgcn_target "amdgcn-amd-amdhsa--gfx950"
.text
.globl sequential_preLN__sliding_local_dilated__dense_activation_silu__prompt_kernel
.p2align 8
.type sequential_preLN__sliding_local_dilated__dense_activation_silu__prompt_kernel,@function
sequential_preLN__sliding_local_dilated__dense_activation_silu__prompt_kernel:
    s_cmp_ge_u32 s2, 256
    s_cbranch_scc1 L_end
    s_load_dwordx16 s[40:55], s[0:1], 0
    s_load_dwordx2 s[56:57], s[0:1], 64
    v_lshrrev_b32 v1, 6, v0
    v_and_b32 v0, 63, v0
    s_and_b32 s61, s2, 7
    v_readfirstlane_b32 s3, v1
    s_lshr_b32 s7, s2, 3
    s_and_b32 s4, s61, 3
    s_lshr_b32 s6, s61, 2
    s_lshl_b32 s4, s4, 2
    s_and_b32 s61, s7, 3
    s_add_u32 s4, s4, s61
    s_lshr_b32 s7, s7, 2
    s_lshl_b32 s5, s6, 3
    s_add_u32 s5, s5, s7
    s_sub_u32 s63, s3, 4
    s_lshl_b32 s76, s4, 11
    s_lshl_b32 s75, s6, 9
    s_add_u32 s75, s75, s76
    s_cmp_ge_u32 s5, 3
    s_addc_u32 s61, s5, 0
    s_cmp_ge_u32 s5, 10
    s_addc_u32 s77, s61, 0
    s_lshl_b32 s77, s77, 7
    s_cmp_ge_u32 s3, 4
    s_cbranch_scc1 P1_ld
    s_cmp_ge_u32 s2, 8
    s_cbranch_scc1 Lpc_1
    s_getpc_b64 s[64:65]
    v_lshlrev_b32 v3, 7, v0
    v_lshl_add_u32 v3, s3, 13, v3
    global_load_dword v250, v3, s[64:65]
    v_add_u32 v3, 0x8000, v3
    global_load_dword v251, v3, s[64:65]
Lpc_1:
    v_and_b32 v1, 15, v0
    v_lshrrev_b32 v2, 4, v0
    v_lshrrev_b32 v3, 1, v1
    v_xor_b32 v3, v2, v3
    v_lshlrev_b32 v4, 7, v1
    v_lshl_add_u32 v8, v3, 4, v4
    v_xor_b32 v9, 64, v8
    v_lshrrev_b32 v3, 2, v1
    v_lshlrev_b32 v3, 7, v3
    v_lshl_add_u32 v3, v2, 10, v3
    v_and_b32 v4, 3, v1
    v_lshl_add_u32 v5, v4, 3, v3
    v_add_u32 v5, 18432, v5
    v_lshrrev_b32 v3, 3, v1
    v_and_b32 v4, 1, v2
    v_lshl_add_u32 v6, v4, 1, v3
    v_xor_b32 v7, s3, v6
    v_lshl_add_u32 v10, v7, 5, v5
    s_lshl_b32 s61, s3, 5
    v_mul_u32_u24 v3, 400, v1
    v_lshl_add_u32 v3, v2, 3, v3
    v_add_u32 v11, s61, v3
    v_lshlrev_b32 v3, 3, v1
    v_add_u32 v12, 129024, v3
    v_mov_b32 v16, 0x3f803f80
    v_mov_b32 v17, 0x3f803f80
    v_mov_b32 v18, 0x3f803f80
    v_mov_b32 v19, 0x3f803f80
    v_mov_b32 v20, 0
    v_mov_b32 v21, 0
    v_mov_b32 v22, 0
    v_mov_b32 v23, 0
    v_mov_b32 v24, 0
    v_mov_b32 v25, 0
    v_mov_b32 v26, 0
    v_mov_b32 v27, 0
    v_mov_b32 v28, 0
    v_mov_b32 v29, 0
    v_mov_b32 v30, 0
    v_mov_b32 v31, 0
    v_mov_b32 v32, 0
    v_mov_b32 v33, 0
    v_mov_b32 v34, 0
    v_mov_b32 v35, 0
    v_mov_b32 v36, 0
    v_mov_b32 v37, 0
    v_mov_b32 v38, 0
    v_mov_b32 v39, 0
    v_mov_b32 v40, 0
    v_mov_b32 v41, 0
    v_mov_b32 v42, 0
    v_mov_b32 v43, 0
    v_mov_b32 v44, 0
    v_mov_b32 v45, 0
    v_mov_b32 v46, 0
    v_mov_b32 v47, 0
    v_mov_b32 v48, 0
    v_mov_b32 v49, 0
    v_mov_b32 v50, 0
    v_mov_b32 v51, 0
    v_mov_b32 v52, 0
    v_mov_b32 v53, 0
    v_mov_b32 v54, 0
    v_mov_b32 v55, 0
    v_mov_b32 v56, 0
    v_mov_b32 v57, 0
    v_mov_b32 v58, 0
    v_mov_b32 v59, 0
    v_mov_b32 v60, 0
    v_mov_b32 v61, 0
    v_mov_b32 v62, 0
    v_mov_b32 v63, 0
    v_mov_b32 v64, 0
    v_mov_b32 v65, 0
    v_mov_b32 v66, 0
    v_mov_b32 v67, 0
    v_mov_b32 v68, 0
    v_mov_b32 v69, 0
    v_mov_b32 v70, 0
    v_mov_b32 v71, 0
    v_mov_b32 v72, 0
    v_mov_b32 v73, 0
    v_mov_b32 v74, 0
    v_mov_b32 v75, 0
    v_mov_b32 v76, 0
    v_mov_b32 v77, 0
    v_mov_b32 v78, 0
    v_mov_b32 v79, 0
    v_mov_b32 v80, 0
    v_mov_b32 v81, 0
    v_mov_b32 v82, 0
    v_mov_b32 v83, 0
    v_mov_b32 v84, 0
    v_mov_b32 v85, 0
    v_mov_b32 v86, 0
    v_mov_b32 v87, 0
    v_mov_b32 v88, 0
    v_mov_b32 v89, 0
    v_mov_b32 v90, 0
    v_mov_b32 v91, 0
    v_mov_b32 v92, 0
    v_mov_b32 v93, 0
    v_mov_b32 v94, 0
    v_mov_b32 v95, 0
    v_mov_b32 v96, 0
    v_mov_b32 v97, 0
    v_mov_b32 v98, 0
    v_mov_b32 v99, 0
    v_mov_b32 v100, 0
    v_mov_b32 v101, 0
    v_mov_b32 v102, 0
    v_mov_b32 v103, 0
    v_mov_b32 v104, 0
    v_mov_b32 v105, 0
    v_mov_b32 v106, 0
    v_mov_b32 v107, 0
    v_mov_b32 v108, 0
    v_mov_b32 v109, 0
    v_mov_b32 v110, 0
    v_mov_b32 v111, 0
    v_mov_b32 v112, 0
    v_mov_b32 v113, 0
    v_mov_b32 v114, 0
    v_mov_b32 v115, 0
    v_mov_b32 v116, 0
    v_mov_b32 v117, 0
    v_mov_b32 v118, 0
    v_mov_b32 v119, 0
    v_mov_b32 v120, 0
    v_mov_b32 v121, 0
    v_mov_b32 v122, 0
    v_mov_b32 v123, 0
    v_mov_b32 v124, 0
    v_mov_b32 v125, 0
    v_mov_b32 v126, 0
    v_mov_b32 v127, 0
    v_mov_b32 v128, 0
    v_mov_b32 v129, 0
    v_mov_b32 v130, 0
    v_mov_b32 v131, 0
    v_mov_b32 v132, 0
    v_mov_b32 v133, 0
    v_mov_b32 v134, 0
    v_mov_b32 v135, 0
    s_waitcnt lgkmcnt(0)
    s_add_u32 s32, s56, 44040192
    s_addc_u32 s33, s57, 0
    s_mov_b32 s34, 262144
    s_mov_b32 s35, 0x20000
    s_mov_b32 s36, s54
    s_mov_b32 s37, s55
    s_mov_b32 s38, 256
    s_mov_b32 s39, 0x20000
    s_add_u32 s24, s56, 42991616
    s_addc_u32 s25, s57, 0
    s_mov_b32 s26, 16384
    s_mov_b32 s27, 0x20000
    s_mov_b32 s8, s40
    s_mov_b32 s9, s41
    s_mov_b32 s10, 0
    s_mov_b32 s11, 0x20000
    s_mov_b32 s12, s40
    s_mov_b32 s13, s41
    s_mov_b32 s14, 0
    s_mov_b32 s15, 0x20000
    v_mov_b32 v240, 0
    v_mov_b32 v241, 0
    v_mov_b32 v242, 0
    v_mov_b32 v254, 0
    s_cmp_eq_u32 s3, 0
    s_cselect_b32 s66, 1408, 0
    s_cbranch_scc0 P1_nz
    v_lshlrev_b32 v3, 7, v0
    s_cmp_eq_u32 s5, 0
    v_add_u32 v3, s76, v3
    s_cselect_b32 s61, 10, 0
    v_cmp_gt_u32 vcc, s61, v0
    v_mov_b32 v4, 0x80000000
    s_lshl_b32 s62, s2, 7
    v_cndmask_b32 v3, v4, v3, vcc
    s_add_u32 s62, s62, 65472
    v_lshlrev_b32 v5, 2, v0
    v_add_u32 v5, s62, v5
    v_subrev_u32 v4, 16, v0
    v_cmp_gt_u32 vcc, 4, v4
    v_mov_b32 v6, 0
    s_lshl_b32 s61, s5, 2
    v_cndmask_b32 v3, v3, v5, vcc
    s_add_u32 s61, s61, s76
    s_add_u32 s62, s61, 128
    v_writelane_b32 v3, s61, 20
    v_writelane_b32 v3, s62, 21
    buffer_store_dword v6, v3, s[32:35], 0 offen sc1
P1_nz:
    v_add_u32 v13, 86016, v8
    v_add_u32 v14, 86016, v9
    v_add_u32 v15, 86016, v10
    s_mov_b32 s58, 0
    s_barrier
    ds_read_b64_tr_b16 v[172:173], v10 offset:0
    ds_read_b64_tr_b16 v[174:175], v10 offset:512
    ds_read_b128 v[136:139], v8 offset:0
    ds_read_b128 v[140:143], v8 offset:2048
    ds_read_b128 v[144:147], v8 offset:4096
    ds_read_b128 v[148:151], v8 offset:6144
    ds_read_b128 v[152:155], v8 offset:8192
    ds_read_b128 v[156:159], v8 offset:10240
    ds_read_b128 v[160:163], v8 offset:12288
    ds_read_b128 v[164:167], v8 offset:14336
    ds_read_b128 v[168:171], v8 offset:16384
    ds_read_b64_tr_b16 v[176:177], v10 offset:8192
    ds_read_b64_tr_b16 v[178:179], v10 offset:8704
    ds_read_b64_tr_b16 v[180:181], v10 offset:16384
    ds_read_b64_tr_b16 v[182:183], v10 offset:16896
    s_waitcnt lgkmcnt(0)
Lcl_2:
    v_mfma_f32_16x16x32_bf16 v[20:23], v[172:175], v[140:143], v[20:23]
    ds_read_b64_tr_b16 v[220:221], v10 offset:4096
    v_mfma_f32_16x16x32_bf16 v[24:27], v[172:175], v[144:147], v[24:27]
    ds_read_b64_tr_b16 v[222:223], v10 offset:4608
    v_mfma_f32_16x16x32_bf16 v[28:31], v[172:175], v[148:151], v[28:31]
    v_mfma_f32_16x16x32_bf16 v[32:35], v[172:175], v[152:155], v[32:35]
    ds_read_b128 v[184:187], v9 offset:0
    v_mfma_f32_16x16x32_bf16 v[36:39], v[172:175], v[156:159], v[36:39]
    ds_read_b128 v[188:191], v9 offset:2048
    v_mfma_f32_16x16x32_bf16 v[40:43], v[172:175], v[160:163], v[40:43]
    v_mfma_f32_16x16x32_bf16 v[44:47], v[172:175], v[164:167], v[44:47]
    ds_read_b128 v[192:195], v9 offset:4096
    v_mfma_f32_16x16x32_bf16 v[48:51], v[172:175], v[168:171], v[48:51]
    ds_read_b128 v[196:199], v9 offset:6144
    v_mfma_f32_16x16x32_bf16 v[124:127], v[172:175], v[16:19], v[124:127]
    v_mfma_f32_16x16x32_bf16 v[52:55], v[176:179], v[136:139], v[52:55]
    ds_read_b128 v[200:203], v9 offset:8192
    v_mfma_f32_16x16x32_bf16 v[56:59], v[176:179], v[140:143], v[56:59]
    ds_read_b128 v[204:207], v9 offset:10240
    v_mfma_f32_16x16x32_bf16 v[60:63], v[176:179], v[144:147], v[60:63]
    v_mfma_f32_16x16x32_bf16 v[64:67], v[176:179], v[148:151], v[64:67]
    ds_read_b128 v[208:211], v9 offset:12288
    v_mfma_f32_16x16x32_bf16 v[68:71], v[176:179], v[152:155], v[68:71]
    ds_read_b128 v[212:215], v9 offset:14336
    v_mfma_f32_16x16x32_bf16 v[72:75], v[176:179], v[156:159], v[72:75]
    v_mfma_f32_16x16x32_bf16 v[76:79], v[176:179], v[160:163], v[76:79]
    ds_read_b128 v[216:219], v9 offset:16384
    v_mfma_f32_16x16x32_bf16 v[80:83], v[176:179], v[164:167], v[80:83]
    ds_read_b64_tr_b16 v[224:225], v10 offset:12288
    v_mfma_f32_16x16x32_bf16 v[84:87], v[176:179], v[168:171], v[84:87]
    v_mfma_f32_16x16x32_bf16 v[128:131], v[176:179], v[16:19], v[128:131]
    ds_read_b64_tr_b16 v[226:227], v10 offset:12800
    v_mfma_f32_16x16x32_bf16 v[88:91], v[180:183], v[136:139], v[88:91]
    ds_read_b64_tr_b16 v[228:229], v10 offset:20480
    v_mfma_f32_16x16x32_bf16 v[92:95], v[180:183], v[140:143], v[92:95]
    v_mfma_f32_16x16x32_bf16 v[96:99], v[180:183], v[144:147], v[96:99]
    ds_read_b64_tr_b16 v[230:231], v10 offset:20992
    v_mfma_f32_16x16x32_bf16 v[100:103], v[180:183], v[148:151], v[100:103]
    v_mfma_f32_16x16x32_bf16 v[104:107], v[180:183], v[152:155], v[104:107]
    v_mfma_f32_16x16x32_bf16 v[108:111], v[180:183], v[156:159], v[108:111]
    v_mfma_f32_16x16x32_bf16 v[112:115], v[180:183], v[160:163], v[112:115]
    v_mfma_f32_16x16x32_bf16 v[116:119], v[180:183], v[164:167], v[116:119]
    v_mfma_f32_16x16x32_bf16 v[120:123], v[180:183], v[168:171], v[120:123]
    s_add_u32 s58, s58, 1
    v_mfma_f32_16x16x32_bf16 v[132:135], v[180:183], v[16:19], v[132:135]
    s_waitcnt lgkmcnt(0)
    s_bitcmp1_b32 s66, s58
    s_cbranch_scc1 P1_hk0
P1_hk0_ret:
    s_barrier
    v_mfma_f32_16x16x32_bf16 v[20:23], v[220:223], v[188:191], v[20:23]
    ds_read_b64_tr_b16 v[172:173], v10 offset:43008
    v_mfma_f32_16x16x32_bf16 v[24:27], v[220:223], v[192:195], v[24:27]
    ds_read_b64_tr_b16 v[174:175], v10 offset:43520
    v_mfma_f32_16x16x32_bf16 v[28:31], v[220:223], v[196:199], v[28:31]
    v_mfma_f32_16x16x32_bf16 v[32:35], v[220:223], v[200:203], v[32:35]
    ds_read_b128 v[136:139], v8 offset:43008
    v_mfma_f32_16x16x32_bf16 v[36:39], v[220:223], v[204:207], v[36:39]
    ds_read_b128 v[140:143], v8 offset:45056
    v_mfma_f32_16x16x32_bf16 v[40:43], v[220:223], v[208:211], v[40:43]
    v_mfma_f32_16x16x32_bf16 v[44:47], v[220:223], v[212:215], v[44:47]
    ds_read_b128 v[144:147], v8 offset:47104
    v_mfma_f32_16x16x32_bf16 v[48:51], v[220:223], v[216:219], v[48:51]
    ds_read_b128 v[148:151], v8 offset:49152
    v_mfma_f32_16x16x32_bf16 v[124:127], v[220:223], v[16:19], v[124:127]
    v_mfma_f32_16x16x32_bf16 v[52:55], v[224:227], v[184:187], v[52:55]
    ds_read_b128 v[152:155], v8 offset:51200
    v_mfma_f32_16x16x32_bf16 v[56:59], v[224:227], v[188:191], v[56:59]
    ds_read_b128 v[156:159], v8 offset:53248
    v_mfma_f32_16x16x32_bf16 v[60:63], v[224:227], v[192:195], v[60:63]
    v_mfma_f32_16x16x32_bf16 v[64:67], v[224:227], v[196:199], v[64:67]
    ds_read_b128 v[160:163], v8 offset:55296
    v_mfma_f32_16x16x32_bf16 v[68:71], v[224:227], v[200:203], v[68:71]
    ds_read_b128 v[164:167], v8 offset:57344
    v_mfma_f32_16x16x32_bf16 v[72:75], v[224:227], v[204:207], v[72:75]
    v_mfma_f32_16x16x32_bf16 v[76:79], v[224:227], v[208:211], v[76:79]
    ds_read_b128 v[168:171], v8 offset:59392
    v_mfma_f32_16x16x32_bf16 v[80:83], v[224:227], v[212:215], v[80:83]
    ds_read_b64_tr_b16 v[176:177], v10 offset:51200
    v_mfma_f32_16x16x32_bf16 v[84:87], v[224:227], v[216:219], v[84:87]
    v_mfma_f32_16x16x32_bf16 v[128:131], v[224:227], v[16:19], v[128:131]
    ds_read_b64_tr_b16 v[178:179], v10 offset:51712
    v_mfma_f32_16x16x32_bf16 v[88:91], v[228:231], v[184:187], v[88:91]
    ds_read_b64_tr_b16 v[180:181], v10 offset:59392
    v_mfma_f32_16x16x32_bf16 v[92:95], v[228:231], v[188:191], v[92:95]
    v_mfma_f32_16x16x32_bf16 v[96:99], v[228:231], v[192:195], v[96:99]
    ds_read_b64_tr_b16 v[182:183], v10 offset:59904
    v_mfma_f32_16x16x32_bf16 v[100:103], v[228:231], v[196:199], v[100:103]
    v_mfma_f32_16x16x32_bf16 v[104:107], v[228:231], v[200:203], v[104:107]
    v_mfma_f32_16x16x32_bf16 v[108:111], v[228:231], v[204:207], v[108:111]
    v_mfma_f32_16x16x32_bf16 v[112:115], v[228:231], v[208:211], v[112:115]
    v_mfma_f32_16x16x32_bf16 v[116:119], v[228:231], v[212:215], v[116:119]
    v_mfma_f32_16x16x32_bf16 v[120:123], v[228:231], v[216:219], v[120:123]
    s_cmp_lt_u32 s58, 16
    v_mfma_f32_16x16x32_bf16 v[132:135], v[228:231], v[16:19], v[132:135]
    s_waitcnt lgkmcnt(0)
    s_cbranch_scc0 Lcx_3
    v_mfma_f32_16x16x32_bf16 v[20:23], v[172:175], v[140:143], v[20:23]
    ds_read_b64_tr_b16 v[220:221], v10 offset:47104
    v_mfma_f32_16x16x32_bf16 v[24:27], v[172:175], v[144:147], v[24:27]
    ds_read_b64_tr_b16 v[222:223], v10 offset:47616
    v_mfma_f32_16x16x32_bf16 v[28:31], v[172:175], v[148:151], v[28:31]
    v_mfma_f32_16x16x32_bf16 v[32:35], v[172:175], v[152:155], v[32:35]
    ds_read_b128 v[184:187], v9 offset:43008
    v_mfma_f32_16x16x32_bf16 v[36:39], v[172:175], v[156:159], v[36:39]
    ds_read_b128 v[188:191], v9 offset:45056
    v_mfma_f32_16x16x32_bf16 v[40:43], v[172:175], v[160:163], v[40:43]
    v_mfma_f32_16x16x32_bf16 v[44:47], v[172:175], v[164:167], v[44:47]
    ds_read_b128 v[192:195], v9 offset:47104
    v_mfma_f32_16x16x32_bf16 v[48:51], v[172:175], v[168:171], v[48:51]
    ds_read_b128 v[196:199], v9 offset:49152
    v_mfma_f32_16x16x32_bf16 v[124:127], v[172:175], v[16:19], v[124:127]
    v_mfma_f32_16x16x32_bf16 v[52:55], v[176:179], v[136:139], v[52:55]
    ds_read_b128 v[200:203], v9 offset:51200
    v_mfma_f32_16x16x32_bf16 v[56:59], v[176:179], v[140:143], v[56:59]
    ds_read_b128 v[204:207], v9 offset:53248
    v_mfma_f32_16x16x32_bf16 v[60:63], v[176:179], v[144:147], v[60:63]
    v_mfma_f32_16x16x32_bf16 v[64:67], v[176:179], v[148:151], v[64:67]
    ds_read_b128 v[208:211], v9 offset:55296
    v_mfma_f32_16x16x32_bf16 v[68:71], v[176:179], v[152:155], v[68:71]
    ds_read_b128 v[212:215], v9 offset:57344
    v_mfma_f32_16x16x32_bf16 v[72:75], v[176:179], v[156:159], v[72:75]
    v_mfma_f32_16x16x32_bf16 v[76:79], v[176:179], v[160:163], v[76:79]
    ds_read_b128 v[216:219], v9 offset:59392
    v_mfma_f32_16x16x32_bf16 v[80:83], v[176:179], v[164:167], v[80:83]
    ds_read_b64_tr_b16 v[224:225], v10 offset:55296
    v_mfma_f32_16x16x32_bf16 v[84:87], v[176:179], v[168:171], v[84:87]
    v_mfma_f32_16x16x32_bf16 v[128:131], v[176:179], v[16:19], v[128:131]
    ds_read_b64_tr_b16 v[226:227], v10 offset:55808
    v_mfma_f32_16x16x32_bf16 v[88:91], v[180:183], v[136:139], v[88:91]
    ds_read_b64_tr_b16 v[228:229], v10 offset:63488
    v_mfma_f32_16x16x32_bf16 v[92:95], v[180:183], v[140:143], v[92:95]
    v_mfma_f32_16x16x32_bf16 v[96:99], v[180:183], v[144:147], v[96:99]
    ds_read_b64_tr_b16 v[230:231], v10 offset:64000
    v_mfma_f32_16x16x32_bf16 v[100:103], v[180:183], v[148:151], v[100:103]
    v_mfma_f32_16x16x32_bf16 v[104:107], v[180:183], v[152:155], v[104:107]
    v_mfma_f32_16x16x32_bf16 v[108:111], v[180:183], v[156:159], v[108:111]
    v_mfma_f32_16x16x32_bf16 v[112:115], v[180:183], v[160:163], v[112:115]
    v_mfma_f32_16x16x32_bf16 v[116:119], v[180:183], v[164:167], v[116:119]
    v_mfma_f32_16x16x32_bf16 v[120:123], v[180:183], v[168:171], v[120:123]
    s_add_u32 s58, s58, 1
    v_mfma_f32_16x16x32_bf16 v[132:135], v[180:183], v[16:19], v[132:135]
    s_waitcnt lgkmcnt(0)
    s_bitcmp1_b32 s66, s58
    s_cbranch_scc1 P1_hk1
P1_hk1_ret:
    s_barrier
    v_mfma_f32_16x16x32_bf16 v[20:23], v[220:223], v[188:191], v[20:23]
    ds_read_b64_tr_b16 v[172:173], v15 offset:0
    v_mfma_f32_16x16x32_bf16 v[24:27], v[220:223], v[192:195], v[24:27]
    ds_read_b64_tr_b16 v[174:175], v15 offset:512
    v_mfma_f32_16x16x32_bf16 v[28:31], v[220:223], v[196:199], v[28:31]
    v_mfma_f32_16x16x32_bf16 v[32:35], v[220:223], v[200:203], v[32:35]
    ds_read_b128 v[136:139], v13 offset:0
    v_mfma_f32_16x16x32_bf16 v[36:39], v[220:223], v[204:207], v[36:39]
    ds_read_b128 v[140:143], v13 offset:2048
    v_mfma_f32_16x16x32_bf16 v[40:43], v[220:223], v[208:211], v[40:43]
    v_mfma_f32_16x16x32_bf16 v[44:47], v[220:223], v[212:215], v[44:47]
    ds_read_b128 v[144:147], v13 offset:4096
    v_mfma_f32_16x16x32_bf16 v[48:51], v[220:223], v[216:219], v[48:51]
    ds_read_b128 v[148:151], v13 offset:6144
    v_mfma_f32_16x16x32_bf16 v[124:127], v[220:223], v[16:19], v[124:127]
    v_mfma_f32_16x16x32_bf16 v[52:55], v[224:227], v[184:187], v[52:55]
    ds_read_b128 v[152:155], v13 offset:8192
    v_mfma_f32_16x16x32_bf16 v[56:59], v[224:227], v[188:191], v[56:59]
    ds_read_b128 v[156:159], v13 offset:10240
    v_mfma_f32_16x16x32_bf16 v[60:63], v[224:227], v[192:195], v[60:63]
    v_mfma_f32_16x16x32_bf16 v[64:67], v[224:227], v[196:199], v[64:67]
    ds_read_b128 v[160:163], v13 offset:12288
    v_mfma_f32_16x16x32_bf16 v[68:71], v[224:227], v[200:203], v[68:71]
    ds_read_b128 v[164:167], v13 offset:14336
    v_mfma_f32_16x16x32_bf16 v[72:75], v[224:227], v[204:207], v[72:75]
    v_mfma_f32_16x16x32_bf16 v[76:79], v[224:227], v[208:211], v[76:79]
    ds_read_b128 v[168:171], v13 offset:16384
    v_mfma_f32_16x16x32_bf16 v[80:83], v[224:227], v[212:215], v[80:83]
    ds_read_b64_tr_b16 v[176:177], v15 offset:8192
    v_mfma_f32_16x16x32_bf16 v[84:87], v[224:227], v[216:219], v[84:87]
    v_mfma_f32_16x16x32_bf16 v[128:131], v[224:227], v[16:19], v[128:131]
    ds_read_b64_tr_b16 v[178:179], v15 offset:8704
    v_mfma_f32_16x16x32_bf16 v[88:91], v[228:231], v[184:187], v[88:91]
    ds_read_b64_tr_b16 v[180:181], v15 offset:16384
    v_mfma_f32_16x16x32_bf16 v[92:95], v[228:231], v[188:191], v[92:95]
    v_mfma_f32_16x16x32_bf16 v[96:99], v[228:231], v[192:195], v[96:99]
    ds_read_b64_tr_b16 v[182:183], v15 offset:16896
    v_mfma_f32_16x16x32_bf16 v[100:103], v[228:231], v[196:199], v[100:103]
    v_mfma_f32_16x16x32_bf16 v[104:107], v[228:231], v[200:203], v[104:107]
    v_mfma_f32_16x16x32_bf16 v[108:111], v[228:231], v[204:207], v[108:111]
    v_mfma_f32_16x16x32_bf16 v[112:115], v[228:231], v[208:211], v[112:115]
    v_mfma_f32_16x16x32_bf16 v[116:119], v[228:231], v[212:215], v[116:119]
    v_mfma_f32_16x16x32_bf16 v[120:123], v[228:231], v[216:219], v[120:123]
    v_mfma_f32_16x16x32_bf16 v[132:135], v[228:231], v[16:19], v[132:135]
    s_waitcnt lgkmcnt(0)
    v_mfma_f32_16x16x32_bf16 v[20:23], v[172:175], v[140:143], v[20:23]
    ds_read_b64_tr_b16 v[220:221], v15 offset:4096
    v_mfma_f32_16x16x32_bf16 v[24:27], v[172:175], v[144:147], v[24:27]
    ds_read_b64_tr_b16 v[222:223], v15 offset:4608
    v_mfma_f32_16x16x32_bf16 v[28:31], v[172:175], v[148:151], v[28:31]
    v_mfma_f32_16x16x32_bf16 v[32:35], v[172:175], v[152:155], v[32:35]
    ds_read_b128 v[184:187], v14 offset:0
    v_mfma_f32_16x16x32_bf16 v[36:39], v[172:175], v[156:159], v[36:39]
    ds_read_b128 v[188:191], v14 offset:2048
    v_mfma_f32_16x16x32_bf16 v[40:43], v[172:175], v[160:163], v[40:43]
    v_mfma_f32_16x16x32_bf16 v[44:47], v[172:175], v[164:167], v[44:47]
    ds_read_b128 v[192:195], v14 offset:4096
    v_mfma_f32_16x16x32_bf16 v[48:51], v[172:175], v[168:171], v[48:51]
    ds_read_b128 v[196:199], v14 offset:6144
    v_mfma_f32_16x16x32_bf16 v[124:127], v[172:175], v[16:19], v[124:127]
    v_mfma_f32_16x16x32_bf16 v[52:55], v[176:179], v[136:139], v[52:55]
    ds_read_b128 v[200:203], v14 offset:8192
    v_mfma_f32_16x16x32_bf16 v[56:59], v[176:179], v[140:143], v[56:59]
    ds_read_b128 v[204:207], v14 offset:10240
    v_mfma_f32_16x16x32_bf16 v[60:63], v[176:179], v[144:147], v[60:63]
    v_mfma_f32_16x16x32_bf16 v[64:67], v[176:179], v[148:151], v[64:67]
    ds_read_b128 v[208:211], v14 offset:12288
    v_mfma_f32_16x16x32_bf16 v[68:71], v[176:179], v[152:155], v[68:71]
    ds_read_b128 v[212:215], v14 offset:14336
    v_mfma_f32_16x16x32_bf16 v[72:75], v[176:179], v[156:159], v[72:75]
    v_mfma_f32_16x16x32_bf16 v[76:79], v[176:179], v[160:163], v[76:79]
    ds_read_b128 v[216:219], v14 offset:16384
    v_mfma_f32_16x16x32_bf16 v[80:83], v[176:179], v[164:167], v[80:83]
    ds_read_b64_tr_b16 v[224:225], v15 offset:12288
    v_mfma_f32_16x16x32_bf16 v[84:87], v[176:179], v[168:171], v[84:87]
    v_mfma_f32_16x16x32_bf16 v[128:131], v[176:179], v[16:19], v[128:131]
    ds_read_b64_tr_b16 v[226:227], v15 offset:12800
    v_mfma_f32_16x16x32_bf16 v[88:91], v[180:183], v[136:139], v[88:91]
    ds_read_b64_tr_b16 v[228:229], v15 offset:20480
    v_mfma_f32_16x16x32_bf16 v[92:95], v[180:183], v[140:143], v[92:95]
    v_mfma_f32_16x16x32_bf16 v[96:99], v[180:183], v[144:147], v[96:99]
    ds_read_b64_tr_b16 v[230:231], v15 offset:20992
    v_mfma_f32_16x16x32_bf16 v[100:103], v[180:183], v[148:151], v[100:103]
    v_mfma_f32_16x16x32_bf16 v[104:107], v[180:183], v[152:155], v[104:107]
    v_mfma_f32_16x16x32_bf16 v[108:111], v[180:183], v[156:159], v[108:111]
    v_mfma_f32_16x16x32_bf16 v[112:115], v[180:183], v[160:163], v[112:115]
    v_mfma_f32_16x16x32_bf16 v[116:119], v[180:183], v[164:167], v[116:119]
    v_mfma_f32_16x16x32_bf16 v[120:123], v[180:183], v[168:171], v[120:123]
    s_add_u32 s58, s58, 1
    v_mfma_f32_16x16x32_bf16 v[132:135], v[180:183], v[16:19], v[132:135]
    s_waitcnt lgkmcnt(0)
    s_barrier
    v_mfma_f32_16x16x32_bf16 v[20:23], v[220:223], v[188:191], v[20:23]
    ds_read_b64_tr_b16 v[172:173], v10 offset:0
    v_mfma_f32_16x16x32_bf16 v[24:27], v[220:223], v[192:195], v[24:27]
    ds_read_b64_tr_b16 v[174:175], v10 offset:512
    v_mfma_f32_16x16x32_bf16 v[28:31], v[220:223], v[196:199], v[28:31]
    v_mfma_f32_16x16x32_bf16 v[32:35], v[220:223], v[200:203], v[32:35]
    ds_read_b128 v[136:139], v8 offset:0
    v_mfma_f32_16x16x32_bf16 v[36:39], v[220:223], v[204:207], v[36:39]
    ds_read_b128 v[140:143], v8 offset:2048
    v_mfma_f32_16x16x32_bf16 v[40:43], v[220:223], v[208:211], v[40:43]
    v_mfma_f32_16x16x32_bf16 v[44:47], v[220:223], v[212:215], v[44:47]
    ds_read_b128 v[144:147], v8 offset:4096
    v_mfma_f32_16x16x32_bf16 v[48:51], v[220:223], v[216:219], v[48:51]
    ds_read_b128 v[148:151], v8 offset:6144
    v_mfma_f32_16x16x32_bf16 v[124:127], v[220:223], v[16:19], v[124:127]
    v_mfma_f32_16x16x32_bf16 v[52:55], v[224:227], v[184:187], v[52:55]
    ds_read_b128 v[152:155], v8 offset:8192
    v_mfma_f32_16x16x32_bf16 v[56:59], v[224:227], v[188:191], v[56:59]
    ds_read_b128 v[156:159], v8 offset:10240
    v_mfma_f32_16x16x32_bf16 v[60:63], v[224:227], v[192:195], v[60:63]
    v_mfma_f32_16x16x32_bf16 v[64:67], v[224:227], v[196:199], v[64:67]
    ds_read_b128 v[160:163], v8 offset:12288
    v_mfma_f32_16x16x32_bf16 v[68:71], v[224:227], v[200:203], v[68:71]
    ds_read_b128 v[164:167], v8 offset:14336
    v_mfma_f32_16x16x32_bf16 v[72:75], v[224:227], v[204:207], v[72:75]
    v_mfma_f32_16x16x32_bf16 v[76:79], v[224:227], v[208:211], v[76:79]
    ds_read_b128 v[168:171], v8 offset:16384
    v_mfma_f32_16x16x32_bf16 v[80:83], v[224:227], v[212:215], v[80:83]
    ds_read_b64_tr_b16 v[176:177], v10 offset:8192
    v_mfma_f32_16x16x32_bf16 v[84:87], v[224:227], v[216:219], v[84:87]
    v_mfma_f32_16x16x32_bf16 v[128:131], v[224:227], v[16:19], v[128:131]
    ds_read_b64_tr_b16 v[178:179], v10 offset:8704
    v_mfma_f32_16x16x32_bf16 v[88:91], v[228:231], v[184:187], v[88:91]
    ds_read_b64_tr_b16 v[180:181], v10 offset:16384
    v_mfma_f32_16x16x32_bf16 v[92:95], v[228:231], v[188:191], v[92:95]
    v_mfma_f32_16x16x32_bf16 v[96:99], v[228:231], v[192:195], v[96:99]
    ds_read_b64_tr_b16 v[182:183], v10 offset:16896
    v_mfma_f32_16x16x32_bf16 v[100:103], v[228:231], v[196:199], v[100:103]
    v_mfma_f32_16x16x32_bf16 v[104:107], v[228:231], v[200:203], v[104:107]
    v_mfma_f32_16x16x32_bf16 v[108:111], v[228:231], v[204:207], v[108:111]
    v_mfma_f32_16x16x32_bf16 v[112:115], v[228:231], v[208:211], v[112:115]
    v_mfma_f32_16x16x32_bf16 v[116:119], v[228:231], v[212:215], v[116:119]
    v_mfma_f32_16x16x32_bf16 v[120:123], v[228:231], v[216:219], v[120:123]
    v_mfma_f32_16x16x32_bf16 v[132:135], v[228:231], v[16:19], v[132:135]
    s_waitcnt lgkmcnt(0)
    s_branch Lcl_2
Lcx_3:
    ds_read_b64 v[136:137], v12 offset:0
    ds_read_b64 v[138:139], v12 offset:128
    ds_read_b64 v[140:141], v12 offset:256
    ds_read_b64 v[142:143], v12 offset:384
    ds_read_b64 v[144:145], v12 offset:512
    ds_read_b64 v[146:147], v12 offset:640
    ds_read_b64 v[148:149], v12 offset:768
    ds_read_b64 v[150:151], v12 offset:896
    ds_read_b64 v[152:153], v12 offset:1024
    s_waitcnt lgkmcnt(0)
    v_pk_fma_f32 v[52:53], v[128:129], v[136:137], v[52:53] op_sel_hi:[1,0,1] neg_lo:[0,1,0] neg_hi:[0,1,0]
    v_pk_fma_f32 v[54:55], v[130:131], v[136:137], v[54:55] op_sel_hi:[1,0,1] neg_lo:[0,1,0] neg_hi:[0,1,0]
    v_pk_fma_f32 v[88:89], v[132:133], v[136:137], v[88:89] op_sel_hi:[1,0,1] neg_lo:[0,1,0] neg_hi:[0,1,0]
    v_pk_fma_f32 v[90:91], v[134:135], v[136:137], v[90:91] op_sel_hi:[1,0,1] neg_lo:[0,1,0] neg_hi:[0,1,0]
    v_pk_mul_f32 v[52:53], v[52:53], v[136:137] op_sel:[0,1] op_sel_hi:[1,1]
    v_pk_mul_f32 v[54:55], v[54:55], v[136:137] op_sel:[0,1] op_sel_hi:[1,1]
    v_pk_mul_f32 v[88:89], v[88:89], v[136:137] op_sel:[0,1] op_sel_hi:[1,1]
    v_pk_mul_f32 v[90:91], v[90:91], v[136:137] op_sel:[0,1] op_sel_hi:[1,1]
    v_cvt_pk_bf16_f32 v52, v52, v53
    v_cvt_pk_bf16_f32 v53, v54, v55
    v_cvt_pk_bf16_f32 v88, v88, v89
    v_cvt_pk_bf16_f32 v89, v90, v91
    v_pk_fma_f32 v[20:21], v[124:125], v[138:139], v[20:21] op_sel_hi:[1,0,1] neg_lo:[0,1,0] neg_hi:[0,1,0]
    v_pk_fma_f32 v[22:23], v[126:127], v[138:139], v[22:23] op_sel_hi:[1,0,1] neg_lo:[0,1,0] neg_hi:[0,1,0]
    ds_write_b64 v11, v[52:53] offset:128
    v_pk_fma_f32 v[56:57], v[128:129], v[138:139], v[56:57] op_sel_hi:[1,0,1] neg_lo:[0,1,0] neg_hi:[0,1,0]
    v_pk_fma_f32 v[58:59], v[130:131], v[138:139], v[58:59] op_sel_hi:[1,0,1] neg_lo:[0,1,0] neg_hi:[0,1,0]
    ds_write_b64 v11, v[88:89] offset:256
    v_pk_fma_f32 v[92:93], v[132:133], v[138:139], v[92:93] op_sel_hi:[1,0,1] neg_lo:[0,1,0] neg_hi:[0,1,0]
    v_pk_fma_f32 v[94:95], v[134:135], v[138:139], v[94:95] op_sel_hi:[1,0,1] neg_lo:[0,1,0] neg_hi:[0,1,0]
    v_pk_mul_f32 v[20:21], v[20:21], v[138:139] op_sel:[0,1] op_sel_hi:[1,1]
    v_pk_mul_f32 v[22:23], v[22:23], v[138:139] op_sel:[0,1] op_sel_hi:[1,1]
    v_pk_mul_f32 v[56:57], v[56:57], v[138:139] op_sel:[0,1] op_sel_hi:[1,1]
    v_pk_mul_f32 v[58:59], v[58:59], v[138:139] op_sel:[0,1] op_sel_hi:[1,1]
    v_pk_mul_f32 v[92:93], v[92:93], v[138:139] op_sel:[0,1] op_sel_hi:[1,1]
    v_pk_mul_f32 v[94:95], v[94:95], v[138:139] op_sel:[0,1] op_sel_hi:[1,1]
    v_cvt_pk_bf16_f32 v20, v20, v21
    v_cvt_pk_bf16_f32 v21, v22, v23
    v_cvt_pk_bf16_f32 v56, v56, v57
    v_cvt_pk_bf16_f32 v57, v58, v59
    v_cvt_pk_bf16_f32 v92, v92, v93
    v_cvt_pk_bf16_f32 v93, v94, v95
    v_pk_fma_f32 v[24:25], v[124:125], v[140:141], v[24:25] op_sel_hi:[1,0,1] neg_lo:[0,1,0] neg_hi:[0,1,0]
    v_pk_fma_f32 v[26:27], v[126:127], v[140:141], v[26:27] op_sel_hi:[1,0,1] neg_lo:[0,1,0] neg_hi:[0,1,0]
    ds_write_b64 v11, v[20:21] offset:6400
    v_pk_fma_f32 v[60:61], v[128:129], v[140:141], v[60:61] op_sel_hi:[1,0,1] neg_lo:[0,1,0] neg_hi:[0,1,0]
    v_pk_fma_f32 v[62:63], v[130:131], v[140:141], v[62:63] op_sel_hi:[1,0,1] neg_lo:[0,1,0] neg_hi:[0,1,0]
    ds_write_b64 v11, v[56:57] offset:6528
    v_pk_fma_f32 v[96:97], v[132:133], v[140:141], v[96:97] op_sel_hi:[1,0,1] neg_lo:[0,1,0] neg_hi:[0,1,0]
    v_pk_fma_f32 v[98:99], v[134:135], v[140:141], v[98:99] op_sel_hi:[1,0,1] neg_lo:[0,1,0] neg_hi:[0,1,0]
    ds_write_b64 v11, v[92:93] offset:6656
    v_pk_mul_f32 v[24:25], v[24:25], v[140:141] op_sel:[0,1] op_sel_hi:[1,1]
    v_pk_mul_f32 v[26:27], v[26:27], v[140:141] op_sel:[0,1] op_sel_hi:[1,1]
    v_pk_mul_f32 v[60:61], v[60:61], v[140:141] op_sel:[0,1] op_sel_hi:[1,1]
    v_pk_mul_f32 v[62:63], v[62:63], v[140:141] op_sel:[0,1] op_sel_hi:[1,1]
    v_pk_mul_f32 v[96:97], v[96:97], v[140:141] op_sel:[0,1] op_sel_hi:[1,1]
    v_pk_mul_f32 v[98:99], v[98:99], v[140:141] op_sel:[0,1] op_sel_hi:[1,1]
    v_cvt_pk_bf16_f32 v24, v24, v25
    v_cvt_pk_bf16_f32 v25, v26, v27
    v_cvt_pk_bf16_f32 v60, v60, v61
    v_cvt_pk_bf16_f32 v61, v62, v63
    v_cvt_pk_bf16_f32 v96, v96, v97
    v_cvt_pk_bf16_f32 v97, v98, v99
    v_pk_fma_f32 v[28:29], v[124:125], v[142:143], v[28:29] op_sel_hi:[1,0,1] neg_lo:[0,1,0] neg_hi:[0,1,0]
    v_pk_fma_f32 v[30:31], v[126:127], v[142:143], v[30:31] op_sel_hi:[1,0,1] neg_lo:[0,1,0] neg_hi:[0,1,0]
    ds_write_b64 v11, v[24:25] offset:12800
    v_pk_fma_f32 v[64:65], v[128:129], v[142:143], v[64:65] op_sel_hi:[1,0,1] neg_lo:[0,1,0] neg_hi:[0,1,0]
    v_pk_fma_f32 v[66:67], v[130:131], v[142:143], v[66:67] op_sel_hi:[1,0,1] neg_lo:[0,1,0] neg_hi:[0,1,0]
    ds_write_b64 v11, v[60:61] offset:12928
    v_pk_fma_f32 v[100:101], v[132:133], v[142:143], v[100:101] op_sel_hi:[1,0,1] neg_lo:[0,1,0] neg_hi:[0,1,0]
    v_pk_fma_f32 v[102:103], v[134:135], v[142:143], v[102:103] op_sel_hi:[1,0,1] neg_lo:[0,1,0] neg_hi:[0,1,0]
    ds_write_b64 v11, v[96:97] offset:13056
    v_pk_mul_f32 v[28:29], v[28:29], v[142:143] op_sel:[0,1] op_sel_hi:[1,1]
    v_pk_mul_f32 v[30:31], v[30:31], v[142:143] op_sel:[0,1] op_sel_hi:[1,1]
    v_pk_mul_f32 v[64:65], v[64:65], v[142:143] op_sel:[0,1] op_sel_hi:[1,1]
    v_pk_mul_f32 v[66:67], v[66:67], v[142:143] op_sel:[0,1] op_sel_hi:[1,1]
    v_pk_mul_f32 v[100:101], v[100:101], v[142:143] op_sel:[0,1] op_sel_hi:[1,1]
    v_pk_mul_f32 v[102:103], v[102:103], v[142:143] op_sel:[0,1] op_sel_hi:[1,1]
    v_cvt_pk_bf16_f32 v28, v28, v29
    v_cvt_pk_bf16_f32 v29, v30, v31
    v_cvt_pk_bf16_f32 v64, v64, v65
    v_cvt_pk_bf16_f32 v65, v66, v67
    v_cvt_pk_bf16_f32 v100, v100, v101
    v_cvt_pk_bf16_f32 v101, v102, v103
    v_pk_fma_f32 v[32:33], v[124:125], v[144:145], v[32:33] op_sel_hi:[1,0,1] neg_lo:[0,1,0] neg_hi:[0,1,0]
    v_pk_fma_f32 v[34:35], v[126:127], v[144:145], v[34:35] op_sel_hi:[1,0,1] neg_lo:[0,1,0] neg_hi:[0,1,0]
    ds_write_b64 v11, v[28:29] offset:19200
    v_pk_fma_f32 v[68:69], v[128:129], v[144:145], v[68:69] op_sel_hi:[1,0,1] neg_lo:[0,1,0] neg_hi:[0,1,0]
    v_pk_fma_f32 v[70:71], v[130:131], v[144:145], v[70:71] op_sel_hi:[1,0,1] neg_lo:[0,1,0] neg_hi:[0,1,0]
    ds_write_b64 v11, v[64:65] offset:19328
    v_pk_fma_f32 v[104:105], v[132:133], v[144:145], v[104:105] op_sel_hi:[1,0,1] neg_lo:[0,1,0] neg_hi:[0,1,0]
    v_pk_fma_f32 v[106:107], v[134:135], v[144:145], v[106:107] op_sel_hi:[1,0,1] neg_lo:[0,1,0] neg_hi:[0,1,0]
    ds_write_b64 v11, v[100:101] offset:19456
    v_pk_mul_f32 v[32:33], v[32:33], v[144:145] op_sel:[0,1] op_sel_hi:[1,1]
    v_pk_mul_f32 v[34:35], v[34:35], v[144:145] op_sel:[0,1] op_sel_hi:[1,1]
    v_pk_mul_f32 v[68:69], v[68:69], v[144:145] op_sel:[0,1] op_sel_hi:[1,1]
    v_pk_mul_f32 v[70:71], v[70:71], v[144:145] op_sel:[0,1] op_sel_hi:[1,1]
    v_pk_mul_f32 v[104:105], v[104:105], v[144:145] op_sel:[0,1] op_sel_hi:[1,1]
    v_pk_mul_f32 v[106:107], v[106:107], v[144:145] op_sel:[0,1] op_sel_hi:[1,1]
    v_cvt_pk_bf16_f32 v32, v32, v33
    v_cvt_pk_bf16_f32 v33, v34, v35
    v_cvt_pk_bf16_f32 v68, v68, v69
    v_cvt_pk_bf16_f32 v69, v70, v71
    v_cvt_pk_bf16_f32 v104, v104, v105
    v_cvt_pk_bf16_f32 v105, v106, v107
    v_pk_fma_f32 v[36:37], v[124:125], v[146:147], v[36:37] op_sel_hi:[1,0,1] neg_lo:[0,1,0] neg_hi:[0,1,0]
    v_pk_fma_f32 v[38:39], v[126:127], v[146:147], v[38:39] op_sel_hi:[1,0,1] neg_lo:[0,1,0] neg_hi:[0,1,0]
    ds_write_b64 v11, v[32:33] offset:25600
    v_pk_fma_f32 v[72:73], v[128:129], v[146:147], v[72:73] op_sel_hi:[1,0,1] neg_lo:[0,1,0] neg_hi:[0,1,0]
    v_pk_fma_f32 v[74:75], v[130:131], v[146:147], v[74:75] op_sel_hi:[1,0,1] neg_lo:[0,1,0] neg_hi:[0,1,0]
    ds_write_b64 v11, v[68:69] offset:25728
    v_pk_fma_f32 v[108:109], v[132:133], v[146:147], v[108:109] op_sel_hi:[1,0,1] neg_lo:[0,1,0] neg_hi:[0,1,0]
    v_pk_fma_f32 v[110:111], v[134:135], v[146:147], v[110:111] op_sel_hi:[1,0,1] neg_lo:[0,1,0] neg_hi:[0,1,0]
    ds_write_b64 v11, v[104:105] offset:25856
    v_pk_mul_f32 v[36:37], v[36:37], v[146:147] op_sel:[0,1] op_sel_hi:[1,1]
    v_pk_mul_f32 v[38:39], v[38:39], v[146:147] op_sel:[0,1] op_sel_hi:[1,1]
    v_pk_mul_f32 v[72:73], v[72:73], v[146:147] op_sel:[0,1] op_sel_hi:[1,1]
    v_pk_mul_f32 v[74:75], v[74:75], v[146:147] op_sel:[0,1] op_sel_hi:[1,1]
    v_pk_mul_f32 v[108:109], v[108:109], v[146:147] op_sel:[0,1] op_sel_hi:[1,1]
    v_pk_mul_f32 v[110:111], v[110:111], v[146:147] op_sel:[0,1] op_sel_hi:[1,1]
    v_cvt_pk_bf16_f32 v36, v36, v37
    v_cvt_pk_bf16_f32 v37, v38, v39
    v_cvt_pk_bf16_f32 v72, v72, v73
    v_cvt_pk_bf16_f32 v73, v74, v75
    v_cvt_pk_bf16_f32 v108, v108, v109
    v_cvt_pk_bf16_f32 v109, v110, v111
    v_pk_fma_f32 v[40:41], v[124:125], v[148:149], v[40:41] op_sel_hi:[1,0,1] neg_lo:[0,1,0] neg_hi:[0,1,0]
    v_pk_fma_f32 v[42:43], v[126:127], v[148:149], v[42:43] op_sel_hi:[1,0,1] neg_lo:[0,1,0] neg_hi:[0,1,0]
    ds_write_b64 v11, v[36:37] offset:32000
    v_pk_fma_f32 v[76:77], v[128:129], v[148:149], v[76:77] op_sel_hi:[1,0,1] neg_lo:[0,1,0] neg_hi:[0,1,0]
    v_pk_fma_f32 v[78:79], v[130:131], v[148:149], v[78:79] op_sel_hi:[1,0,1] neg_lo:[0,1,0] neg_hi:[0,1,0]
    ds_write_b64 v11, v[72:73] offset:32128
    v_pk_fma_f32 v[112:113], v[132:133], v[148:149], v[112:113] op_sel_hi:[1,0,1] neg_lo:[0,1,0] neg_hi:[0,1,0]
    v_pk_fma_f32 v[114:115], v[134:135], v[148:149], v[114:115] op_sel_hi:[1,0,1] neg_lo:[0,1,0] neg_hi:[0,1,0]
    ds_write_b64 v11, v[108:109] offset:32256
    v_pk_mul_f32 v[40:41], v[40:41], v[148:149] op_sel:[0,1] op_sel_hi:[1,1]
    v_pk_mul_f32 v[42:43], v[42:43], v[148:149] op_sel:[0,1] op_sel_hi:[1,1]
    v_pk_mul_f32 v[76:77], v[76:77], v[148:149] op_sel:[0,1] op_sel_hi:[1,1]
    v_pk_mul_f32 v[78:79], v[78:79], v[148:149] op_sel:[0,1] op_sel_hi:[1,1]
    v_pk_mul_f32 v[112:113], v[112:113], v[148:149] op_sel:[0,1] op_sel_hi:[1,1]
    v_pk_mul_f32 v[114:115], v[114:115], v[148:149] op_sel:[0,1] op_sel_hi:[1,1]
    v_cvt_pk_bf16_f32 v40, v40, v41
    v_cvt_pk_bf16_f32 v41, v42, v43
    v_cvt_pk_bf16_f32 v76, v76, v77
    v_cvt_pk_bf16_f32 v77, v78, v79
    v_cvt_pk_bf16_f32 v112, v112, v113
    v_cvt_pk_bf16_f32 v113, v114, v115
    v_pk_fma_f32 v[44:45], v[124:125], v[150:151], v[44:45] op_sel_hi:[1,0,1] neg_lo:[0,1,0] neg_hi:[0,1,0]
    v_pk_fma_f32 v[46:47], v[126:127], v[150:151], v[46:47] op_sel_hi:[1,0,1] neg_lo:[0,1,0] neg_hi:[0,1,0]
    ds_write_b64 v11, v[40:41] offset:38400
    v_pk_fma_f32 v[80:81], v[128:129], v[150:151], v[80:81] op_sel_hi:[1,0,1] neg_lo:[0,1,0] neg_hi:[0,1,0]
    v_pk_fma_f32 v[82:83], v[130:131], v[150:151], v[82:83] op_sel_hi:[1,0,1] neg_lo:[0,1,0] neg_hi:[0,1,0]
    ds_write_b64 v11, v[76:77] offset:38528
    v_pk_fma_f32 v[116:117], v[132:133], v[150:151], v[116:117] op_sel_hi:[1,0,1] neg_lo:[0,1,0] neg_hi:[0,1,0]
    v_pk_fma_f32 v[118:119], v[134:135], v[150:151], v[118:119] op_sel_hi:[1,0,1] neg_lo:[0,1,0] neg_hi:[0,1,0]
    ds_write_b64 v11, v[112:113] offset:38656
    v_pk_mul_f32 v[44:45], v[44:45], v[150:151] op_sel:[0,1] op_sel_hi:[1,1]
    v_pk_mul_f32 v[46:47], v[46:47], v[150:151] op_sel:[0,1] op_sel_hi:[1,1]
    v_pk_mul_f32 v[80:81], v[80:81], v[150:151] op_sel:[0,1] op_sel_hi:[1,1]
    v_pk_mul_f32 v[82:83], v[82:83], v[150:151] op_sel:[0,1] op_sel_hi:[1,1]
    v_pk_mul_f32 v[116:117], v[116:117], v[150:151] op_sel:[0,1] op_sel_hi:[1,1]
    v_pk_mul_f32 v[118:119], v[118:119], v[150:151] op_sel:[0,1] op_sel_hi:[1,1]
    v_cvt_pk_bf16_f32 v44, v44, v45
    v_cvt_pk_bf16_f32 v45, v46, v47
    v_cvt_pk_bf16_f32 v80, v80, v81
    v_cvt_pk_bf16_f32 v81, v82, v83
    v_cvt_pk_bf16_f32 v116, v116, v117
    v_cvt_pk_bf16_f32 v117, v118, v119
    v_pk_fma_f32 v[48:49], v[124:125], v[152:153], v[48:49] op_sel_hi:[1,0,1] neg_lo:[0,1,0] neg_hi:[0,1,0]
    v_pk_fma_f32 v[50:51], v[126:127], v[152:153], v[50:51] op_sel_hi:[1,0,1] neg_lo:[0,1,0] neg_hi:[0,1,0]
    ds_write_b64 v11, v[44:45] offset:44800
    v_pk_fma_f32 v[84:85], v[128:129], v[152:153], v[84:85] op_sel_hi:[1,0,1] neg_lo:[0,1,0] neg_hi:[0,1,0]
    v_pk_fma_f32 v[86:87], v[130:131], v[152:153], v[86:87] op_sel_hi:[1,0,1] neg_lo:[0,1,0] neg_hi:[0,1,0]
    ds_write_b64 v11, v[80:81] offset:44928
    v_pk_fma_f32 v[120:121], v[132:133], v[152:153], v[120:121] op_sel_hi:[1,0,1] neg_lo:[0,1,0] neg_hi:[0,1,0]
    v_pk_fma_f32 v[122:123], v[134:135], v[152:153], v[122:123] op_sel_hi:[1,0,1] neg_lo:[0,1,0] neg_hi:[0,1,0]
    ds_write_b64 v11, v[116:117] offset:45056
    v_pk_mul_f32 v[48:49], v[48:49], v[152:153] op_sel:[0,1] op_sel_hi:[1,1]
    v_pk_mul_f32 v[50:51], v[50:51], v[152:153] op_sel:[0,1] op_sel_hi:[1,1]
    v_pk_mul_f32 v[84:85], v[84:85], v[152:153] op_sel:[0,1] op_sel_hi:[1,1]
    v_pk_mul_f32 v[86:87], v[86:87], v[152:153] op_sel:[0,1] op_sel_hi:[1,1]
    v_pk_mul_f32 v[120:121], v[120:121], v[152:153] op_sel:[0,1] op_sel_hi:[1,1]
    v_pk_mul_f32 v[122:123], v[122:123], v[152:153] op_sel:[0,1] op_sel_hi:[1,1]
    v_cvt_pk_bf16_f32 v48, v48, v49
    v_cvt_pk_bf16_f32 v49, v50, v51
    v_cvt_pk_bf16_f32 v84, v84, v85
    v_cvt_pk_bf16_f32 v85, v86, v87
    v_cvt_pk_bf16_f32 v120, v120, v121
    v_cvt_pk_bf16_f32 v121, v122, v123
    ds_write_b64 v11, v[48:49] offset:51200
    ds_write_b64 v11, v[84:85] offset:51328
    ds_write_b64 v11, v[120:121] offset:51456
    s_branch P1_epi
P1_hk0:
    s_cmp_lg_u32 s58, 7
    s_cbranch_scc1 P1_hk0_0
    v_and_b32 v3, 7, v0
    v_lshlrev_b32 v3, 3, v3
    v_add_u32 v4, 130176, v3
    ds_read_b64 v[6:7], v4
    s_branch P1_hk0_ret
P1_hk0_0:
    s_lshl_b32 s61, s4, 4
    v_mov_b32 v3, s61
    v_mov_b32 v4, 1
    s_mov_b64 exec, 1
    s_waitcnt vmcnt(0)
    buffer_atomic_add v4, v3, s[36:39], 0 offen sc1
    s_mov_b64 exec, -1
    s_branch P1_hk0_ret
P1_hk1:
    s_lshl_b32 s61, s4, 10
    s_lshl_b32 s62, s5, 6
    s_add_u32 s61, s61, s62
    s_mov_b64 exec, 0xff
    buffer_store_dwordx2 v[6:7], v3, s[24:27], s61 offen sc1
    s_mov_b64 exec, -1
    s_branch P1_hk1_ret
P1_ld:
    s_setprio 3
    v_lshrrev_b32 v243, 3, v0
    v_and_b32 v244, 7, v0
    v_lshrrev_b32 v245, 4, v0
    s_lshl_b32 s61, s4, 7
    s_lshl_b32 s80, s63, 3
    s_add_u32 s61, s61, s80
    v_add_u32 v246, s61, v243
    v_lshlrev_b32 v246, 11, v246
    s_and_b32 s82, s63, 1
    s_lshl_b32 s82, s82, 2
    v_xor_b32 v247, v244, v245
    v_xor_b32 v247, s82, v247
    v_lshl_add_u32 v240, v247, 4, v246
    v_add_u32 v246, s80, v243
    v_mul_u32_u24 v246, 6144, v246
    v_and_b32 v247, 2, v243
    v_xor_b32 v247, v244, v247
    v_xor_b32 v247, s82, v247
    v_lshl_add_u32 v241, v247, 4, v246
    s_lshl_b32 s61, s5, 7
    v_add_u32 v241, s61, v241
    s_lshl_b32 s61, s4, 7
    s_max_u32 s61, s61, 16
    s_sub_u32 s61, s61, 16
    s_lshl_b32 s81, s63, 2
    s_add_u32 s61, s61, s81
    v_add_u32 v246, s61, v243
    v_lshlrev_b32 v246, 11, v246
    s_lshl_b32 s81, s63, 1
    v_add_u32 v247, s81, v245
    v_xor_b32 v247, v244, v247
    v_and_b32 v247, 7, v247
    v_lshl_add_u32 v242, v247, 4, v246
    s_lshl_b32 s80, s63, 10
    s_lshl_b32 s81, s63, 9
    s_mov_b32 s82, 65536
    s_mov_b32 s83, 131072
    s_mov_b32 s84, 196608
    s_mov_b32 s85, 2048
    s_mov_b32 s86, 198656
    s_mov_b32 s87, 4096
    s_mov_b32 s88, 200704
    s_waitcnt lgkmcnt(0)
    s_mov_b32 s8, s40
    s_mov_b32 s9, s41
    s_mov_b32 s10, 4194304
    s_mov_b32 s11, 0x20000
    s_mov_b32 s12, s42
    s_mov_b32 s13, s43
    s_mov_b32 s14, 6291456
    s_mov_b32 s15, 0x20000
    s_lshl_b32 s61, s2, 2
    s_add_u32 s61, s61, s63
    s_mul_i32 s61, s61, 4096
    s_add_u32 s46, s40, s61
    s_addc_u32 s47, s41, 0
    s_load_dwordx2 s[78:79], s[46:47], 444
    s_load_dwordx2 s[78:79], s[46:47], 2492
    s_load_dwordx2 s[78:79], s[46:47], 572
    s_load_dwordx2 s[78:79], s[46:47], 2620
    s_load_dwordx2 s[78:79], s[46:47], 700
    s_load_dwordx2 s[78:79], s[46:47], 2748
    s_load_dwordx2 s[78:79], s[46:47], 828
    s_add_u32 m0, s80, 2048
    s_nop 0
    buffer_load_dwordx4 v240, s[8:11], 0 offen  lds
    s_add_u32 m0, s80, 6144
    s_nop 0
    buffer_load_dwordx4 v240, s[8:11], s82 offen  lds
    s_add_u32 m0, s80, 10240
    s_nop 0
    buffer_load_dwordx4 v240, s[8:11], s83 offen  lds
    s_add_u32 m0, s80, 14336
    s_nop 0
    buffer_load_dwordx4 v240, s[8:11], s84 offen  lds
    s_add_u32 m0, s81, 0
    s_mov_b32 exec_hi, 0
    buffer_load_dwordx4 v242, s[8:11], 0 offen  lds
    s_mov_b32 exec_hi, -1
    v_add_u32 v240, 128, v240
    v_add_u32 v242, 128, v242
    s_add_u32 m0, s80, 18432
    s_nop 0
    buffer_load_dwordx4 v241, s[12:15], 0 offen  lds
    s_add_u32 m0, s80, 22528
    s_nop 0
    buffer_load_dwordx4 v241, s[12:15], s84 offen  lds
    s_add_u32 m0, s80, 26624
    s_nop 0
    buffer_load_dwordx4 v241, s[12:15], s85 offen  lds
    s_add_u32 m0, s80, 30720
    s_nop 0
    buffer_load_dwordx4 v241, s[12:15], s86 offen  lds
    s_add_u32 m0, s80, 34816
    s_nop 0
    buffer_load_dwordx4 v241, s[12:15], s87 offen  lds
    s_add_u32 m0, s80, 38912
    s_nop 0
    buffer_load_dwordx4 v241, s[12:15], s88 offen  lds
    v_add_u32 v241, 0x60000, v241
    v_mov_b32 v4, 0x80000000
    s_mul_i32 s61, s2, 6144
    s_mul_i32 s62, s63, 1536
    s_add_u32 s61, s61, s62
    v_lshlrev_b32 v3, 7, v0
    v_add_u32 v3, s61, v3
    v_cmp_gt_u32 vcc, 12, v0
    v_mov_b32 v254, s76
    s_nop 0
    v_cndmask_b32 v13, v4, v3, vcc
    s_lshr_b32 s61, s2, 3
    s_lshl_b32 s61, s61, 3
    s_lshl_b32 s62, s63, 1
    s_add_u32 s61, s61, s62
    s_mul_i32 s61, s61, 6144
    s_lshl_b32 s62, s6, 10
    s_lshl_b32 s62, s62, 0
    s_add_u32 s61, s61, s62
    s_add_u32 s61, s61, -24192
    v_lshlrev_b32 v3, 11, v0
    v_add_u32 v3, s61, v3
    v_subrev_u32 v5, 12, v0
    v_cmp_gt_u32 vcc, 6, v5
    s_nop 1
    v_cndmask_b32 v13, v13, v3, vcc
    s_add_u32 m0, s80, 45056
    s_nop 0
    buffer_load_dwordx4 v240, s[8:11], 0 offen  lds
    s_add_u32 m0, s80, 49152
    s_nop 0
    buffer_load_dwordx4 v240, s[8:11], s82 offen  lds
    s_add_u32 m0, s80, 53248
    s_nop 0
    buffer_load_dwordx4 v240, s[8:11], s83 offen  lds
    s_add_u32 m0, s80, 57344
    s_nop 0
    buffer_load_dwordx4 v240, s[8:11], s84 offen  lds
    s_add_u32 m0, s81, 43008
    s_mov_b32 exec_hi, 0
    buffer_load_dwordx4 v242, s[8:11], 0 offen  lds
    s_mov_b32 exec_hi, -1
    v_add_u32 v240, 128, v240
    v_add_u32 v242, 128, v242
    s_add_u32 m0, s80, 61440
    s_nop 0
    buffer_load_dwordx4 v241, s[12:15], 0 offen  lds
    s_add_u32 m0, s80, 65536
    s_nop 0
    buffer_load_dwordx4 v241, s[12:15], s84 offen  lds
    s_add_u32 m0, s80, 69632
    s_nop 0
    buffer_load_dwordx4 v241, s[12:15], s85 offen  lds
    s_add_u32 m0, s80, 73728
    s_nop 0
    buffer_load_dwordx4 v241, s[12:15], s86 offen  lds
    s_add_u32 m0, s80, 77824
    s_nop 0
    buffer_load_dwordx4 v241, s[12:15], s87 offen  lds
    s_add_u32 m0, s80, 81920
    s_nop 0
    buffer_load_dwordx4 v241, s[12:15], s88 offen  lds
    v_add_u32 v241, 0x60000, v241
    s_mov_b32 s28, s42
    s_mov_b32 s29, s43
    s_mov_b32 s30, 6291456
    s_mov_b32 s31, 0x20000
    s_mov_b32 s61, 0
    buffer_load_dword v251, v13, s[28:31], s61 offen
    s_waitcnt vmcnt(12)
    s_barrier
    s_add_u32 m0, s80, 88064
    s_nop 0
    buffer_load_dwordx4 v240, s[8:11], 0 offen  lds
    s_add_u32 m0, s80, 92160
    s_nop 0
    buffer_load_dwordx4 v240, s[8:11], s82 offen  lds
    s_add_u32 m0, s80, 96256
    s_nop 0
    buffer_load_dwordx4 v240, s[8:11], s83 offen  lds
    s_add_u32 m0, s80, 100352
    s_nop 0
    buffer_load_dwordx4 v240, s[8:11], s84 offen  lds
    s_add_u32 m0, s81, 86016
    s_mov_b32 exec_hi, 0
    buffer_load_dwordx4 v242, s[8:11], 0 offen  lds
    s_mov_b32 exec_hi, -1
    v_add_u32 v240, 128, v240
    v_add_u32 v242, 128, v242
    s_add_u32 m0, s80, 104448
    s_nop 0
    buffer_load_dwordx4 v241, s[12:15], 0 offen  lds
    s_add_u32 m0, s80, 108544
    s_nop 0
    buffer_load_dwordx4 v241, s[12:15], s84 offen  lds
    s_add_u32 m0, s80, 112640
    s_nop 0
    buffer_load_dwordx4 v241, s[12:15], s85 offen  lds
    s_add_u32 m0, s80, 116736
    s_nop 0
    buffer_load_dwordx4 v241, s[12:15], s86 offen  lds
    s_add_u32 m0, s80, 120832
    s_nop 0
    buffer_load_dwordx4 v241, s[12:15], s87 offen  lds
    s_add_u32 m0, s80, 124928
    s_nop 0
    buffer_load_dwordx4 v241, s[12:15], s88 offen  lds
    v_add_u32 v241, 0x60000, v241
    s_add_u32 s32, s56, 44040192
    s_addc_u32 s33, s57, 0
    s_mov_b32 s34, 262144
    s_mov_b32 s35, 0x20000
    s_mov_b32 s36, s54
    s_mov_b32 s37, s55
    s_mov_b32 s38, 256
    s_mov_b32 s39, 0x20000
    s_add_u32 s24, s56, 42991616
    s_addc_u32 s25, s57, 0
    s_mov_b32 s26, 16384
    s_mov_b32 s27, 0x20000
    s_setprio 0
    s_load_dwordx2 s[78:79], s[46:47], 2876
    s_load_dwordx2 s[78:79], s[46:47], 956
    s_load_dwordx2 s[78:79], s[46:47], 3004
    s_load_dwordx2 s[78:79], s[46:47], 1084
    s_waitcnt vmcnt(12)
    s_barrier
    s_add_u32 m0, s80, 2048
    s_nop 0
    buffer_load_dwordx4 v240, s[8:11], 0 offen  lds
    s_add_u32 m0, s80, 6144
    s_nop 0
    buffer_load_dwordx4 v240, s[8:11], s82 offen  lds
    s_add_u32 m0, s80, 10240
    s_nop 0
    buffer_load_dwordx4 v240, s[8:11], s83 offen  lds
    s_add_u32 m0, s80, 14336
    s_nop 0
    buffer_load_dwordx4 v240, s[8:11], s84 offen  lds
    s_add_u32 m0, s81, 0
    s_mov_b32 exec_hi, 0
    buffer_load_dwordx4 v242, s[8:11], 0 offen  lds
    s_mov_b32 exec_hi, -1
    v_add_u32 v240, 128, v240
    v_add_u32 v242, 128, v242
    s_add_u32 m0, s80, 18432
    s_nop 0
    buffer_load_dwordx4 v241, s[12:15], 0 offen  lds
    s_add_u32 m0, s80, 22528
    s_nop 0
    buffer_load_dwordx4 v241, s[12:15], s84 offen  lds
    s_add_u32 m0, s80, 26624
    s_nop 0
    buffer_load_dwordx4 v241, s[12:15], s85 offen  lds
    s_add_u32 m0, s80, 30720
    s_nop 0
    buffer_load_dwordx4 v241, s[12:15], s86 offen  lds
    s_add_u32 m0, s80, 34816
    s_nop 0
    buffer_load_dwordx4 v241, s[12:15], s87 offen  lds
    s_add_u32 m0, s80, 38912
    s_nop 0
    buffer_load_dwordx4 v241, s[12:15], s88 offen  lds
    v_add_u32 v241, 0x60000, v241
    s_mov_b32 s28, s42
    s_mov_b32 s29, s43
    s_mov_b32 s30, 6291456
    s_mov_b32 s31, 0x20000
    s_mov_b32 s61, 1572864
    buffer_load_dword v251, v13, s[28:31], s61 offen
    s_load_dwordx2 s[78:79], s[46:47], 3132
    s_load_dwordx2 s[78:79], s[46:47], 1212
    s_load_dwordx2 s[78:79], s[46:47], 3260
    s_load_dwordx2 s[78:79], s[46:47], 1340
    s_load_dwordx2 s[78:79], s[46:47], 3388
    s_waitcnt vmcnt(12)
    s_barrier
    s_add_u32 m0, s80, 45056
    s_nop 0
    buffer_load_dwordx4 v240, s[8:11], 0 offen  lds
    s_add_u32 m0, s80, 49152
    s_nop 0
    buffer_load_dwordx4 v240, s[8:11], s82 offen  lds
    s_add_u32 m0, s80, 53248
    s_nop 0
    buffer_load_dwordx4 v240, s[8:11], s83 offen  lds
    s_add_u32 m0, s80, 57344
    s_nop 0
    buffer_load_dwordx4 v240, s[8:11], s84 offen  lds
    s_add_u32 m0, s81, 43008
    s_mov_b32 exec_hi, 0
    buffer_load_dwordx4 v242, s[8:11], 0 offen  lds
    s_mov_b32 exec_hi, -1
    v_add_u32 v240, 128, v240
    v_add_u32 v242, 128, v242
    s_add_u32 m0, s80, 61440
    s_nop 0
    buffer_load_dwordx4 v241, s[12:15], 0 offen  lds
    s_add_u32 m0, s80, 65536
    s_nop 0
    buffer_load_dwordx4 v241, s[12:15], s84 offen  lds
    s_add_u32 m0, s80, 69632
    s_nop 0
    buffer_load_dwordx4 v241, s[12:15], s85 offen  lds
    s_add_u32 m0, s80, 73728
    s_nop 0
    buffer_load_dwordx4 v241, s[12:15], s86 offen  lds
    s_add_u32 m0, s80, 77824
    s_nop 0
    buffer_load_dwordx4 v241, s[12:15], s87 offen  lds
    s_add_u32 m0, s80, 81920
    s_nop 0
    buffer_load_dwordx4 v241, s[12:15], s88 offen  lds
    v_add_u32 v241, 0x60000, v241
    s_mov_b32 s28, s40
    s_mov_b32 s29, s41
    s_mov_b32 s30, 4194304
    s_mov_b32 s31, 0x20000
    s_lshl_b32 s61, s4, 7
    s_lshl_b32 s62, s5, 3
    s_add_u32 s61, s61, s62
    s_lshl_b32 s62, s63, 1
    s_add_u32 s61, s61, s62
    v_lshrrev_b32 v3, 5, v0
    v_add_u32 v14, s61, v3
    v_lshlrev_b32 v3, 11, v14
    v_and_b32 v4, 31, v0
    v_lshl_add_u32 v3, v4, 4, v3
    buffer_load_dwordx4 v[16:19], v3, s[28:31], 0 offen offset:0
    buffer_load_dwordx4 v[20:23], v3, s[28:31], 0 offen offset:512
    buffer_load_dwordx4 v[24:27], v3, s[28:31], 0 offen offset:1024
    buffer_load_dwordx4 v[28:31], v3, s[28:31], 0 offen offset:1536
    s_load_dwordx2 s[78:79], s[46:47], 1468
    s_load_dwordx2 s[78:79], s[46:47], 3516
    s_load_dwordx2 s[78:79], s[46:47], 1596
    s_load_dwordx2 s[78:79], s[46:47], 3644
    s_load_dwordx2 s[78:79], s[46:47], 1724
    s_waitcnt vmcnt(16)
    s_barrier
    s_add_u32 m0, s80, 88064
    s_nop 0
    buffer_load_dwordx4 v240, s[8:11], 0 offen  lds
    s_add_u32 m0, s80, 92160
    s_nop 0
    buffer_load_dwordx4 v240, s[8:11], s82 offen  lds
    s_add_u32 m0, s80, 96256
    s_nop 0
    buffer_load_dwordx4 v240, s[8:11], s83 offen  lds
    s_add_u32 m0, s80, 100352
    s_nop 0
    buffer_load_dwordx4 v240, s[8:11], s84 offen  lds
    s_add_u32 m0, s81, 86016
    s_mov_b32 exec_hi, 0
    buffer_load_dwordx4 v242, s[8:11], 0 offen  lds
    s_mov_b32 exec_hi, -1
    v_add_u32 v240, 128, v240
    v_add_u32 v242, 128, v242
    s_add_u32 m0, s80, 104448
    s_nop 0
    buffer_load_dwordx4 v241, s[12:15], 0 offen  lds
    s_add_u32 m0, s80, 108544
    s_nop 0
    buffer_load_dwordx4 v241, s[12:15], s84 offen  lds
    s_add_u32 m0, s80, 112640
    s_nop 0
    buffer_load_dwordx4 v241, s[12:15], s85 offen  lds
    s_add_u32 m0, s80, 116736
    s_nop 0
    buffer_load_dwordx4 v241, s[12:15], s86 offen  lds
    s_add_u32 m0, s80, 120832
    s_nop 0
    buffer_load_dwordx4 v241, s[12:15], s87 offen  lds
    s_add_u32 m0, s80, 124928
    s_nop 0
    buffer_load_dwordx4 v241, s[12:15], s88 offen  lds
    v_add_u32 v241, 0x60000, v241
    s_waitcnt vmcnt(11)
    v_lshlrev_b32 v40, 16, v16
    v_and_b32 v41, 0xffff0000, v16
    v_pk_mul_f32 v[34:35], v[40:41], v[40:41]
    v_mov_b32 v32, v40
    v_mov_b32 v33, v41
    v_lshlrev_b32 v42, 16, v17
    v_and_b32 v43, 0xffff0000, v17
    v_pk_add_f32 v[32:33], v[32:33], v[42:43]
    v_pk_fma_f32 v[34:35], v[42:43], v[42:43], v[34:35]
    v_lshlrev_b32 v44, 16, v18
    v_and_b32 v45, 0xffff0000, v18
    v_pk_add_f32 v[32:33], v[32:33], v[44:45]
    v_pk_fma_f32 v[34:35], v[44:45], v[44:45], v[34:35]
    v_lshlrev_b32 v46, 16, v19
    v_and_b32 v47, 0xffff0000, v19
    v_pk_add_f32 v[32:33], v[32:33], v[46:47]
    v_pk_fma_f32 v[34:35], v[46:47], v[46:47], v[34:35]
    v_lshlrev_b32 v40, 16, v20
    v_and_b32 v41, 0xffff0000, v20
    v_pk_add_f32 v[32:33], v[32:33], v[40:41]
    v_pk_fma_f32 v[34:35], v[40:41], v[40:41], v[34:35]
    v_lshlrev_b32 v42, 16, v21
    v_and_b32 v43, 0xffff0000, v21
    v_pk_add_f32 v[32:33], v[32:33], v[42:43]
    v_pk_fma_f32 v[34:35], v[42:43], v[42:43], v[34:35]
    v_lshlrev_b32 v44, 16, v22
    v_and_b32 v45, 0xffff0000, v22
    v_pk_add_f32 v[32:33], v[32:33], v[44:45]
    v_pk_fma_f32 v[34:35], v[44:45], v[44:45], v[34:35]
    v_lshlrev_b32 v46, 16, v23
    v_and_b32 v47, 0xffff0000, v23
    v_pk_add_f32 v[32:33], v[32:33], v[46:47]
    v_pk_fma_f32 v[34:35], v[46:47], v[46:47], v[34:35]
    s_load_dwordx2 s[78:79], s[46:47], 3772
    s_load_dwordx2 s[78:79], s[46:47], 1852
    s_load_dwordx2 s[78:79], s[46:47], 3900
    s_load_dwordx2 s[78:79], s[46:47], 1980
    s_load_dwordx2 s[78:79], s[46:47], 4028
    s_barrier
    s_add_u32 m0, s80, 2048
    s_nop 0
    buffer_load_dwordx4 v240, s[8:11], 0 offen  lds
    s_add_u32 m0, s80, 6144
    s_nop 0
    buffer_load_dwordx4 v240, s[8:11], s82 offen  lds
    s_add_u32 m0, s80, 10240
    s_nop 0
    buffer_load_dwordx4 v240, s[8:11], s83 offen  lds
    s_add_u32 m0, s80, 14336
    s_nop 0
    buffer_load_dwordx4 v240, s[8:11], s84 offen  lds
    s_add_u32 m0, s81, 0
    s_mov_b32 exec_hi, 0
    buffer_load_dwordx4 v242, s[8:11], 0 offen  lds
    s_mov_b32 exec_hi, -1
    v_add_u32 v240, 128, v240
    v_add_u32 v242, 128, v242
    s_add_u32 m0, s80, 18432
    s_nop 0
    buffer_load_dwordx4 v241, s[12:15], 0 offen  lds
    s_add_u32 m0, s80, 22528
    s_nop 0
    buffer_load_dwordx4 v241, s[12:15], s84 offen  lds
    s_add_u32 m0, s80, 26624
    s_nop 0
    buffer_load_dwordx4 v241, s[12:15], s85 offen  lds
    s_add_u32 m0, s80, 30720
    s_nop 0
    buffer_load_dwordx4 v241, s[12:15], s86 offen  lds
    s_add_u32 m0, s80, 34816
    s_nop 0
    buffer_load_dwordx4 v241, s[12:15], s87 offen  lds
    s_add_u32 m0, s80, 38912
    s_nop 0
    buffer_load_dwordx4 v241, s[12:15], s88 offen  lds
    v_add_u32 v241, 0x60000, v241
    s_mov_b32 s28, s42
    s_mov_b32 s29, s43
    s_mov_b32 s30, 6291456
    s_mov_b32 s31, 0x20000
    s_mov_b32 s61, 3145728
    buffer_load_dword v251, v13, s[28:31], s61 offen
    v_lshlrev_b32 v40, 16, v24
    v_and_b32 v41, 0xffff0000, v24
    v_pk_add_f32 v[32:33], v[32:33], v[40:41]
    v_pk_fma_f32 v[34:35], v[40:41], v[40:41], v[34:35]
    v_lshlrev_b32 v42, 16, v25
    v_and_b32 v43, 0xffff0000, v25
    v_pk_add_f32 v[32:33], v[32:33], v[42:43]
    v_pk_fma_f32 v[34:35], v[42:43], v[42:43], v[34:35]
    v_lshlrev_b32 v44, 16, v26
    v_and_b32 v45, 0xffff0000, v26
    v_pk_add_f32 v[32:33], v[32:33], v[44:45]
    v_pk_fma_f32 v[34:35], v[44:45], v[44:45], v[34:35]
    v_lshlrev_b32 v46, 16, v27
    v_and_b32 v47, 0xffff0000, v27
    v_pk_add_f32 v[32:33], v[32:33], v[46:47]
    v_pk_fma_f32 v[34:35], v[46:47], v[46:47], v[34:35]
    v_lshlrev_b32 v40, 16, v28
    v_and_b32 v41, 0xffff0000, v28
    v_pk_add_f32 v[32:33], v[32:33], v[40:41]
    v_pk_fma_f32 v[34:35], v[40:41], v[40:41], v[34:35]
    v_lshlrev_b32 v42, 16, v29
    v_and_b32 v43, 0xffff0000, v29
    v_pk_add_f32 v[32:33], v[32:33], v[42:43]
    v_pk_fma_f32 v[34:35], v[42:43], v[42:43], v[34:35]
    v_lshlrev_b32 v44, 16, v30
    v_and_b32 v45, 0xffff0000, v30
    v_pk_add_f32 v[32:33], v[32:33], v[44:45]
    v_pk_fma_f32 v[34:35], v[44:45], v[44:45], v[34:35]
    v_lshlrev_b32 v46, 16, v31
    v_and_b32 v47, 0xffff0000, v31
    v_pk_add_f32 v[32:33], v[32:33], v[46:47]
    v_pk_fma_f32 v[34:35], v[46:47], v[46:47], v[34:35]
    v_add_f32 v32, v32, v33
    s_waitcnt vmcnt(12)
    s_barrier
    s_add_u32 m0, s80, 45056
    s_nop 0
    buffer_load_dwordx4 v240, s[8:11], 0 offen  lds
    s_add_u32 m0, s80, 49152
    s_nop 0
    buffer_load_dwordx4 v240, s[8:11], s82 offen  lds
    s_add_u32 m0, s80, 53248
    s_nop 0
    buffer_load_dwordx4 v240, s[8:11], s83 offen  lds
    s_add_u32 m0, s80, 57344
    s_nop 0
    buffer_load_dwordx4 v240, s[8:11], s84 offen  lds
    s_add_u32 m0, s81, 43008
    s_mov_b32 exec_hi, 0
    buffer_load_dwordx4 v242, s[8:11], 0 offen  lds
    s_mov_b32 exec_hi, -1
    v_add_u32 v240, 128, v240
    v_add_u32 v242, 128, v242
    s_add_u32 m0, s80, 61440
    s_nop 0
    buffer_load_dwordx4 v241, s[12:15], 0 offen  lds
    s_add_u32 m0, s80, 65536
    s_nop 0
    buffer_load_dwordx4 v241, s[12:15], s84 offen  lds
    s_add_u32 m0, s80, 69632
    s_nop 0
    buffer_load_dwordx4 v241, s[12:15], s85 offen  lds
    s_add_u32 m0, s80, 73728
    s_nop 0
    buffer_load_dwordx4 v241, s[12:15], s86 offen  lds
    s_add_u32 m0, s80, 77824
    s_nop 0
    buffer_load_dwordx4 v241, s[12:15], s87 offen  lds
    s_add_u32 m0, s80, 81920
    s_nop 0
    buffer_load_dwordx4 v241, s[12:15], s88 offen  lds
    v_add_u32 v241, 0x60000, v241
    v_add_f32 v33, v34, v35
    s_nop 1
    v_add_f32_dpp v32, v32, v32 quad_perm:[1,0,3,2] row_mask:0xf bank_mask:0xf
    v_add_f32_dpp v33, v33, v33 quad_perm:[1,0,3,2] row_mask:0xf bank_mask:0xf
    s_nop 1
    v_add_f32_dpp v32, v32, v32 quad_perm:[2,3,0,1] row_mask:0xf bank_mask:0xf
    v_add_f32_dpp v33, v33, v33 quad_perm:[2,3,0,1] row_mask:0xf bank_mask:0xf
    s_nop 1
    v_add_f32_dpp v32, v32, v32 row_half_mirror row_mask:0xf bank_mask:0xf
    v_add_f32_dpp v33, v33, v33 row_half_mirror row_mask:0xf bank_mask:0xf
    s_nop 1
    v_add_f32_dpp v32, v32, v32 row_mirror row_mask:0xf bank_mask:0xf
    v_add_f32_dpp v33, v33, v33 row_mirror row_mask:0xf bank_mask:0xf
    v_mov_b32 v34, v32
    v_mov_b32 v35, v33
    s_nop 1
    v_permlane16_swap_b32 v32, v34
    v_permlane16_swap_b32 v33, v35
    s_nop 1
    v_add_f32 v32, v32, v34
    v_add_f32 v33, v33, v35
    v_mul_f32 v36, 0x3a800000, v32
    v_mul_f32 v38, v36, v36
    v_mov_b32 v39, 0x3a800000
    v_fma_f32 v37, v33, v39, -v38
    v_max_f32 v37, 0, v37
    v_add_f32 v37, 0x3727c5ac, v37
    v_rsq_f32 v37, v37
    v_and_b32 v40, 7, v14
    v_lshlrev_b32 v40, 3, v40
    v_add_u32 v40, 130176, v40
    ds_write_b64 v40, v[36:37] offset:0
    s_waitcnt vmcnt(12)
    s_waitcnt lgkmcnt(0)
    s_barrier
    s_add_u32 m0, s80, 88064
    s_nop 0
    buffer_load_dwordx4 v240, s[8:11], 0 offen  lds
    s_add_u32 m0, s80, 92160
    s_nop 0
    buffer_load_dwordx4 v240, s[8:11], s82 offen  lds
    s_add_u32 m0, s80, 96256
    s_nop 0
    buffer_load_dwordx4 v240, s[8:11], s83 offen  lds
    s_add_u32 m0, s80, 100352
    s_nop 0
    buffer_load_dwordx4 v240, s[8:11], s84 offen  lds
    s_add_u32 m0, s81, 86016
    s_mov_b32 exec_hi, 0
    buffer_load_dwordx4 v242, s[8:11], 0 offen  lds
    s_mov_b32 exec_hi, -1
    v_add_u32 v240, 128, v240
    v_add_u32 v242, 128, v242
    s_add_u32 m0, s80, 104448
    s_nop 0
    buffer_load_dwordx4 v241, s[12:15], 0 offen  lds
    s_add_u32 m0, s80, 108544
    s_nop 0
    buffer_load_dwordx4 v241, s[12:15], s84 offen  lds
    s_add_u32 m0, s80, 112640
    s_nop 0
    buffer_load_dwordx4 v241, s[12:15], s85 offen  lds
    s_add_u32 m0, s80, 116736
    s_nop 0
    buffer_load_dwordx4 v241, s[12:15], s86 offen  lds
    s_add_u32 m0, s80, 120832
    s_nop 0
    buffer_load_dwordx4 v241, s[12:15], s87 offen  lds
    s_add_u32 m0, s80, 124928
    s_nop 0
    buffer_load_dwordx4 v241, s[12:15], s88 offen  lds
    v_add_u32 v241, 0x60000, v241
    s_lshl_b32 s61, s2, 2
    s_add_u32 s61, s61, s63
    s_mul_i32 s61, s61, 512
    s_add_u32 s46, s44, s61
    s_addc_u32 s47, s45, 0
    s_load_dwordx2 s[78:79], s[46:47], 60
    s_load_dwordx2 s[78:79], s[46:47], 188
    s_load_dwordx2 s[78:79], s[46:47], 316
    s_load_dwordx2 s[78:79], s[46:47], 444
    s_waitcnt vmcnt(11)
    s_barrier
    s_add_u32 m0, s80, 2048
    s_nop 0
    buffer_load_dwordx4 v240, s[8:11], 0 offen  lds
    s_add_u32 m0, s80, 6144
    s_nop 0
    buffer_load_dwordx4 v240, s[8:11], s82 offen  lds
    s_add_u32 m0, s80, 10240
    s_nop 0
    buffer_load_dwordx4 v240, s[8:11], s83 offen  lds
    s_add_u32 m0, s80, 14336
    s_nop 0
    buffer_load_dwordx4 v240, s[8:11], s84 offen  lds
    s_add_u32 m0, s81, 0
    s_mov_b32 exec_hi, 0
    buffer_load_dwordx4 v242, s[8:11], 0 offen  lds
    s_mov_b32 exec_hi, -1
    v_add_u32 v240, 128, v240
    v_add_u32 v242, 128, v242
    s_add_u32 m0, s80, 18432
    s_nop 0
    buffer_load_dwordx4 v241, s[12:15], 0 offen  lds
    s_add_u32 m0, s80, 22528
    s_nop 0
    buffer_load_dwordx4 v241, s[12:15], s84 offen  lds
    s_add_u32 m0, s80, 26624
    s_nop 0
    buffer_load_dwordx4 v241, s[12:15], s85 offen  lds
    s_add_u32 m0, s80, 30720
    s_nop 0
    buffer_load_dwordx4 v241, s[12:15], s86 offen  lds
    s_add_u32 m0, s80, 34816
    s_nop 0
    buffer_load_dwordx4 v241, s[12:15], s87 offen  lds
    s_add_u32 m0, s80, 38912
    s_nop 0
    buffer_load_dwordx4 v241, s[12:15], s88 offen  lds
    v_add_u32 v241, 0x60000, v241
    s_mov_b32 s28, s42
    s_mov_b32 s29, s43
    s_mov_b32 s30, 6291456
    s_mov_b32 s31, 0x20000
    s_mov_b32 s61, 4718592
    buffer_load_dword v251, v13, s[28:31], s61 offen
    s_load_dwordx2 s[78:79], s[46:47], 524348
    s_load_dwordx2 s[78:79], s[46:47], 524476
    s_load_dwordx2 s[78:79], s[46:47], 524604
    s_load_dwordx2 s[78:79], s[46:47], 524732
    s_waitcnt vmcnt(12)
    s_barrier
    s_add_u32 m0, s80, 45056
    s_nop 0
    buffer_load_dwordx4 v240, s[8:11], 0 offen  lds
    s_add_u32 m0, s80, 49152
    s_nop 0
    buffer_load_dwordx4 v240, s[8:11], s82 offen  lds
    s_add_u32 m0, s80, 53248
    s_nop 0
    buffer_load_dwordx4 v240, s[8:11], s83 offen  lds
    s_add_u32 m0, s80, 57344
    s_nop 0
    buffer_load_dwordx4 v240, s[8:11], s84 offen  lds
    s_add_u32 m0, s81, 43008
    s_mov_b32 exec_hi, 0
    buffer_load_dwordx4 v242, s[8:11], 0 offen  lds
    s_mov_b32 exec_hi, -1
    v_add_u32 v240, 128, v240
    v_add_u32 v242, 128, v242
    s_add_u32 m0, s80, 61440
    s_nop 0
    buffer_load_dwordx4 v241, s[12:15], 0 offen  lds
    s_add_u32 m0, s80, 65536
    s_nop 0
    buffer_load_dwordx4 v241, s[12:15], s84 offen  lds
    s_add_u32 m0, s80, 69632
    s_nop 0
    buffer_load_dwordx4 v241, s[12:15], s85 offen  lds
    s_add_u32 m0, s80, 73728
    s_nop 0
    buffer_load_dwordx4 v241, s[12:15], s86 offen  lds
    s_add_u32 m0, s80, 77824
    s_nop 0
    buffer_load_dwordx4 v241, s[12:15], s87 offen  lds
    s_add_u32 m0, s80, 81920
    s_nop 0
    buffer_load_dwordx4 v241, s[12:15], s88 offen  lds
    v_add_u32 v241, 0x60000, v241
    s_mov_b32 s61, 1048636
    s_load_dwordx2 s[78:79], s[46:47], s61
    s_mov_b32 s61, 1048764
    s_load_dwordx2 s[78:79], s[46:47], s61
    s_mov_b32 s61, 1048892
    s_load_dwordx2 s[78:79], s[46:47], s61
    s_mov_b32 s61, 1049020
    s_load_dwordx2 s[78:79], s[46:47], s61
    s_waitcnt vmcnt(12)
    s_barrier
    s_add_u32 m0, s80, 88064
    s_nop 0
    buffer_load_dwordx4 v240, s[8:11], 0 offen  lds
    s_add_u32 m0, s80, 92160
    s_nop 0
    buffer_load_dwordx4 v240, s[8:11], s82 offen  lds
    s_add_u32 m0, s80, 96256
    s_nop 0
    buffer_load_dwordx4 v240, s[8:11], s83 offen  lds
    s_add_u32 m0, s80, 100352
    s_nop 0
    buffer_load_dwordx4 v240, s[8:11], s84 offen  lds
    s_add_u32 m0, s81, 86016
    s_mov_b32 exec_hi, 0
    buffer_load_dwordx4 v242, s[8:11], 0 offen  lds
    s_mov_b32 exec_hi, -1
    v_add_u32 v240, 128, v240
    v_add_u32 v242, 128, v242
    s_add_u32 m0, s80, 104448
    s_nop 0
    buffer_load_dwordx4 v241, s[12:15], 0 offen  lds
    s_add_u32 m0, s80, 108544
    s_nop 0
    buffer_load_dwordx4 v241, s[12:15], s84 offen  lds
    s_add_u32 m0, s80, 112640
    s_nop 0
    buffer_load_dwordx4 v241, s[12:15], s85 offen  lds
    s_add_u32 m0, s80, 116736
    s_nop 0
    buffer_load_dwordx4 v241, s[12:15], s86 offen  lds
    s_add_u32 m0, s80, 120832
    s_nop 0
    buffer_load_dwordx4 v241, s[12:15], s87 offen  lds
    s_add_u32 m0, s80, 124928
    s_nop 0
    buffer_load_dwordx4 v241, s[12:15], s88 offen  lds
    v_add_u32 v241, 0x60000, v241
    s_mov_b32 s61, 1572924
    s_load_dwordx2 s[78:79], s[46:47], s61
    s_mov_b32 s61, 1573052
    s_load_dwordx2 s[78:79], s[46:47], s61
    s_mov_b32 s61, 1573180
    s_load_dwordx2 s[78:79], s[46:47], s61
    s_mov_b32 s61, 1573308
    s_load_dwordx2 s[78:79], s[46:47], s61
    s_waitcnt vmcnt(11)
    s_barrier
    s_add_u32 m0, s80, 2048
    s_nop 0
    buffer_load_dwordx4 v240, s[8:11], 0 offen  lds
    s_add_u32 m0, s80, 6144
    s_nop 0
    buffer_load_dwordx4 v240, s[8:11], s82 offen  lds
    s_add_u32 m0, s80, 10240
    s_nop 0
    buffer_load_dwordx4 v240, s[8:11], s83 offen  lds
    s_add_u32 m0, s80, 14336
    s_nop 0
    buffer_load_dwordx4 v240, s[8:11], s84 offen  lds
    s_add_u32 m0, s81, 0
    s_mov_b32 exec_hi, 0
    buffer_load_dwordx4 v242, s[8:11], 0 offen  lds
    s_mov_b32 exec_hi, -1
    v_add_u32 v240, 128, v240
    v_add_u32 v242, 128, v242
    s_add_u32 m0, s80, 18432
    s_nop 0
    buffer_load_dwordx4 v241, s[12:15], 0 offen  lds
    s_add_u32 m0, s80, 22528
    s_nop 0
    buffer_load_dwordx4 v241, s[12:15], s84 offen  lds
    s_add_u32 m0, s80, 26624
    s_nop 0
    buffer_load_dwordx4 v241, s[12:15], s85 offen  lds
    s_add_u32 m0, s80, 30720
    s_nop 0
    buffer_load_dwordx4 v241, s[12:15], s86 offen  lds
    s_add_u32 m0, s80, 34816
    s_nop 0
    buffer_load_dwordx4 v241, s[12:15], s87 offen  lds
    s_add_u32 m0, s80, 38912
    s_nop 0
    buffer_load_dwordx4 v241, s[12:15], s88 offen  lds
    v_add_u32 v241, 0x60000, v241
    s_lshl_b32 s61, s2, 2
    s_add_u32 s61, s61, s63
    s_mul_i32 s61, s61, 896
    s_add_u32 s46, s48, s61
    s_addc_u32 s47, s49, 0
    s_load_dwordx2 s[78:79], s[46:47], 60
    s_load_dwordx2 s[78:79], s[46:47], 188
    s_load_dwordx2 s[78:79], s[46:47], 316
    s_load_dwordx2 s[78:79], s[46:47], 444
    s_waitcnt vmcnt(11)
    s_barrier
    s_add_u32 m0, s80, 45056
    s_nop 0
    buffer_load_dwordx4 v240, s[8:11], 0 offen  lds
    s_add_u32 m0, s80, 49152
    s_nop 0
    buffer_load_dwordx4 v240, s[8:11], s82 offen  lds
    s_add_u32 m0, s80, 53248
    s_nop 0
    buffer_load_dwordx4 v240, s[8:11], s83 offen  lds
    s_add_u32 m0, s80, 57344
    s_nop 0
    buffer_load_dwordx4 v240, s[8:11], s84 offen  lds
    s_add_u32 m0, s81, 43008
    s_mov_b32 exec_hi, 0
    buffer_load_dwordx4 v242, s[8:11], 0 offen  lds
    s_mov_b32 exec_hi, -1
    v_add_u32 v240, 128, v240
    v_add_u32 v242, 128, v242
    s_add_u32 m0, s80, 61440
    s_nop 0
    buffer_load_dwordx4 v241, s[12:15], 0 offen  lds
    s_add_u32 m0, s80, 65536
    s_nop 0
    buffer_load_dwordx4 v241, s[12:15], s84 offen  lds
    s_add_u32 m0, s80, 69632
    s_nop 0
    buffer_load_dwordx4 v241, s[12:15], s85 offen  lds
    s_add_u32 m0, s80, 73728
    s_nop 0
    buffer_load_dwordx4 v241, s[12:15], s86 offen  lds
    s_add_u32 m0, s80, 77824
    s_nop 0
    buffer_load_dwordx4 v241, s[12:15], s87 offen  lds
    s_add_u32 m0, s80, 81920
    s_nop 0
    buffer_load_dwordx4 v241, s[12:15], s88 offen  lds
    v_add_u32 v241, 0x60000, v241
    s_load_dwordx2 s[78:79], s[46:47], 572
    s_load_dwordx2 s[78:79], s[46:47], 700
    s_load_dwordx2 s[78:79], s[46:47], 828
    s_load_dwordx2 s[78:79], s[46:47], 917564
    s_waitcnt vmcnt(11)
    s_barrier
    s_add_u32 m0, s80, 88064
    s_nop 0
    buffer_load_dwordx4 v240, s[8:11], 0 offen  lds
    s_add_u32 m0, s80, 92160
    s_nop 0
    buffer_load_dwordx4 v240, s[8:11], s82 offen  lds
    s_add_u32 m0, s80, 96256
    s_nop 0
    buffer_load_dwordx4 v240, s[8:11], s83 offen  lds
    s_add_u32 m0, s80, 100352
    s_nop 0
    buffer_load_dwordx4 v240, s[8:11], s84 offen  lds
    s_add_u32 m0, s81, 86016
    s_mov_b32 exec_hi, 0
    buffer_load_dwordx4 v242, s[8:11], 0 offen  lds
    s_mov_b32 exec_hi, -1
    v_add_u32 v240, 128, v240
    v_add_u32 v242, 128, v242
    s_add_u32 m0, s80, 104448
    s_nop 0
    buffer_load_dwordx4 v241, s[12:15], 0 offen  lds
    s_add_u32 m0, s80, 108544
    s_nop 0
    buffer_load_dwordx4 v241, s[12:15], s84 offen  lds
    s_add_u32 m0, s80, 112640
    s_nop 0
    buffer_load_dwordx4 v241, s[12:15], s85 offen  lds
    s_add_u32 m0, s80, 116736
    s_nop 0
    buffer_load_dwordx4 v241, s[12:15], s86 offen  lds
    s_add_u32 m0, s80, 120832
    s_nop 0
    buffer_load_dwordx4 v241, s[12:15], s87 offen  lds
    s_add_u32 m0, s80, 124928
    s_nop 0
    buffer_load_dwordx4 v241, s[12:15], s88 offen  lds
    v_add_u32 v241, 0x60000, v241
    s_load_dwordx2 s[78:79], s[46:47], 917692
    s_load_dwordx2 s[78:79], s[46:47], 917820
    s_load_dwordx2 s[78:79], s[46:47], 917948
    s_load_dwordx2 s[78:79], s[46:47], 918076
    s_waitcnt vmcnt(11)
    s_barrier
    s_add_u32 m0, s80, 2048
    s_nop 0
    buffer_load_dwordx4 v240, s[8:11], 0 offen  lds
    s_add_u32 m0, s80, 6144
    s_nop 0
    buffer_load_dwordx4 v240, s[8:11], s82 offen  lds
    s_add_u32 m0, s80, 10240
    s_nop 0
    buffer_load_dwordx4 v240, s[8:11], s83 offen  lds
    s_add_u32 m0, s80, 14336
    s_nop 0
    buffer_load_dwordx4 v240, s[8:11], s84 offen  lds
    s_add_u32 m0, s81, 0
    s_mov_b32 exec_hi, 0
    buffer_load_dwordx4 v242, s[8:11], 0 offen  lds
    s_mov_b32 exec_hi, -1
    v_add_u32 v240, 128, v240
    v_add_u32 v242, 128, v242
    s_add_u32 m0, s80, 18432
    s_nop 0
    buffer_load_dwordx4 v241, s[12:15], 0 offen  lds
    s_add_u32 m0, s80, 22528
    s_nop 0
    buffer_load_dwordx4 v241, s[12:15], s84 offen  lds
    s_add_u32 m0, s80, 26624
    s_nop 0
    buffer_load_dwordx4 v241, s[12:15], s85 offen  lds
    s_add_u32 m0, s80, 30720
    s_nop 0
    buffer_load_dwordx4 v241, s[12:15], s86 offen  lds
    s_add_u32 m0, s80, 34816
    s_nop 0
    buffer_load_dwordx4 v241, s[12:15], s87 offen  lds
    s_add_u32 m0, s80, 38912
    s_nop 0
    buffer_load_dwordx4 v241, s[12:15], s88 offen  lds
    v_add_u32 v241, 0x60000, v241
    s_load_dwordx2 s[78:79], s[46:47], 918204
    s_load_dwordx2 s[78:79], s[46:47], 918332
    s_mov_b32 s61, 1835068
    s_load_dwordx2 s[78:79], s[46:47], s61
    s_mov_b32 s61, 1835196
    s_load_dwordx2 s[78:79], s[46:47], s61
    s_waitcnt vmcnt(11)
    s_barrier
    s_mov_b32 s28, s44
    s_mov_b32 s29, s45
    s_mov_b32 s30, 2097152
    s_mov_b32 s31, 0x20000
    s_lshr_b32 s61, s2, 3
    s_lshl_b32 s61, s61, 5
    s_lshl_b32 s62, s63, 3
    s_add_u32 s61, s61, s62
    v_lshrrev_b32 v3, 3, v0
    v_add_u32 v3, s61, v3
    v_lshlrev_b32 v3, 11, v3
    v_and_b32 v4, 7, v0
    v_lshl_add_u32 v3, v4, 7, v3
    s_lshl_b32 s61, s6, 10
    buffer_load_dword v250, v3, s[28:31], s61 offen
    s_waitcnt vmcnt(1)
    s_barrier
    s_lshl_b32 s61, s4, 4
    v_mov_b32 v3, s61
    s_max_u32 s61, s61, 16
    s_sub_u32 s61, s61, 16
    v_mov_b32 v4, s61
    s_mov_b32 s58, 20000
Lpoll_4:
    buffer_load_dword v248, v3, s[36:39], 0 offen offset:0 sc1
    s_sub_u32 s58, s58, 1
    s_waitcnt vmcnt(0)
    v_readfirstlane_b32 s61, v248
    s_cmp_ge_u32 s61, 16
    s_cbranch_scc1 Lpok_5
    s_sleep 2
    s_cmp_lg_u32 s58, 0
    s_cbranch_scc1 Lpoll_4
Lpok_5:
    s_mov_b32 s58, 20000
Lpoll_6:
    buffer_load_dword v248, v4, s[36:39], 0 offen offset:0 sc1
    s_sub_u32 s58, s58, 1
    s_waitcnt vmcnt(0)
    v_readfirstlane_b32 s61, v248
    s_cmp_ge_u32 s61, 16
    s_cbranch_scc1 Lpok_7
    s_sleep 2
    s_cmp_lg_u32 s58, 0
    s_cbranch_scc1 Lpoll_6
Lpok_7:
    v_lshl_add_u32 v3, s63, 6, v0
    s_lshl_b32 s61, s4, 7
    s_sub_u32 s61, s61, 16
    v_add_u32 v4, s61, v3
    v_lshlrev_b32 v4, 3, v4
    buffer_load_dwordx2 v[6:7], v4, s[24:27], 0 offen sc1
    v_lshlrev_b32 v3, 3, v3
    v_add_u32 v3, 129024, v3
    v_cmp_gt_u32 vcc, 130176, v3
    s_waitcnt vmcnt(0)
    s_and_saveexec_b64 s[64:65], vcc
    ds_write_b64 v3, v[6:7]
    s_mov_b64 exec, s[64:65]
    s_waitcnt lgkmcnt(0)
    s_barrier
    v_lshrrev_b32 v243, 3, v0
    v_and_b32 v244, 7, v0
    v_lshrrev_b32 v245, 4, v0
    s_lshl_b32 s61, s4, 7
    s_lshl_b32 s80, s63, 3
    s_add_u32 s61, s61, s80
    v_add_u32 v246, s61, v243
    v_lshlrev_b32 v246, 12, v246
    s_and_b32 s82, s63, 1
    s_lshl_b32 s82, s82, 2
    v_xor_b32 v247, v244, v245
    v_xor_b32 v247, s82, v247
    v_lshl_add_u32 v240, v247, 4, v246
    v_add_u32 v246, s80, v243
    v_mul_u32_u24 v246, 2048, v246
    v_and_b32 v247, 2, v243
    v_xor_b32 v247, v244, v247
    v_xor_b32 v247, s82, v247
    v_lshl_add_u32 v241, v247, 4, v246
    s_lshl_b32 s61, s5, 7
    v_add_u32 v241, s61, v241
    s_lshl_b32 s80, s63, 10
    s_mov_b32 s81, 131072
    s_mov_b32 s82, 262144
    s_mov_b32 s83, 393216
    s_mov_b32 s84, 65536
    s_mov_b32 s8, s56
    s_mov_b32 s9, s57
    s_mov_b32 s10, 8388608
    s_mov_b32 s11, 0x20000
    s_mov_b32 s12, s44
    s_mov_b32 s13, s45
    s_mov_b32 s14, 2097152
    s_mov_b32 s15, 0x20000
    v_mov_b32 v236, v240
    v_mov_b32 v237, v241
    s_mov_b32 s61, s5
    s_mul_i32 s37, s61, 131072
    s_cmp_ge_u32 s61, 3
    s_addc_u32 s36, s61, 0
    s_cmp_ge_u32 s61, 10
    s_addc_u32 s61, s36, 0
    s_lshl_b32 s36, s61, 7
    v_add_u32 v241, s37, v237
    s_add_u32 m0, s80, 81920
    s_nop 0
    buffer_load_dwordx4 v241, s[12:15], 0 offen  lds
    s_add_u32 m0, s80, 86016
    s_nop 0
    buffer_load_dwordx4 v241, s[12:15], s84 offen  lds
P1_epi:
    s_mov_b32 s16, s56
    s_mov_b32 s17, s57
    s_mov_b32 s18, 8388608
    s_mov_b32 s19, 0x20000
    v_and_b32 v1, 15, v0
    v_lshrrev_b32 v2, 4, v0
    s_mul_i32 s61, s3, 6400
    v_mul_u32_u24 v3, 400, v1
    v_lshl_add_u32 v3, v2, 4, v3
    v_add_u32 v8, s61, v3
    v_lshrrev_b32 v3, 2, v1
    v_lshl_add_u32 v3, v2, 2, v3
    v_mul_u32_u24 v3, 400, v3
    v_and_b32 v4, 3, v1
    v_lshl_add_u32 v3, v4, 3, v3
    v_add_u32 v9, s61, v3
    v_lshlrev_b32 v3, 2, v2
    v_sub_u32 v3, v1, v3
    v_and_b32 v4, 1, v1
    v_sub_u32 v3, v3, v4
    v_cmp_le_i32 s[66:67], 0, v3
    v_cmp_le_i32 s[68:69], 2, v3
    v_cmp_eq_u32 s[70:71], 1, v4
    v_mov_b32 v5, 0xffff
    v_mov_b32 v6, 0xffff0000
    v_cndmask_b32 v5, v5, v6, s[70:71]
    v_mov_b32 v6, 0
    v_cndmask_b32 v10, v5, v6, s[66:67]
    v_cndmask_b32 v11, v5, v6, s[68:69]
    v_cndmask_b32 v12, v6, v5, s[66:67]
    v_cndmask_b32 v13, v6, v5, s[68:69]
    s_or_b32 s62, s4, s3
    s_cmp_eq_u32 s62, 0
    s_cselect_b32 s62, 0xf149f2ca, 0
    v_mov_b32 v7, s62
    v_cndmask_b32 v14, v7, v6, s[66:67]
    v_cndmask_b32 v15, v7, v6, s[68:69]
    s_lshl_b32 s62, s4, 7
    s_lshl_b32 s61, s3, 4
    s_add_u32 s61, s61, s62
    v_and_b32 v3, 7, v1
    v_add_u32 v3, s61, v3
    v_lshlrev_b32 v3, 12, v3
    v_and_b32 v4, 1, v2
    v_lshl_add_u32 v3, v4, 5, v3
    v_lshrrev_b32 v4, 1, v2
    v_lshl_add_u32 v3, v4, 4, v3
    v_and_b32 v4, 8, v1
    v_lshl_add_u32 v3, v4, 3, v3
    v_add_u32 v16, s77, v3
    v_xor_b32 v17, 64, v16
    v_add_u32 v17, 32768, v17
    s_mov_b32 s61, 0x3e8293ee
    s_waitcnt lgkmcnt(0)
    s_barrier
    ds_read_b128 v[20:23], v8 offset:6400
    ds_read_b128 v[24:27], v8 offset:128
    ds_read_b128 v[28:31], v8 offset:6528
    ds_read_b128 v[80:83], v8 offset:6464
    ds_read_b128 v[84:87], v8 offset:192
    ds_read_b128 v[88:91], v8 offset:6592
    ds_read_b64_tr_b16 v[32:33], v9 offset:256
    ds_read_b64_tr_b16 v[34:35], v9 offset:6656
    ds_read_b64_tr_b16 v[36:37], v9 offset:288
    ds_read_b64_tr_b16 v[38:39], v9 offset:6688
    ds_read_b64_tr_b16 v[92:93], v9 offset:320
    ds_read_b64_tr_b16 v[94:95], v9 offset:6720
    ds_read_b64_tr_b16 v[96:97], v9 offset:352
    ds_read_b64_tr_b16 v[98:99], v9 offset:6752
    s_waitcnt lgkmcnt(11)
    v_mfma_f32_16x16x32_bf16 v[40:43], v[24:27], v[20:23], 0
    v_mfma_f32_16x16x32_bf16 v[44:47], v[28:31], v[20:23], 0
    s_waitcnt lgkmcnt(8)
    v_mfma_f32_16x16x32_bf16 v[100:103], v[84:87], v[80:83], 0
    v_mfma_f32_16x16x32_bf16 v[104:107], v[88:91], v[80:83], 0
    s_nop 7
    v_cndmask_b32 v48, v40, v41, s[70:71]
    v_cndmask_b32 v49, v42, v43, s[70:71]
    v_cndmask_b32 v50, v44, v45, s[70:71]
    v_cndmask_b32 v51, v46, v47, s[70:71]
    v_cndmask_b32 v48, v48, v50, s[66:67]
    v_cndmask_b32 v49, v49, v51, s[68:69]
    v_add_f32 v48, v48, v14
    v_add_f32 v49, v49, v15
    v_max_f32 v50, v48, v49
    v_cndmask_b32 v108, v100, v101, s[70:71]
    v_cndmask_b32 v109, v102, v103, s[70:71]
    v_cndmask_b32 v110, v104, v105, s[70:71]
    v_cndmask_b32 v111, v106, v107, s[70:71]
    v_cndmask_b32 v108, v108, v110, s[66:67]
    v_cndmask_b32 v109, v109, v111, s[68:69]
    v_add_f32 v108, v108, v14
    v_add_f32 v109, v109, v15
    v_max_f32 v110, v108, v109
    v_mov_b32 v51, v50
    v_mov_b32 v111, v110
    s_nop 1
    v_permlane32_swap_b32 v50, v51
    v_permlane32_swap_b32 v110, v111
    s_nop 1
    v_max_f32 v50, v50, v51
    v_max_f32 v110, v110, v111
    v_mov_b32 v51, v50
    v_mov_b32 v111, v110
    s_nop 1
    v_permlane16_swap_b32 v50, v51
    v_permlane16_swap_b32 v110, v111
    s_nop 1
    v_max_f32 v50, v50, v51
    v_max_f32 v110, v110, v111
    v_sub_f32 v48, v48, v50
    v_sub_f32 v49, v49, v50
    v_mul_f32 v48, s61, v48
    v_mul_f32 v49, s61, v49
    v_exp_f32 v48, v48
    v_exp_f32 v49, v49
    v_sub_f32 v108, v108, v110
    v_sub_f32 v109, v109, v110
    v_mul_f32 v108, s61, v108
    v_mul_f32 v109, s61, v109
    v_exp_f32 v108, v108
    v_exp_f32 v109, v109
    s_nop 0
    v_add_f32 v50, v48, v49
    v_add_f32 v110, v108, v109
    v_mov_b32 v51, v50
    v_mov_b32 v111, v110
    s_nop 1
    v_permlane32_swap_b32 v50, v51
    v_permlane32_swap_b32 v110, v111
    s_nop 1
    v_add_f32 v50, v50, v51
    v_add_f32 v110, v110, v111
    v_mov_b32 v51, v50
    v_mov_b32 v111, v110
    s_nop 1
    v_permlane16_swap_b32 v50, v51
    v_permlane16_swap_b32 v110, v111
    s_nop 1
    v_add_f32 v50, v50, v51
    v_add_f32 v110, v110, v111
    v_rcp_f32 v50, v50
    v_rcp_f32 v110, v110
    s_nop 0
    v_mul_f32 v48, v48, v50
    v_mul_f32 v49, v49, v50
    v_cvt_pk_bf16_f32 v48, v48, v48
    v_cvt_pk_bf16_f32 v49, v49, v49
    v_and_b32 v52, v10, v48
    v_and_b32 v53, v11, v49
    v_and_b32 v54, v12, v48
    v_and_b32 v55, v13, v49
    v_mul_f32 v108, v108, v110
    v_mul_f32 v109, v109, v110
    v_cvt_pk_bf16_f32 v108, v108, v108
    v_cvt_pk_bf16_f32 v109, v109, v109
    v_and_b32 v112, v10, v108
    v_and_b32 v113, v11, v109
    v_and_b32 v114, v12, v108
    v_and_b32 v115, v13, v109
    s_waitcnt lgkmcnt(0)
    s_nop 0
    v_mfma_f32_16x16x32_bf16 v[56:59], v[32:35], v[52:55], 0
    v_mfma_f32_16x16x32_bf16 v[60:63], v[36:39], v[52:55], 0
    v_mfma_f32_16x16x32_bf16 v[116:119], v[92:95], v[112:115], 0
    v_mfma_f32_16x16x32_bf16 v[120:123], v[96:99], v[112:115], 0
    s_nop 7
    v_cvt_pk_bf16_f32 v64, v56, v57
    v_cvt_pk_bf16_f32 v65, v58, v59
    v_cvt_pk_bf16_f32 v66, v60, v61
    v_cvt_pk_bf16_f32 v67, v62, v63
    v_cvt_pk_bf16_f32 v124, v116, v117
    v_cvt_pk_bf16_f32 v125, v118, v119
    v_cvt_pk_bf16_f32 v126, v120, v121
    v_cvt_pk_bf16_f32 v127, v122, v123
    s_nop 1
    v_permlane16_swap_b32 v64, v66
    v_permlane16_swap_b32 v65, v67
    v_permlane16_swap_b32 v124, v126
    v_permlane16_swap_b32 v125, v127
    v_mov_b32 v68, v64
    v_mov_b32 v69, v65
    v_mov_b32 v70, v66
    v_mov_b32 v71, v67
    v_mov_b32_dpp v64, v124 row_ror:8 row_mask:0xf bank_mask:0xc
    v_mov_b32_dpp v65, v125 row_ror:8 row_mask:0xf bank_mask:0xc
    v_mov_b32_dpp v66, v126 row_ror:8 row_mask:0xf bank_mask:0xc
    v_mov_b32_dpp v67, v127 row_ror:8 row_mask:0xf bank_mask:0xc
    v_mov_b32_dpp v68, v124 row_ror:8 row_mask:0xf bank_mask:0x3
    v_mov_b32_dpp v69, v125 row_ror:8 row_mask:0xf bank_mask:0x3
    v_mov_b32_dpp v70, v126 row_ror:8 row_mask:0xf bank_mask:0x3
    v_mov_b32_dpp v71, v127 row_ror:8 row_mask:0xf bank_mask:0x3
    buffer_store_dwordx4 v[64:67], v16, s[16:19], 0 offen sc1
    buffer_store_dwordx4 v[68:71], v17, s[16:19], 0 offen sc1
    s_waitcnt vmcnt(0)
    s_barrier
    s_cmp_lg_u32 s3, 0
    s_cbranch_scc1 Lsg_8
    s_mov_b32 s62, s76
    s_lshl_b32 s61, s5, 2
    s_add_u32 s61, s61, s62
    v_mov_b32 v1, 1
    v_mov_b32 v2, s61
    s_mov_b64 exec, 1
    buffer_store_dword v1, v2, s[32:35], 0 offen offset:0 sc1
    s_mov_b64 exec, -1
Lsg_8:
    s_cmp_ge_u32 s3, 4
    s_cbranch_scc1 P2_ld
    s_and_b32 s61, s3, 1
    s_lshl_b32 s61, s61, 13
    v_and_b32 v1, 15, v0
    v_lshrrev_b32 v2, 4, v0
    v_lshrrev_b32 v3, 1, v1
    v_xor_b32 v3, v2, v3
    v_lshlrev_b32 v4, 7, v1
    v_lshl_add_u32 v10, v3, 4, v4
    v_add_u32 v10, s61, v10
    v_xor_b32 v11, 64, v10
    v_add_u32 v10, 65536, v10
    v_add_u32 v11, 65536, v11
    v_lshrrev_b32 v3, 2, v1
    v_lshlrev_b32 v3, 7, v3
    v_lshl_add_u32 v3, v2, 10, v3
    v_and_b32 v4, 3, v1
    v_lshl_add_u32 v5, v4, 3, v3
    v_add_u32 v5, 81920, v5
    v_lshrrev_b32 v3, 3, v1
    v_and_b32 v4, 1, v2
    v_lshl_add_u32 v6, v4, 1, v3
    s_lshr_b32 s61, s3, 1
    s_lshl_b32 s61, s61, 1
    v_xor_b32 v7, s61, v6
    v_lshl_add_u32 v12, v7, 5, v5
    v_xor_b32 v13, 32, v12
    s_and_b32 s62, s3, 1
    s_mul_i32 s62, s62, 17408
    s_lshl_b32 s61, s61, 6
    s_add_u32 s61, s61, s62
    v_mul_u32_u24 v7, 272, v1
    v_lshl_add_u32 v7, v2, 4, v7
    v_add_u32 v14, s61, v7
    v_mov_b32 v16, 0
    v_mov_b32 v17, 0
    v_mov_b32 v18, 0
    v_mov_b32 v19, 0
    v_mov_b32 v20, 0
    v_mov_b32 v21, 0
    v_mov_b32 v22, 0
    v_mov_b32 v23, 0
    v_mov_b32 v24, 0
    v_mov_b32 v25, 0
    v_mov_b32 v26, 0
    v_mov_b32 v27, 0
    v_mov_b32 v28, 0
    v_mov_b32 v29, 0
    v_mov_b32 v30, 0
    v_mov_b32 v31, 0
    v_mov_b32 v32, 0
    v_mov_b32 v33, 0
    v_mov_b32 v34, 0
    v_mov_b32 v35, 0
    v_mov_b32 v36, 0
    v_mov_b32 v37, 0
    v_mov_b32 v38, 0
    v_mov_b32 v39, 0
    v_mov_b32 v40, 0
    v_mov_b32 v41, 0
    v_mov_b32 v42, 0
    v_mov_b32 v43, 0
    v_mov_b32 v44, 0
    v_mov_b32 v45, 0
    v_mov_b32 v46, 0
    v_mov_b32 v47, 0
    v_add_u32 v100, 73728, v10
    v_add_u32 v101, 73728, v11
    v_add_u32 v102, 73728, v12
    v_add_u32 v103, 73728, v13
    s_mov_b32 s58, 0
    s_barrier
    ds_read_b64_tr_b16 v[64:65], v12 offset:0
    ds_read_b64_tr_b16 v[66:67], v12 offset:512
    ds_read_b128 v[48:51], v10 offset:0
    ds_read_b128 v[52:55], v10 offset:2048
    ds_read_b128 v[56:59], v10 offset:4096
    ds_read_b128 v[60:63], v10 offset:6144
    ds_read_b64_tr_b16 v[68:69], v13 offset:0
    ds_read_b64_tr_b16 v[70:71], v13 offset:512
    s_waitcnt lgkmcnt(0)
Lcl_9:
    v_mfma_f32_16x16x32_bf16 v[16:19], v[64:67], v[48:51], v[16:19]
    ds_read_b64_tr_b16 v[88:89], v12 offset:4096
    ds_read_b64_tr_b16 v[90:91], v12 offset:4608
    v_mfma_f32_16x16x32_bf16 v[20:23], v[64:67], v[52:55], v[20:23]
    ds_read_b128 v[72:75], v11 offset:0
    v_mfma_f32_16x16x32_bf16 v[24:27], v[64:67], v[56:59], v[24:27]
    ds_read_b128 v[76:79], v11 offset:2048
    v_mfma_f32_16x16x32_bf16 v[28:31], v[64:67], v[60:63], v[28:31]
    ds_read_b128 v[80:83], v11 offset:4096
    ds_read_b128 v[84:87], v11 offset:6144
    v_mfma_f32_16x16x32_bf16 v[32:35], v[68:71], v[48:51], v[32:35]
    ds_read_b64_tr_b16 v[92:93], v13 offset:4096
    v_mfma_f32_16x16x32_bf16 v[36:39], v[68:71], v[52:55], v[36:39]
    ds_read_b64_tr_b16 v[94:95], v13 offset:4608
    v_mfma_f32_16x16x32_bf16 v[40:43], v[68:71], v[56:59], v[40:43]
    s_add_u32 s58, s58, 1
    v_mfma_f32_16x16x32_bf16 v[44:47], v[68:71], v[60:63], v[44:47]
    s_waitcnt lgkmcnt(0)
    s_barrier
    v_mfma_f32_16x16x32_bf16 v[16:19], v[88:91], v[72:75], v[16:19]
    ds_read_b64_tr_b16 v[64:65], v12 offset:24576
    ds_read_b64_tr_b16 v[66:67], v12 offset:25088
    v_mfma_f32_16x16x32_bf16 v[20:23], v[88:91], v[76:79], v[20:23]
    ds_read_b128 v[48:51], v10 offset:24576
    v_mfma_f32_16x16x32_bf16 v[24:27], v[88:91], v[80:83], v[24:27]
    ds_read_b128 v[52:55], v10 offset:26624
    v_mfma_f32_16x16x32_bf16 v[28:31], v[88:91], v[84:87], v[28:31]
    ds_read_b128 v[56:59], v10 offset:28672
    ds_read_b128 v[60:63], v10 offset:30720
    v_mfma_f32_16x16x32_bf16 v[32:35], v[92:95], v[72:75], v[32:35]
    ds_read_b64_tr_b16 v[68:69], v13 offset:24576
    v_mfma_f32_16x16x32_bf16 v[36:39], v[92:95], v[76:79], v[36:39]
    ds_read_b64_tr_b16 v[70:71], v13 offset:25088
    v_mfma_f32_16x16x32_bf16 v[40:43], v[92:95], v[80:83], v[40:43]
    v_mfma_f32_16x16x32_bf16 v[44:47], v[92:95], v[84:87], v[44:47]
    s_waitcnt lgkmcnt(0)
    v_mfma_f32_16x16x32_bf16 v[16:19], v[64:67], v[48:51], v[16:19]
    ds_read_b64_tr_b16 v[88:89], v12 offset:28672
    ds_read_b64_tr_b16 v[90:91], v12 offset:29184
    v_mfma_f32_16x16x32_bf16 v[20:23], v[64:67], v[52:55], v[20:23]
    ds_read_b128 v[72:75], v11 offset:24576
    v_mfma_f32_16x16x32_bf16 v[24:27], v[64:67], v[56:59], v[24:27]
    ds_read_b128 v[76:79], v11 offset:26624
    v_mfma_f32_16x16x32_bf16 v[28:31], v[64:67], v[60:63], v[28:31]
    ds_read_b128 v[80:83], v11 offset:28672
    ds_read_b128 v[84:87], v11 offset:30720
    v_mfma_f32_16x16x32_bf16 v[32:35], v[68:71], v[48:51], v[32:35]
    ds_read_b64_tr_b16 v[92:93], v13 offset:28672
    v_mfma_f32_16x16x32_bf16 v[36:39], v[68:71], v[52:55], v[36:39]
    ds_read_b64_tr_b16 v[94:95], v13 offset:29184
    v_mfma_f32_16x16x32_bf16 v[40:43], v[68:71], v[56:59], v[40:43]
    s_add_u32 s58, s58, 1
    v_mfma_f32_16x16x32_bf16 v[44:47], v[68:71], v[60:63], v[44:47]
    s_waitcnt lgkmcnt(0)
    s_barrier
    v_mfma_f32_16x16x32_bf16 v[16:19], v[88:91], v[72:75], v[16:19]
    ds_read_b64_tr_b16 v[64:65], v12 offset:49152
    ds_read_b64_tr_b16 v[66:67], v12 offset:49664
    v_mfma_f32_16x16x32_bf16 v[20:23], v[88:91], v[76:79], v[20:23]
    ds_read_b128 v[48:51], v10 offset:49152
    v_mfma_f32_16x16x32_bf16 v[24:27], v[88:91], v[80:83], v[24:27]
    ds_read_b128 v[52:55], v10 offset:51200
    v_mfma_f32_16x16x32_bf16 v[28:31], v[88:91], v[84:87], v[28:31]
    ds_read_b128 v[56:59], v10 offset:53248
    ds_read_b128 v[60:63], v10 offset:55296
    v_mfma_f32_16x16x32_bf16 v[32:35], v[92:95], v[72:75], v[32:35]
    ds_read_b64_tr_b16 v[68:69], v13 offset:49152
    v_mfma_f32_16x16x32_bf16 v[36:39], v[92:95], v[76:79], v[36:39]
    ds_read_b64_tr_b16 v[70:71], v13 offset:49664
    v_mfma_f32_16x16x32_bf16 v[40:43], v[92:95], v[80:83], v[40:43]
    v_mfma_f32_16x16x32_bf16 v[44:47], v[92:95], v[84:87], v[44:47]
    s_waitcnt lgkmcnt(0)
    v_mfma_f32_16x16x32_bf16 v[16:19], v[64:67], v[48:51], v[16:19]
    ds_read_b64_tr_b16 v[88:89], v12 offset:53248
    ds_read_b64_tr_b16 v[90:91], v12 offset:53760
    v_mfma_f32_16x16x32_bf16 v[20:23], v[64:67], v[52:55], v[20:23]
    ds_read_b128 v[72:75], v11 offset:49152
    v_mfma_f32_16x16x32_bf16 v[24:27], v[64:67], v[56:59], v[24:27]
    ds_read_b128 v[76:79], v11 offset:51200
    v_mfma_f32_16x16x32_bf16 v[28:31], v[64:67], v[60:63], v[28:31]
    ds_read_b128 v[80:83], v11 offset:53248
    ds_read_b128 v[84:87], v11 offset:55296
    v_mfma_f32_16x16x32_bf16 v[32:35], v[68:71], v[48:51], v[32:35]
    ds_read_b64_tr_b16 v[92:93], v13 offset:53248
    v_mfma_f32_16x16x32_bf16 v[36:39], v[68:71], v[52:55], v[36:39]
    ds_read_b64_tr_b16 v[94:95], v13 offset:53760
    v_mfma_f32_16x16x32_bf16 v[40:43], v[68:71], v[56:59], v[40:43]
    s_add_u32 s58, s58, 1
    v_mfma_f32_16x16x32_bf16 v[44:47], v[68:71], v[60:63], v[44:47]
    s_waitcnt lgkmcnt(0)
    s_barrier
    v_mfma_f32_16x16x32_bf16 v[16:19], v[88:91], v[72:75], v[16:19]
    ds_read_b64_tr_b16 v[64:65], v102 offset:0
    ds_read_b64_tr_b16 v[66:67], v102 offset:512
    v_mfma_f32_16x16x32_bf16 v[20:23], v[88:91], v[76:79], v[20:23]
    ds_read_b128 v[48:51], v100 offset:0
    v_mfma_f32_16x16x32_bf16 v[24:27], v[88:91], v[80:83], v[24:27]
    ds_read_b128 v[52:55], v100 offset:2048
    v_mfma_f32_16x16x32_bf16 v[28:31], v[88:91], v[84:87], v[28:31]
    ds_read_b128 v[56:59], v100 offset:4096
    ds_read_b128 v[60:63], v100 offset:6144
    v_mfma_f32_16x16x32_bf16 v[32:35], v[92:95], v[72:75], v[32:35]
    ds_read_b64_tr_b16 v[68:69], v103 offset:0
    v_mfma_f32_16x16x32_bf16 v[36:39], v[92:95], v[76:79], v[36:39]
    ds_read_b64_tr_b16 v[70:71], v103 offset:512
    v_mfma_f32_16x16x32_bf16 v[40:43], v[92:95], v[80:83], v[40:43]
    v_mfma_f32_16x16x32_bf16 v[44:47], v[92:95], v[84:87], v[44:47]
    s_waitcnt lgkmcnt(0)
    v_mfma_f32_16x16x32_bf16 v[16:19], v[64:67], v[48:51], v[16:19]
    ds_read_b64_tr_b16 v[88:89], v102 offset:4096
    ds_read_b64_tr_b16 v[90:91], v102 offset:4608
    v_mfma_f32_16x16x32_bf16 v[20:23], v[64:67], v[52:55], v[20:23]
    ds_read_b128 v[72:75], v101 offset:0
    v_mfma_f32_16x16x32_bf16 v[24:27], v[64:67], v[56:59], v[24:27]
    ds_read_b128 v[76:79], v101 offset:2048
    v_mfma_f32_16x16x32_bf16 v[28:31], v[64:67], v[60:63], v[28:31]
    ds_read_b128 v[80:83], v101 offset:4096
    ds_read_b128 v[84:87], v101 offset:6144
    v_mfma_f32_16x16x32_bf16 v[32:35], v[68:71], v[48:51], v[32:35]
    ds_read_b64_tr_b16 v[92:93], v103 offset:4096
    v_mfma_f32_16x16x32_bf16 v[36:39], v[68:71], v[52:55], v[36:39]
    ds_read_b64_tr_b16 v[94:95], v103 offset:4608
    v_mfma_f32_16x16x32_bf16 v[40:43], v[68:71], v[56:59], v[40:43]
    s_add_u32 s58, s58, 1
    v_mfma_f32_16x16x32_bf16 v[44:47], v[68:71], v[60:63], v[44:47]
    s_waitcnt lgkmcnt(0)
    s_barrier
    v_mfma_f32_16x16x32_bf16 v[16:19], v[88:91], v[72:75], v[16:19]
    ds_read_b64_tr_b16 v[64:65], v12 offset:0
    ds_read_b64_tr_b16 v[66:67], v12 offset:512
    v_mfma_f32_16x16x32_bf16 v[20:23], v[88:91], v[76:79], v[20:23]
    ds_read_b128 v[48:51], v10 offset:0
    v_mfma_f32_16x16x32_bf16 v[24:27], v[88:91], v[80:83], v[24:27]
    ds_read_b128 v[52:55], v10 offset:2048
    v_mfma_f32_16x16x32_bf16 v[28:31], v[88:91], v[84:87], v[28:31]
    ds_read_b128 v[56:59], v10 offset:4096
    ds_read_b128 v[60:63], v10 offset:6144
    v_mfma_f32_16x16x32_bf16 v[32:35], v[92:95], v[72:75], v[32:35]
    ds_read_b64_tr_b16 v[68:69], v13 offset:0
    v_mfma_f32_16x16x32_bf16 v[36:39], v[92:95], v[76:79], v[36:39]
    ds_read_b64_tr_b16 v[70:71], v13 offset:512
    v_mfma_f32_16x16x32_bf16 v[40:43], v[92:95], v[80:83], v[40:43]
    s_cmp_lt_u32 s58, 16
    v_mfma_f32_16x16x32_bf16 v[44:47], v[92:95], v[84:87], v[44:47]
    s_waitcnt lgkmcnt(0)
    s_cbranch_scc1 Lcl_9
Lcx_10:
    s_nop 7
    ds_write_b128 v14, v[16:19] offset:0
    ds_write_b128 v14, v[20:23] offset:4352
    ds_write_b128 v14, v[24:27] offset:8704
    ds_write_b128 v14, v[28:31] offset:13056
    ds_write_b128 v14, v[32:35] offset:64
    ds_write_b128 v14, v[36:39] offset:4416
    ds_write_b128 v14, v[40:43] offset:8768
    ds_write_b128 v14, v[44:47] offset:13120
    s_branch P2_epi
P2_ld:
    s_setprio 3
    v_add_u32 v239, s5, v0
    v_and_b32 v239, 15, v239
    s_mov_b32 s61, s76
    v_lshl_add_u32 v239, v239, 2, s61
    v_add_u32 v240, s36, v236
    s_add_u32 m0, s80, 65536
    s_nop 0
    buffer_load_dwordx4 v240, s[8:11], 0 offen sc1 lds
    s_add_u32 m0, s80, 69632
    s_nop 0
    buffer_load_dwordx4 v240, s[8:11], s81 offen sc1 lds
    s_add_u32 m0, s80, 73728
    s_nop 0
    buffer_load_dwordx4 v240, s[8:11], s82 offen sc1 lds
    s_add_u32 m0, s80, 77824
    s_nop 0
    buffer_load_dwordx4 v240, s[8:11], s83 offen sc1 lds
    s_add_u32 s61, s5, 1
    s_and_b32 s61, s61, 15
    s_mul_i32 s37, s61, 131072
    s_cmp_ge_u32 s61, 3
    s_addc_u32 s36, s61, 0
    s_cmp_ge_u32 s61, 10
    s_addc_u32 s61, s36, 0
    s_lshl_b32 s36, s61, 7
    v_add_u32 v241, s37, v237
    s_add_u32 m0, s80, 106496
    s_nop 0
    buffer_load_dwordx4 v241, s[12:15], 0 offen  lds
    s_add_u32 m0, s80, 110592
    s_nop 0
    buffer_load_dwordx4 v241, s[12:15], s84 offen  lds
    s_add_u32 s61, s5, 2
    s_and_b32 s61, s61, 15
    s_mul_i32 s37, s61, 131072
    s_cmp_ge_u32 s61, 3
    s_addc_u32 s36, s61, 0
    s_cmp_ge_u32 s61, 10
    s_addc_u32 s61, s36, 0
    s_lshl_b32 s36, s61, 7
    v_add_u32 v241, s37, v237
    s_add_u32 m0, s80, 131072
    s_nop 0
    buffer_load_dwordx4 v241, s[12:15], 0 offen  lds
    s_add_u32 m0, s80, 135168
    s_nop 0
    buffer_load_dwordx4 v241, s[12:15], s84 offen  lds
    s_add_u32 s61, s5, 3
    s_and_b32 s61, s61, 15
    s_mul_i32 s37, s61, 131072
    s_cmp_ge_u32 s61, 3
    s_addc_u32 s36, s61, 0
    s_cmp_ge_u32 s61, 10
    s_addc_u32 s61, s36, 0
    s_lshl_b32 s36, s61, 7
    v_add_u32 v241, s37, v237
    s_add_u32 m0, s80, 155648
    s_nop 0
    buffer_load_dwordx4 v241, s[12:15], 0 offen  lds
    s_add_u32 m0, s80, 159744
    s_nop 0
    buffer_load_dwordx4 v241, s[12:15], s84 offen  lds
    s_mov_b32 s61, 1835324
    s_load_dwordx2 s[78:79], s[46:47], s61
    s_mov_b32 s61, 1835452
    s_load_dwordx2 s[78:79], s[46:47], s61
    s_mov_b32 s61, 1835580
    s_load_dwordx2 s[78:79], s[46:47], s61
    s_mov_b32 s61, 1835708
    s_load_dwordx2 s[78:79], s[46:47], s61
    s_mov_b32 s61, 1835836
    s_load_dwordx2 s[78:79], s[46:47], s61
    s_mov_b32 s61, 2752572
    s_load_dwordx2 s[78:79], s[46:47], s61
    s_mov_b32 s61, 2752700
    s_load_dwordx2 s[78:79], s[46:47], s61
    s_waitcnt vmcnt(6)
    s_barrier
    s_mov_b32 s59, 0
    s_bitcmp1_b32 s59, 1
    s_cbranch_scc1 Lpk_11
    s_mov_b32 s60, 20000
Lpk_11_p:
    buffer_load_dword v248, v239, s[32:35], 0 offen offset:0 sc1
    s_waitcnt vmcnt(0)
    v_cmp_ne_u32 vcc, 0, v248
    s_nop 1
    s_and_b32 s59, vcc_lo, 0xffff
    s_sub_u32 s60, s60, 1
    s_cselect_b32 s59, 0xffff, s59
    s_bitcmp1_b32 s59, 1
    s_cbranch_scc0 Lpk_11_p
Lpk_11:
    s_add_u32 s61, s5, 1
    s_and_b32 s61, s61, 15
    s_mul_i32 s37, s61, 131072
    s_cmp_ge_u32 s61, 3
    s_addc_u32 s36, s61, 0
    s_cmp_ge_u32 s61, 10
    s_addc_u32 s61, s36, 0
    s_lshl_b32 s36, s61, 7
    v_add_u32 v240, s36, v236
    s_add_u32 m0, s80, 90112
    s_nop 0
    buffer_load_dwordx4 v240, s[8:11], 0 offen sc1 lds
    s_add_u32 m0, s80, 94208
    s_nop 0
    buffer_load_dwordx4 v240, s[8:11], s81 offen sc1 lds
    s_add_u32 m0, s80, 98304
    s_nop 0
    buffer_load_dwordx4 v240, s[8:11], s82 offen sc1 lds
    s_add_u32 m0, s80, 102400
    s_nop 0
    buffer_load_dwordx4 v240, s[8:11], s83 offen sc1 lds
    s_bitcmp1_b32 s59, 2
    s_cbranch_scc1 Lpk_12
    s_mov_b32 s60, 20000
Lpk_12_p:
    buffer_load_dword v248, v239, s[32:35], 0 offen offset:0 sc1
    s_waitcnt vmcnt(0)
    v_cmp_ne_u32 vcc, 0, v248
    s_nop 1
    s_and_b32 s59, vcc_lo, 0xffff
    s_sub_u32 s60, s60, 1
    s_cselect_b32 s59, 0xffff, s59
    s_bitcmp1_b32 s59, 2
    s_cbranch_scc0 Lpk_12_p
Lpk_12:
    s_add_u32 s61, s5, 2
    s_and_b32 s61, s61, 15
    s_mul_i32 s37, s61, 131072
    s_cmp_ge_u32 s61, 3
    s_addc_u32 s36, s61, 0
    s_cmp_ge_u32 s61, 10
    s_addc_u32 s61, s36, 0
    s_lshl_b32 s36, s61, 7
    v_add_u32 v240, s36, v236
    s_add_u32 m0, s80, 114688
    s_nop 0
    buffer_load_dwordx4 v240, s[8:11], 0 offen sc1 lds
    s_add_u32 m0, s80, 118784
    s_nop 0
    buffer_load_dwordx4 v240, s[8:11], s81 offen sc1 lds
    s_add_u32 m0, s80, 122880
    s_nop 0
    buffer_load_dwordx4 v240, s[8:11], s82 offen sc1 lds
    s_add_u32 m0, s80, 126976
    s_nop 0
    buffer_load_dwordx4 v240, s[8:11], s83 offen sc1 lds
    s_bitcmp1_b32 s59, 3
    s_cbranch_scc1 Lpk_13
    s_mov_b32 s60, 20000
Lpk_13_p:
    buffer_load_dword v248, v239, s[32:35], 0 offen offset:0 sc1
    s_waitcnt vmcnt(0)
    v_cmp_ne_u32 vcc, 0, v248
    s_nop 1
    s_and_b32 s59, vcc_lo, 0xffff
    s_sub_u32 s60, s60, 1
    s_cselect_b32 s59, 0xffff, s59
    s_bitcmp1_b32 s59, 3
    s_cbranch_scc0 Lpk_13_p
Lpk_13:
    s_add_u32 s61, s5, 3
    s_and_b32 s61, s61, 15
    s_mul_i32 s37, s61, 131072
    s_cmp_ge_u32 s61, 3
    s_addc_u32 s36, s61, 0
    s_cmp_ge_u32 s61, 10
    s_addc_u32 s61, s36, 0
    s_lshl_b32 s36, s61, 7
    v_add_u32 v240, s36, v236
    s_add_u32 m0, s80, 139264
    s_nop 0
    buffer_load_dwordx4 v240, s[8:11], 0 offen sc1 lds
    s_add_u32 m0, s80, 143360
    s_nop 0
    buffer_load_dwordx4 v240, s[8:11], s81 offen sc1 lds
    s_add_u32 m0, s80, 147456
    s_nop 0
    buffer_load_dwordx4 v240, s[8:11], s82 offen sc1 lds
    s_add_u32 m0, s80, 151552
    s_nop 0
    buffer_load_dwordx4 v240, s[8:11], s83 offen sc1 lds
    s_setprio 0
    s_waitcnt vmcnt(8)
    s_barrier
    s_bitcmp1_b32 s59, 4
    s_cbranch_scc1 Lpk_14
    s_mov_b32 s60, 20000
Lpk_14_p:
    buffer_load_dword v248, v239, s[32:35], 0 offen offset:0 sc1
    s_waitcnt vmcnt(0)
    v_cmp_ne_u32 vcc, 0, v248
    s_nop 1
    s_and_b32 s59, vcc_lo, 0xffff
    s_sub_u32 s60, s60, 1
    s_cselect_b32 s59, 0xffff, s59
    s_bitcmp1_b32 s59, 4
    s_cbranch_scc0 Lpk_14_p
Lpk_14:
    s_add_u32 s61, s5, 4
    s_and_b32 s61, s61, 15
    s_mul_i32 s37, s61, 131072
    s_cmp_ge_u32 s61, 3
    s_addc_u32 s36, s61, 0
    s_cmp_ge_u32 s61, 10
    s_addc_u32 s61, s36, 0
    s_lshl_b32 s36, s61, 7
    v_add_u32 v240, s36, v236
    s_add_u32 m0, s80, 65536
    s_nop 0
    buffer_load_dwordx4 v240, s[8:11], 0 offen sc1 lds
    s_add_u32 m0, s80, 69632
    s_nop 0
    buffer_load_dwordx4 v240, s[8:11], s81 offen sc1 lds
    s_add_u32 m0, s80, 73728
    s_nop 0
    buffer_load_dwordx4 v240, s[8:11], s82 offen sc1 lds
    s_add_u32 m0, s80, 77824
    s_nop 0
    buffer_load_dwordx4 v240, s[8:11], s83 offen sc1 lds
    v_add_u32 v241, s37, v237
    s_add_u32 m0, s80, 81920
    s_nop 0
    buffer_load_dwordx4 v241, s[12:15], 0 offen  lds
    s_add_u32 m0, s80, 86016
    s_nop 0
    buffer_load_dwordx4 v241, s[12:15], s84 offen  lds
    s_mov_b32 s61, 2752828
    s_load_dwordx2 s[78:79], s[46:47], s61
    s_mov_b32 s61, 2752956
    s_load_dwordx2 s[78:79], s[46:47], s61
    s_mov_b32 s61, 2753084
    s_load_dwordx2 s[78:79], s[46:47], s61
    s_waitcnt vmcnt(10)
    s_barrier
    s_bitcmp1_b32 s59, 5
    s_cbranch_scc1 Lpk_15
    s_mov_b32 s60, 20000
Lpk_15_p:
    buffer_load_dword v248, v239, s[32:35], 0 offen offset:0 sc1
    s_waitcnt vmcnt(0)
    v_cmp_ne_u32 vcc, 0, v248
    s_nop 1
    s_and_b32 s59, vcc_lo, 0xffff
    s_sub_u32 s60, s60, 1
    s_cselect_b32 s59, 0xffff, s59
    s_bitcmp1_b32 s59, 5
    s_cbranch_scc0 Lpk_15_p
Lpk_15:
    s_add_u32 s61, s5, 5
    s_and_b32 s61, s61, 15
    s_mul_i32 s37, s61, 131072
    s_cmp_ge_u32 s61, 3
    s_addc_u32 s36, s61, 0
    s_cmp_ge_u32 s61, 10
    s_addc_u32 s61, s36, 0
    s_lshl_b32 s36, s61, 7
    v_add_u32 v240, s36, v236
    s_add_u32 m0, s80, 90112
    s_nop 0
    buffer_load_dwordx4 v240, s[8:11], 0 offen sc1 lds
    s_add_u32 m0, s80, 94208
    s_nop 0
    buffer_load_dwordx4 v240, s[8:11], s81 offen sc1 lds
    s_add_u32 m0, s80, 98304
    s_nop 0
    buffer_load_dwordx4 v240, s[8:11], s82 offen sc1 lds
    s_add_u32 m0, s80, 102400
    s_nop 0
    buffer_load_dwordx4 v240, s[8:11], s83 offen sc1 lds
    v_add_u32 v241, s37, v237
    s_add_u32 m0, s80, 106496
    s_nop 0
    buffer_load_dwordx4 v241, s[12:15], 0 offen  lds
    s_add_u32 m0, s80, 110592
    s_nop 0
    buffer_load_dwordx4 v241, s[12:15], s84 offen  lds
    s_waitcnt vmcnt(12)
    s_barrier
    s_bitcmp1_b32 s59, 6
    s_cbranch_scc1 Lpk_16
    s_mov_b32 s60, 20000
Lpk_16_p:
    buffer_load_dword v248, v239, s[32:35], 0 offen offset:0 sc1
    s_waitcnt vmcnt(0)
    v_cmp_ne_u32 vcc, 0, v248
    s_nop 1
    s_and_b32 s59, vcc_lo, 0xffff
    s_sub_u32 s60, s60, 1
    s_cselect_b32 s59, 0xffff, s59
    s_bitcmp1_b32 s59, 6
    s_cbranch_scc0 Lpk_16_p
Lpk_16:
    s_add_u32 s61, s5, 6
    s_and_b32 s61, s61, 15
    s_mul_i32 s37, s61, 131072
    s_cmp_ge_u32 s61, 3
    s_addc_u32 s36, s61, 0
    s_cmp_ge_u32 s61, 10
    s_addc_u32 s61, s36, 0
    s_lshl_b32 s36, s61, 7
    v_add_u32 v240, s36, v236
    s_add_u32 m0, s80, 114688
    s_nop 0
    buffer_load_dwordx4 v240, s[8:11], 0 offen sc1 lds
    s_add_u32 m0, s80, 118784
    s_nop 0
    buffer_load_dwordx4 v240, s[8:11], s81 offen sc1 lds
    s_add_u32 m0, s80, 122880
    s_nop 0
    buffer_load_dwordx4 v240, s[8:11], s82 offen sc1 lds
    s_add_u32 m0, s80, 126976
    s_nop 0
    buffer_load_dwordx4 v240, s[8:11], s83 offen sc1 lds
    v_add_u32 v241, s37, v237
    s_add_u32 m0, s80, 131072
    s_nop 0
    buffer_load_dwordx4 v241, s[12:15], 0 offen  lds
    s_add_u32 m0, s80, 135168
    s_nop 0
    buffer_load_dwordx4 v241, s[12:15], s84 offen  lds
    s_mov_b32 s61, 2753212
    s_load_dwordx2 s[78:79], s[46:47], s61
    s_mov_b32 s61, 2753340
    s_load_dwordx2 s[78:79], s[46:47], s61
    s_mov_b32 s61, 3670076
    s_load_dwordx2 s[78:79], s[46:47], s61
    s_waitcnt vmcnt(12)
    s_barrier
    s_bitcmp1_b32 s59, 7
    s_cbranch_scc1 Lpk_17
    s_mov_b32 s60, 20000
Lpk_17_p:
    buffer_load_dword v248, v239, s[32:35], 0 offen offset:0 sc1
    s_waitcnt vmcnt(0)
    v_cmp_ne_u32 vcc, 0, v248
    s_nop 1
    s_and_b32 s59, vcc_lo, 0xffff
    s_sub_u32 s60, s60, 1
    s_cselect_b32 s59, 0xffff, s59
    s_bitcmp1_b32 s59, 7
    s_cbranch_scc0 Lpk_17_p
Lpk_17:
    s_add_u32 s61, s5, 7
    s_and_b32 s61, s61, 15
    s_mul_i32 s37, s61, 131072
    s_cmp_ge_u32 s61, 3
    s_addc_u32 s36, s61, 0
    s_cmp_ge_u32 s61, 10
    s_addc_u32 s61, s36, 0
    s_lshl_b32 s36, s61, 7
    v_add_u32 v240, s36, v236
    s_add_u32 m0, s80, 139264
    s_nop 0
    buffer_load_dwordx4 v240, s[8:11], 0 offen sc1 lds
    s_add_u32 m0, s80, 143360
    s_nop 0
    buffer_load_dwordx4 v240, s[8:11], s81 offen sc1 lds
    s_add_u32 m0, s80, 147456
    s_nop 0
    buffer_load_dwordx4 v240, s[8:11], s82 offen sc1 lds
    s_add_u32 m0, s80, 151552
    s_nop 0
    buffer_load_dwordx4 v240, s[8:11], s83 offen sc1 lds
    v_add_u32 v241, s37, v237
    s_add_u32 m0, s80, 155648
    s_nop 0
    buffer_load_dwordx4 v241, s[12:15], 0 offen  lds
    s_add_u32 m0, s80, 159744
    s_nop 0
    buffer_load_dwordx4 v241, s[12:15], s84 offen  lds
    s_waitcnt vmcnt(12)
    s_barrier
    s_bitcmp1_b32 s59, 8
    s_cbranch_scc1 Lpk_18
    s_mov_b32 s60, 20000
Lpk_18_p:
    buffer_load_dword v248, v239, s[32:35], 0 offen offset:0 sc1
    s_waitcnt vmcnt(0)
    v_cmp_ne_u32 vcc, 0, v248
    s_nop 1
    s_and_b32 s59, vcc_lo, 0xffff
    s_sub_u32 s60, s60, 1
    s_cselect_b32 s59, 0xffff, s59
    s_bitcmp1_b32 s59, 8
    s_cbranch_scc0 Lpk_18_p
Lpk_18:
    s_add_u32 s61, s5, 8
    s_and_b32 s61, s61, 15
    s_mul_i32 s37, s61, 131072
    s_cmp_ge_u32 s61, 3
    s_addc_u32 s36, s61, 0
    s_cmp_ge_u32 s61, 10
    s_addc_u32 s61, s36, 0
    s_lshl_b32 s36, s61, 7
    v_add_u32 v240, s36, v236
    s_add_u32 m0, s80, 65536
    s_nop 0
    buffer_load_dwordx4 v240, s[8:11], 0 offen sc1 lds
    s_add_u32 m0, s80, 69632
    s_nop 0
    buffer_load_dwordx4 v240, s[8:11], s81 offen sc1 lds
    s_add_u32 m0, s80, 73728
    s_nop 0
    buffer_load_dwordx4 v240, s[8:11], s82 offen sc1 lds
    s_add_u32 m0, s80, 77824
    s_nop 0
    buffer_load_dwordx4 v240, s[8:11], s83 offen sc1 lds
    v_add_u32 v241, s37, v237
    s_add_u32 m0, s80, 81920
    s_nop 0
    buffer_load_dwordx4 v241, s[12:15], 0 offen  lds
    s_add_u32 m0, s80, 86016
    s_nop 0
    buffer_load_dwordx4 v241, s[12:15], s84 offen  lds
    s_mov_b32 s61, 3670204
    s_load_dwordx2 s[78:79], s[46:47], s61
    s_mov_b32 s61, 3670332
    s_load_dwordx2 s[78:79], s[46:47], s61
    s_mov_b32 s61, 3670460
    s_load_dwordx2 s[78:79], s[46:47], s61
    s_waitcnt vmcnt(12)
    s_barrier
    s_bitcmp1_b32 s59, 9
    s_cbranch_scc1 Lpk_19
    s_mov_b32 s60, 20000
Lpk_19_p:
    buffer_load_dword v248, v239, s[32:35], 0 offen offset:0 sc1
    s_waitcnt vmcnt(0)
    v_cmp_ne_u32 vcc, 0, v248
    s_nop 1
    s_and_b32 s59, vcc_lo, 0xffff
    s_sub_u32 s60, s60, 1
    s_cselect_b32 s59, 0xffff, s59
    s_bitcmp1_b32 s59, 9
    s_cbranch_scc0 Lpk_19_p
Lpk_19:
    s_add_u32 s61, s5, 9
    s_and_b32 s61, s61, 15
    s_mul_i32 s37, s61, 131072
    s_cmp_ge_u32 s61, 3
    s_addc_u32 s36, s61, 0
    s_cmp_ge_u32 s61, 10
    s_addc_u32 s61, s36, 0
    s_lshl_b32 s36, s61, 7
    v_add_u32 v240, s36, v236
    s_add_u32 m0, s80, 90112
    s_nop 0
    buffer_load_dwordx4 v240, s[8:11], 0 offen sc1 lds
    s_add_u32 m0, s80, 94208
    s_nop 0
    buffer_load_dwordx4 v240, s[8:11], s81 offen sc1 lds
    s_add_u32 m0, s80, 98304
    s_nop 0
    buffer_load_dwordx4 v240, s[8:11], s82 offen sc1 lds
    s_add_u32 m0, s80, 102400
    s_nop 0
    buffer_load_dwordx4 v240, s[8:11], s83 offen sc1 lds
    v_add_u32 v241, s37, v237
    s_add_u32 m0, s80, 106496
    s_nop 0
    buffer_load_dwordx4 v241, s[12:15], 0 offen  lds
    s_add_u32 m0, s80, 110592
    s_nop 0
    buffer_load_dwordx4 v241, s[12:15], s84 offen  lds
    s_waitcnt vmcnt(12)
    s_barrier
    s_bitcmp1_b32 s59, 10
    s_cbranch_scc1 Lpk_20
    s_mov_b32 s60, 20000
Lpk_20_p:
    buffer_load_dword v248, v239, s[32:35], 0 offen offset:0 sc1
    s_waitcnt vmcnt(0)
    v_cmp_ne_u32 vcc, 0, v248
    s_nop 1
    s_and_b32 s59, vcc_lo, 0xffff
    s_sub_u32 s60, s60, 1
    s_cselect_b32 s59, 0xffff, s59
    s_bitcmp1_b32 s59, 10
    s_cbranch_scc0 Lpk_20_p
Lpk_20:
    s_add_u32 s61, s5, 10
    s_and_b32 s61, s61, 15
    s_mul_i32 s37, s61, 131072
    s_cmp_ge_u32 s61, 3
    s_addc_u32 s36, s61, 0
    s_cmp_ge_u32 s61, 10
    s_addc_u32 s61, s36, 0
    s_lshl_b32 s36, s61, 7
    v_add_u32 v240, s36, v236
    s_add_u32 m0, s80, 114688
    s_nop 0
    buffer_load_dwordx4 v240, s[8:11], 0 offen sc1 lds
    s_add_u32 m0, s80, 118784
    s_nop 0
    buffer_load_dwordx4 v240, s[8:11], s81 offen sc1 lds
    s_add_u32 m0, s80, 122880
    s_nop 0
    buffer_load_dwordx4 v240, s[8:11], s82 offen sc1 lds
    s_add_u32 m0, s80, 126976
    s_nop 0
    buffer_load_dwordx4 v240, s[8:11], s83 offen sc1 lds
    v_add_u32 v241, s37, v237
    s_add_u32 m0, s80, 131072
    s_nop 0
    buffer_load_dwordx4 v241, s[12:15], 0 offen  lds
    s_add_u32 m0, s80, 135168
    s_nop 0
    buffer_load_dwordx4 v241, s[12:15], s84 offen  lds
    s_mov_b32 s61, 3670588
    s_load_dwordx2 s[78:79], s[46:47], s61
    s_mov_b32 s61, 3670716
    s_load_dwordx2 s[78:79], s[46:47], s61
    s_mov_b32 s61, 3670844
    s_load_dwordx2 s[78:79], s[46:47], s61
    s_waitcnt vmcnt(12)
    s_barrier
    s_bitcmp1_b32 s59, 11
    s_cbranch_scc1 Lpk_21
    s_mov_b32 s60, 20000
Lpk_21_p:
    buffer_load_dword v248, v239, s[32:35], 0 offen offset:0 sc1
    s_waitcnt vmcnt(0)
    v_cmp_ne_u32 vcc, 0, v248
    s_nop 1
    s_and_b32 s59, vcc_lo, 0xffff
    s_sub_u32 s60, s60, 1
    s_cselect_b32 s59, 0xffff, s59
    s_bitcmp1_b32 s59, 11
    s_cbranch_scc0 Lpk_21_p
Lpk_21:
    s_add_u32 s61, s5, 11
    s_and_b32 s61, s61, 15
    s_mul_i32 s37, s61, 131072
    s_cmp_ge_u32 s61, 3
    s_addc_u32 s36, s61, 0
    s_cmp_ge_u32 s61, 10
    s_addc_u32 s61, s36, 0
    s_lshl_b32 s36, s61, 7
    v_add_u32 v240, s36, v236
    s_add_u32 m0, s80, 139264
    s_nop 0
    buffer_load_dwordx4 v240, s[8:11], 0 offen sc1 lds
    s_add_u32 m0, s80, 143360
    s_nop 0
    buffer_load_dwordx4 v240, s[8:11], s81 offen sc1 lds
    s_add_u32 m0, s80, 147456
    s_nop 0
    buffer_load_dwordx4 v240, s[8:11], s82 offen sc1 lds
    s_add_u32 m0, s80, 151552
    s_nop 0
    buffer_load_dwordx4 v240, s[8:11], s83 offen sc1 lds
    v_add_u32 v241, s37, v237
    s_add_u32 m0, s80, 155648
    s_nop 0
    buffer_load_dwordx4 v241, s[12:15], 0 offen  lds
    s_add_u32 m0, s80, 159744
    s_nop 0
    buffer_load_dwordx4 v241, s[12:15], s84 offen  lds
    s_waitcnt vmcnt(12)
    s_barrier
    s_bitcmp1_b32 s59, 12
    s_cbranch_scc1 Lpk_22
    s_mov_b32 s60, 20000
Lpk_22_p:
    buffer_load_dword v248, v239, s[32:35], 0 offen offset:0 sc1
    s_waitcnt vmcnt(0)
    v_cmp_ne_u32 vcc, 0, v248
    s_nop 1
    s_and_b32 s59, vcc_lo, 0xffff
    s_sub_u32 s60, s60, 1
    s_cselect_b32 s59, 0xffff, s59
    s_bitcmp1_b32 s59, 12
    s_cbranch_scc0 Lpk_22_p
Lpk_22:
    s_add_u32 s61, s5, 12
    s_and_b32 s61, s61, 15
    s_mul_i32 s37, s61, 131072
    s_cmp_ge_u32 s61, 3
    s_addc_u32 s36, s61, 0
    s_cmp_ge_u32 s61, 10
    s_addc_u32 s61, s36, 0
    s_lshl_b32 s36, s61, 7
    v_add_u32 v240, s36, v236
    s_add_u32 m0, s80, 65536
    s_nop 0
    buffer_load_dwordx4 v240, s[8:11], 0 offen sc1 lds
    s_add_u32 m0, s80, 69632
    s_nop 0
    buffer_load_dwordx4 v240, s[8:11], s81 offen sc1 lds
    s_add_u32 m0, s80, 73728
    s_nop 0
    buffer_load_dwordx4 v240, s[8:11], s82 offen sc1 lds
    s_add_u32 m0, s80, 77824
    s_nop 0
    buffer_load_dwordx4 v240, s[8:11], s83 offen sc1 lds
    v_add_u32 v241, s37, v237
    s_add_u32 m0, s80, 81920
    s_nop 0
    buffer_load_dwordx4 v241, s[12:15], 0 offen  lds
    s_add_u32 m0, s80, 86016
    s_nop 0
    buffer_load_dwordx4 v241, s[12:15], s84 offen  lds
    s_mov_b32 s61, 4587580
    s_load_dwordx2 s[78:79], s[46:47], s61
    s_mov_b32 s61, 4587708
    s_load_dwordx2 s[78:79], s[46:47], s61
    s_mov_b32 s61, 4587836
    s_load_dwordx2 s[78:79], s[46:47], s61
    s_waitcnt vmcnt(12)
    s_barrier
    s_bitcmp1_b32 s59, 13
    s_cbranch_scc1 Lpk_23
    s_mov_b32 s60, 20000
Lpk_23_p:
    buffer_load_dword v248, v239, s[32:35], 0 offen offset:0 sc1
    s_waitcnt vmcnt(0)
    v_cmp_ne_u32 vcc, 0, v248
    s_nop 1
    s_and_b32 s59, vcc_lo, 0xffff
    s_sub_u32 s60, s60, 1
    s_cselect_b32 s59, 0xffff, s59
    s_bitcmp1_b32 s59, 13
    s_cbranch_scc0 Lpk_23_p
Lpk_23:
    s_add_u32 s61, s5, 13
    s_and_b32 s61, s61, 15
    s_mul_i32 s37, s61, 131072
    s_cmp_ge_u32 s61, 3
    s_addc_u32 s36, s61, 0
    s_cmp_ge_u32 s61, 10
    s_addc_u32 s61, s36, 0
    s_lshl_b32 s36, s61, 7
    v_add_u32 v240, s36, v236
    s_add_u32 m0, s80, 90112
    s_nop 0
    buffer_load_dwordx4 v240, s[8:11], 0 offen sc1 lds
    s_add_u32 m0, s80, 94208
    s_nop 0
    buffer_load_dwordx4 v240, s[8:11], s81 offen sc1 lds
    s_add_u32 m0, s80, 98304
    s_nop 0
    buffer_load_dwordx4 v240, s[8:11], s82 offen sc1 lds
    s_add_u32 m0, s80, 102400
    s_nop 0
    buffer_load_dwordx4 v240, s[8:11], s83 offen sc1 lds
    v_add_u32 v241, s37, v237
    s_add_u32 m0, s80, 106496
    s_nop 0
    buffer_load_dwordx4 v241, s[12:15], 0 offen  lds
    s_add_u32 m0, s80, 110592
    s_nop 0
    buffer_load_dwordx4 v241, s[12:15], s84 offen  lds
    s_waitcnt vmcnt(12)
    s_barrier
    s_bitcmp1_b32 s59, 14
    s_cbranch_scc1 Lpk_24
    s_mov_b32 s60, 20000
Lpk_24_p:
    buffer_load_dword v248, v239, s[32:35], 0 offen offset:0 sc1
    s_waitcnt vmcnt(0)
    v_cmp_ne_u32 vcc, 0, v248
    s_nop 1
    s_and_b32 s59, vcc_lo, 0xffff
    s_sub_u32 s60, s60, 1
    s_cselect_b32 s59, 0xffff, s59
    s_bitcmp1_b32 s59, 14
    s_cbranch_scc0 Lpk_24_p
Lpk_24:
    s_add_u32 s61, s5, 14
    s_and_b32 s61, s61, 15
    s_mul_i32 s37, s61, 131072
    s_cmp_ge_u32 s61, 3
    s_addc_u32 s36, s61, 0
    s_cmp_ge_u32 s61, 10
    s_addc_u32 s61, s36, 0
    s_lshl_b32 s36, s61, 7
    v_add_u32 v240, s36, v236
    s_add_u32 m0, s80, 114688
    s_nop 0
    buffer_load_dwordx4 v240, s[8:11], 0 offen sc1 lds
    s_add_u32 m0, s80, 118784
    s_nop 0
    buffer_load_dwordx4 v240, s[8:11], s81 offen sc1 lds
    s_add_u32 m0, s80, 122880
    s_nop 0
    buffer_load_dwordx4 v240, s[8:11], s82 offen sc1 lds
    s_add_u32 m0, s80, 126976
    s_nop 0
    buffer_load_dwordx4 v240, s[8:11], s83 offen sc1 lds
    v_add_u32 v241, s37, v237
    s_add_u32 m0, s80, 131072
    s_nop 0
    buffer_load_dwordx4 v241, s[12:15], 0 offen  lds
    s_add_u32 m0, s80, 135168
    s_nop 0
    buffer_load_dwordx4 v241, s[12:15], s84 offen  lds
    s_waitcnt vmcnt(12)
    s_barrier
    s_bitcmp1_b32 s59, 15
    s_cbranch_scc1 Lpk_25
    s_mov_b32 s60, 20000
Lpk_25_p:
    buffer_load_dword v248, v239, s[32:35], 0 offen offset:0 sc1
    s_waitcnt vmcnt(0)
    v_cmp_ne_u32 vcc, 0, v248
    s_nop 1
    s_and_b32 s59, vcc_lo, 0xffff
    s_sub_u32 s60, s60, 1
    s_cselect_b32 s59, 0xffff, s59
    s_bitcmp1_b32 s59, 15
    s_cbranch_scc0 Lpk_25_p
Lpk_25:
    s_add_u32 s61, s5, 15
    s_and_b32 s61, s61, 15
    s_mul_i32 s37, s61, 131072
    s_cmp_ge_u32 s61, 3
    s_addc_u32 s36, s61, 0
    s_cmp_ge_u32 s61, 10
    s_addc_u32 s61, s36, 0
    s_lshl_b32 s36, s61, 7
    v_add_u32 v240, s36, v236
    s_add_u32 m0, s80, 139264
    s_nop 0
    buffer_load_dwordx4 v240, s[8:11], 0 offen sc1 lds
    s_add_u32 m0, s80, 143360
    s_nop 0
    buffer_load_dwordx4 v240, s[8:11], s81 offen sc1 lds
    s_add_u32 m0, s80, 147456
    s_nop 0
    buffer_load_dwordx4 v240, s[8:11], s82 offen sc1 lds
    s_add_u32 m0, s80, 151552
    s_nop 0
    buffer_load_dwordx4 v240, s[8:11], s83 offen sc1 lds
    v_add_u32 v241, s37, v237
    s_add_u32 m0, s80, 155648
    s_nop 0
    buffer_load_dwordx4 v241, s[12:15], 0 offen  lds
    s_add_u32 m0, s80, 159744
    s_nop 0
    buffer_load_dwordx4 v241, s[12:15], s84 offen  lds
    s_waitcnt vmcnt(12)
    s_barrier
    s_mov_b32 s20, s40
    s_mov_b32 s21, s41
    s_mov_b32 s22, 4194304
    s_mov_b32 s23, 0x20000
    s_lshl_b32 s61, s4, 7
    s_lshl_b32 s62, s63, 3
    s_add_u32 s61, s61, s62
    v_lshrrev_b32 v3, 3, v0
    v_add_u32 v3, s61, v3
    v_lshlrev_b32 v3, 11, v3
    v_and_b32 v4, 7, v0
    v_lshl_add_u32 v3, v4, 4, v3
    s_lshl_b32 s61, s5, 7
    v_add_u32 v3, s61, v3
    s_add_u32 m0, s80, 34816
    s_mov_b32 s61, 0
    buffer_load_dwordx4 v3, s[20:23], s61 offen lds
    s_add_u32 m0, s80, 38912
    s_mov_b32 s61, 65536
    buffer_load_dwordx4 v3, s[20:23], s61 offen lds
    s_add_u32 m0, s80, 43008
    s_mov_b32 s61, 131072
    buffer_load_dwordx4 v3, s[20:23], s61 offen lds
    s_add_u32 m0, s80, 47104
    s_mov_b32 s61, 196608
    buffer_load_dwordx4 v3, s[20:23], s61 offen lds
    s_waitcnt vmcnt(10)
    s_barrier
    s_waitcnt vmcnt(4)
    s_barrier
    s_barrier
    s_mul_i32 s74, s5, 448
    s_bitcmp1_b32 s5, 0
    s_cselect_b32 s72, 64, 0
    s_cselect_b32 s73, 0, 0x180
    v_lshrrev_b32 v243, 3, v0
    v_and_b32 v244, 7, v0
    v_lshrrev_b32 v245, 4, v0
    s_lshl_b32 s61, s4, 7
    s_lshl_b32 s80, s63, 3
    s_add_u32 s61, s61, s80
    v_add_u32 v246, s61, v243
    v_lshlrev_b32 v246, 12, v246
    s_and_b32 s82, s63, 1
    s_lshl_b32 s82, s82, 2
    v_xor_b32 v247, v244, v245
    v_xor_b32 v247, s82, v247
    v_lshl_add_u32 v240, v247, 4, v246
    v_add_u32 v246, s80, v243
    v_mul_u32_u24 v246, 7168, v246
    v_and_b32 v247, 2, v243
    v_xor_b32 v247, v244, v247
    v_xor_b32 v247, s82, v247
    v_lshl_add_u32 v241, v247, 4, v246
    s_add_u32 s61, s74, s72
    v_add_u32 v241, s61, v241
    v_lshrrev_b32 v246, 2, v0
    s_lshl_b32 s81, s63, 4
    v_add_u32 v246, s81, v246
    v_mul_u32_u24 v246, 7168, v246
    v_and_b32 v247, 3, v0
    v_and_b32 v248, 2, v245
    v_xor_b32 v247, v247, v248
    v_lshl_add_u32 v242, v247, 4, v246
    s_add_u32 s61, s74, s73
    v_add_u32 v242, s61, v242
    s_lshl_b32 s80, s63, 10
    s_mov_b32 s81, 131072
    s_mov_b32 s82, 262144
    s_mov_b32 s83, 393216
    s_mov_b32 s84, 229376
    s_mov_b32 s85, 128
    s_mov_b32 s86, 229504
    s_mov_b32 s87, 256
    s_mov_b32 s88, 229632
    s_add_u32 s8, s56, 8388608
    s_addc_u32 s9, s57, 0
    s_mov_b32 s10, 8388608
    s_mov_b32 s11, 0x20000
    s_mov_b32 s12, s48
    s_mov_b32 s13, s49
    s_mov_b32 s14, 7340032
    s_mov_b32 s15, 0x20000
    v_mov_b32 v236, v240
    v_mov_b32 v237, v241
    v_mov_b32 v238, v242
    s_mov_b32 s61, s5
    s_mul_i32 s37, s61, 458752
    s_cmp_ge_u32 s61, 3
    s_addc_u32 s36, s61, 0
    s_cmp_ge_u32 s61, 10
    s_addc_u32 s61, s36, 0
    s_lshl_b32 s36, s61, 7
    v_add_u32 v241, s37, v237
    v_add_u32 v242, s37, v238
    s_add_u32 m0, s80, 61440
    s_nop 0
    buffer_load_dwordx4 v241, s[12:15], 0 offen  lds
    s_add_u32 m0, s80, 65536
    s_nop 0
    buffer_load_dwordx4 v241, s[12:15], s84 offen  lds
    s_add_u32 m0, s80, 69632
    s_nop 0
    buffer_load_dwordx4 v241, s[12:15], s85 offen  lds
    s_add_u32 m0, s80, 73728
    s_nop 0
    buffer_load_dwordx4 v241, s[12:15], s86 offen  lds
    s_add_u32 m0, s80, 77824
    s_nop 0
    buffer_load_dwordx4 v241, s[12:15], s87 offen  lds
    s_add_u32 m0, s80, 81920
    s_nop 0
    buffer_load_dwordx4 v241, s[12:15], s88 offen  lds
    s_add_u32 m0, s80, 86016
    s_nop 0
    buffer_load_dwordx4 v242, s[12:15], 0 offen  lds
    s_waitcnt vmcnt(7)
P2_epi:
    s_add_u32 s16, s56, 8388608
    s_addc_u32 s17, s57, 0
    s_mov_b32 s18, 8388608
    s_mov_b32 s19, 0x20000
    s_add_u32 s24, s56, 41943040
    s_addc_u32 s25, s57, 0
    s_mov_b32 s26, 262144
    s_mov_b32 s27, 0x20000
    v_lshl_add_u32 v5, s3, 6, v0
    v_lshrrev_b32 v6, 3, v5
    v_and_b32 v7, 7, v5
    s_lshl_b32 s61, s4, 7
    v_add_u32 v8, s61, v6
    v_lshlrev_b32 v9, 12, v8
    v_lshl_add_u32 v9, v7, 4, v9
    v_add_u32 v9, s77, v9
    s_lshl_b32 s61, s4, 4
    s_add_u32 s61, s61, s5
    s_lshl_b32 s61, s61, 10
    v_lshl_add_u32 v8, v6, 3, s61
    v_mul_u32_u24 v6, 272, v6
    v_lshl_add_u32 v10, v7, 5, v6
    v_lshlrev_b32 v11, 4, v5
    v_cmp_eq_u32 vcc, 0, v7
    v_mov_b32 v12, 0x80000000
    s_mov_b32 s66, 262144
    v_cndmask_b32 v8, v12, v8, vcc
    s_mov_b32 s61, 0xffff0000
    v_mov_b32 v60, 0x3f803f80
    s_waitcnt lgkmcnt(0)
    s_barrier
    ds_read_b128 v[64:67], v11 offset:34816
    ds_read_b128 v[16:19], v10 offset:0
    ds_read_b128 v[20:23], v10 offset:16
    ds_read_b128 v[68:71], v11 offset:43008
    ds_read_b128 v[24:27], v10 offset:17408
    ds_read_b128 v[28:31], v10 offset:17424
    s_waitcnt lgkmcnt(5)
    v_lshlrev_b32 v32, 16, v64
    v_and_b32 v33, s61, v64
    v_lshlrev_b32 v34, 16, v65
    v_and_b32 v35, s61, v65
    v_lshlrev_b32 v36, 16, v66
    v_and_b32 v37, s61, v66
    v_lshlrev_b32 v38, 16, v67
    v_and_b32 v39, s61, v67
    s_waitcnt lgkmcnt(3)
    v_pk_add_f32 v[16:17], v[16:17], v[32:33]
    v_pk_add_f32 v[18:19], v[18:19], v[34:35]
    v_pk_add_f32 v[20:21], v[20:21], v[36:37]
    v_pk_add_f32 v[22:23], v[22:23], v[38:39]
    v_cvt_pk_bf16_f32 v48, v16, v17
    v_cvt_pk_bf16_f32 v49, v18, v19
    v_cvt_pk_bf16_f32 v50, v20, v21
    v_cvt_pk_bf16_f32 v51, v22, v23
    buffer_store_dwordx4 v[48:51], v9, s[16:19], 0 offen sc1
    s_waitcnt lgkmcnt(2)
    v_lshlrev_b32 v40, 16, v68
    v_and_b32 v41, s61, v68
    v_lshlrev_b32 v42, 16, v69
    v_and_b32 v43, s61, v69
    v_lshlrev_b32 v44, 16, v70
    v_and_b32 v45, s61, v70
    v_lshlrev_b32 v46, 16, v71
    v_and_b32 v47, s61, v71
    s_waitcnt lgkmcnt(0)
    v_pk_add_f32 v[24:25], v[24:25], v[40:41]
    v_pk_add_f32 v[26:27], v[26:27], v[42:43]
    v_pk_add_f32 v[28:29], v[28:29], v[44:45]
    v_pk_add_f32 v[30:31], v[30:31], v[46:47]
    v_cvt_pk_bf16_f32 v52, v24, v25
    v_cvt_pk_bf16_f32 v53, v26, v27
    v_cvt_pk_bf16_f32 v54, v28, v29
    v_cvt_pk_bf16_f32 v55, v30, v31
    buffer_store_dwordx4 v[52:55], v9, s[16:19], s66 offen sc1
    v_mov_b32 v56, 0
    v_mov_b32 v57, 0
    v_mov_b32 v58, 0
    v_mov_b32 v59, 0
    v_dot2c_f32_bf16 v56, v48, v60
    v_dot2c_f32_bf16 v57, v48, v48
    v_dot2c_f32_bf16 v58, v52, v60
    v_dot2c_f32_bf16 v59, v52, v52
    v_dot2c_f32_bf16 v56, v49, v60
    v_dot2c_f32_bf16 v57, v49, v49
    v_dot2c_f32_bf16 v58, v53, v60
    v_dot2c_f32_bf16 v59, v53, v53
    v_dot2c_f32_bf16 v56, v50, v60
    v_dot2c_f32_bf16 v57, v50, v50
    v_dot2c_f32_bf16 v58, v54, v60
    v_dot2c_f32_bf16 v59, v54, v54
    v_dot2c_f32_bf16 v56, v51, v60
    v_dot2c_f32_bf16 v57, v51, v51
    v_dot2c_f32_bf16 v58, v55, v60
    v_dot2c_f32_bf16 v59, v55, v55
    s_nop 2
    v_add_f32_dpp v56, v56, v56 quad_perm:[1,0,3,2] row_mask:0xf bank_mask:0xf
    v_add_f32_dpp v57, v57, v57 quad_perm:[1,0,3,2] row_mask:0xf bank_mask:0xf
    v_add_f32_dpp v58, v58, v58 quad_perm:[1,0,3,2] row_mask:0xf bank_mask:0xf
    v_add_f32_dpp v59, v59, v59 quad_perm:[1,0,3,2] row_mask:0xf bank_mask:0xf
    v_add_f32_dpp v56, v56, v56 quad_perm:[2,3,0,1] row_mask:0xf bank_mask:0xf
    v_add_f32_dpp v57, v57, v57 quad_perm:[2,3,0,1] row_mask:0xf bank_mask:0xf
    v_add_f32_dpp v58, v58, v58 quad_perm:[2,3,0,1] row_mask:0xf bank_mask:0xf
    v_add_f32_dpp v59, v59, v59 quad_perm:[2,3,0,1] row_mask:0xf bank_mask:0xf
    v_add_f32_dpp v56, v56, v56 row_half_mirror row_mask:0xf bank_mask:0xf
    v_add_f32_dpp v57, v57, v57 row_half_mirror row_mask:0xf bank_mask:0xf
    v_add_f32_dpp v58, v58, v58 row_half_mirror row_mask:0xf bank_mask:0xf
    v_add_f32_dpp v59, v59, v59 row_half_mirror row_mask:0xf bank_mask:0xf
    buffer_store_dwordx2 v[56:57], v8, s[24:27], 0 offen sc1
    buffer_store_dwordx2 v[58:59], v8, s[24:27], 0 offen offset:512 sc1
    s_waitcnt vmcnt(0)
    s_barrier
    s_cmp_lg_u32 s3, 0
    s_cbranch_scc1 Lsg_26
    s_mov_b32 s62, s76
    s_lshl_b32 s61, s5, 2
    s_add_u32 s61, s61, s62
    v_mov_b32 v1, 1
    v_mov_b32 v2, s61
    s_mov_b64 exec, 1
    buffer_store_dword v1, v2, s[32:35], 0 offen offset:128 sc1
    s_mov_b64 exec, -1
Lsg_26:
    s_cmp_ge_u32 s3, 4
    s_cbranch_scc1 P3_ld
    s_and_b32 s66, s3, 1
    s_lshr_b32 s67, s3, 1
    s_lshl_b32 s68, s67, 1
    s_add_u32 s68, s68, s66
    s_lshl_b32 s61, s66, 13
    v_and_b32 v1, 15, v0
    v_lshrrev_b32 v2, 4, v0
    v_lshrrev_b32 v3, 1, v1
    v_xor_b32 v3, v2, v3
    v_lshlrev_b32 v4, 7, v1
    v_lshl_add_u32 v8, v3, 4, v4
    v_add_u32 v8, s61, v8
    v_xor_b32 v9, 64, v8
    v_lshrrev_b32 v3, 2, v1
    v_lshlrev_b32 v3, 7, v3
    v_lshl_add_u32 v3, v2, 10, v3
    v_and_b32 v4, 3, v1
    v_lshl_add_u32 v5, v4, 3, v3
    v_add_u32 v5, 16384, v5
    v_lshrrev_b32 v3, 3, v1
    v_and_b32 v4, 1, v2
    v_lshl_add_u32 v6, v4, 1, v3
    v_xor_b32 v3, s68, v6
    v_lshl_add_u32 v10, v3, 5, v5
    v_xor_b32 v11, 32, v10
    v_lshrrev_b32 v3, 1, v2
    v_lshlrev_b32 v3, 10, v3
    v_and_b32 v4, 1, v2
    v_lshl_add_u32 v3, v4, 9, v3
    v_xor_b32 v4, s67, v4
    v_lshl_add_u32 v3, v4, 5, v3
    v_lshrrev_b32 v4, 2, v1
    v_lshl_add_u32 v3, v4, 6, v3
    v_and_b32 v4, 3, v1
    v_lshl_add_u32 v3, v4, 3, v3
    v_add_u32 v12, 40960, v3
    v_lshrrev_b32 v3, 1, v2
    v_lshl_add_u32 v3, s68, 1, v3
    v_lshrrev_b32 v4, 1, v1
    v_xor_b32 v3, v3, v4
    v_lshlrev_b32 v3, 4, v3
    v_lshl_add_u32 v3, v1, 7, v3
    v_and_b32 v4, 1, v2
    v_lshl_add_u32 v3, v4, 3, v3
    s_lshl_b32 s61, s66, 13
    s_add_u32 s61, s61, 0x10000
    v_add_u32 v13, s61, v3
    s_mul_i32 s61, s66, 5120
    s_lshl_b32 s62, s67, 5
    s_add_u32 s61, s61, s62
    v_mul_u32_u24 v3, 80, v1
    v_lshl_add_u32 v3, v2, 3, v3
    v_add_u32 v14, s61, v3
    s_lshl_b32 s61, s66, 10
    s_add_u32 s61, s61, 135168
    v_lshlrev_b32 v3, 4, v1
    v_add_u32 v15, s61, v3
    s_lshl_b32 s61, s68, 6
    s_add_u32 s61, s61, 137216
    v_lshlrev_b32 v3, 4, v2
    v_add_u32 v16, s61, v3
    v_mov_b32 v20, 0x3f803f80
    v_mov_b32 v21, 0x3f803f80
    v_mov_b32 v22, 0x3f803f80
    v_mov_b32 v23, 0x3f803f80
    v_mov_b32 v24, 0
    v_mov_b32 v25, 0
    v_mov_b32 v26, 0
    v_mov_b32 v27, 0
    v_mov_b32 v28, 0
    v_mov_b32 v29, 0
    v_mov_b32 v30, 0
    v_mov_b32 v31, 0
    v_mov_b32 v32, 0
    v_mov_b32 v33, 0
    v_mov_b32 v34, 0
    v_mov_b32 v35, 0
    v_mov_b32 v36, 0
    v_mov_b32 v37, 0
    v_mov_b32 v38, 0
    v_mov_b32 v39, 0
    v_mov_b32 v40, 0
    v_mov_b32 v41, 0
    v_mov_b32 v42, 0
    v_mov_b32 v43, 0
    v_mov_b32 v44, 0
    v_mov_b32 v45, 0
    v_mov_b32 v46, 0
    v_mov_b32 v47, 0
    v_mov_b32 v48, 0
    v_mov_b32 v49, 0
    v_mov_b32 v50, 0
    v_mov_b32 v51, 0
    v_mov_b32 v52, 0
    v_mov_b32 v53, 0
    v_mov_b32 v54, 0
    v_mov_b32 v55, 0
    v_mov_b32 v56, 0
    v_mov_b32 v57, 0
    v_mov_b32 v58, 0
    v_mov_b32 v59, 0
    v_mov_b32 v60, 0
    v_mov_b32 v61, 0
    v_mov_b32 v62, 0
    v_mov_b32 v63, 0
    v_mov_b32 v64, 0
    v_mov_b32 v65, 0
    v_mov_b32 v66, 0
    v_mov_b32 v67, 0
    v_mov_b32 v68, 0
    v_mov_b32 v69, 0
    v_mov_b32 v70, 0
    v_mov_b32 v71, 0
    v_mov_b32 v72, 0
    v_mov_b32 v73, 0
    v_mov_b32 v74, 0
    v_mov_b32 v75, 0
    v_mov_b32 v76, 0
    v_mov_b32 v77, 0
    v_mov_b32 v78, 0
    v_mov_b32 v79, 0
    v_mov_b32 v80, 0
    v_mov_b32 v81, 0
    v_mov_b32 v82, 0
    v_mov_b32 v83, 0
    v_mov_b32 v84, 0
    v_mov_b32 v85, 0
    v_mov_b32 v86, 0
    v_mov_b32 v87, 0
    v_mov_b32 v88, 0
    v_mov_b32 v89, 0
    v_mov_b32 v90, 0
    v_mov_b32 v91, 0
    v_mov_b32 v92, 0
    v_mov_b32 v93, 0
    v_mov_b32 v94, 0
    v_mov_b32 v95, 0
    v_mov_b32 v96, 0
    v_mov_b32 v97, 0
    v_mov_b32 v98, 0
    v_mov_b32 v99, 0
    v_mov_b32 v100, 0
    v_mov_b32 v101, 0
    v_mov_b32 v102, 0
    v_mov_b32 v103, 0
    v_mov_b32 v104, 0
    v_mov_b32 v105, 0
    v_mov_b32 v106, 0
    v_mov_b32 v107, 0
    v_mov_b32 v108, 0
    v_mov_b32 v109, 0
    v_mov_b32 v110, 0
    v_mov_b32 v111, 0
    v_mov_b32 v112, 0
    v_mov_b32 v113, 0
    v_mov_b32 v114, 0
    v_mov_b32 v115, 0
    v_mov_b32 v116, 0
    v_mov_b32 v117, 0
    v_mov_b32 v118, 0
    v_mov_b32 v119, 0
    v_mov_b32 v120, 0
    v_mov_b32 v121, 0
    v_mov_b32 v122, 0
    v_mov_b32 v123, 0
    v_mov_b32 v124, 0
    v_mov_b32 v125, 0
    v_mov_b32 v126, 0
    v_mov_b32 v127, 0
    v_mov_b32 v128, 0
    v_mov_b32 v129, 0
    v_mov_b32 v130, 0
    v_mov_b32 v131, 0
    v_mov_b32 v132, 0
    v_mov_b32 v133, 0
    v_mov_b32 v134, 0
    v_mov_b32 v135, 0
    v_mov_b32 v136, 0
    v_mov_b32 v137, 0
    v_mov_b32 v138, 0
    v_mov_b32 v139, 0
    v_mov_b32 v140, 0
    v_mov_b32 v141, 0
    v_mov_b32 v142, 0
    v_mov_b32 v143, 0
    v_mov_b32 v144, 0
    v_mov_b32 v145, 0
    v_mov_b32 v146, 0
    v_mov_b32 v147, 0
    v_mov_b32 v148, 0
    v_mov_b32 v149, 0
    v_mov_b32 v150, 0
    v_mov_b32 v151, 0
    v_add_u32 v240, 45056, v8
    v_add_u32 v241, 45056, v9
    v_add_u32 v242, 45056, v10
    v_add_u32 v243, 45056, v11
    v_add_u32 v244, 45056, v12
    v_add_u32 v245, 90112, v8
    v_add_u32 v246, 90112, v9
    v_add_u32 v247, 90112, v10
    v_add_u32 v248, 90112, v11
    v_add_u32 v249, 90112, v12
    s_mov_b32 s58, 0
    s_barrier
    ds_read_b64_tr_b16 v[168:169], v242 offset:0
    ds_read_b64_tr_b16 v[170:171], v242 offset:512
    ds_read_b128 v[152:155], v240 offset:0
    ds_read_b128 v[156:159], v240 offset:2048
    ds_read_b128 v[160:163], v240 offset:4096
    ds_read_b128 v[164:167], v240 offset:6144
    ds_read_b64_tr_b16 v[172:173], v243 offset:0
    ds_read_b64_tr_b16 v[174:175], v243 offset:512
    ds_read_b64_tr_b16 v[176:177], v242 offset:8192
    ds_read_b64_tr_b16 v[178:179], v242 offset:8704
    ds_read_b64_tr_b16 v[180:181], v243 offset:8192
    ds_read_b64_tr_b16 v[182:183], v243 offset:8704
    ds_read_b64_tr_b16 v[184:185], v242 offset:16384
    ds_read_b64_tr_b16 v[186:187], v242 offset:16896
    ds_read_b64_tr_b16 v[188:189], v243 offset:16384
    ds_read_b64_tr_b16 v[190:191], v243 offset:16896
    ds_read_b64_tr_b16 v[192:193], v244 offset:0
    ds_read_b64_tr_b16 v[194:195], v244 offset:256
    s_waitcnt lgkmcnt(0)
Lcl_27:
    v_mfma_f32_16x16x32_bf16 v[24:27], v[168:171], v[152:155], v[24:27]
    ds_read_b64_tr_b16 v[212:213], v242 offset:4096
    v_mfma_f32_16x16x32_bf16 v[28:31], v[168:171], v[156:159], v[28:31]
    ds_read_b64_tr_b16 v[214:215], v242 offset:4608
    v_mfma_f32_16x16x32_bf16 v[32:35], v[168:171], v[160:163], v[32:35]
    ds_read_b128 v[196:199], v241 offset:0
    v_mfma_f32_16x16x32_bf16 v[36:39], v[168:171], v[164:167], v[36:39]
    v_mfma_f32_16x16x32_bf16 v[136:139], v[168:171], v[20:23], v[136:139]
    ds_read_b128 v[200:203], v241 offset:2048
    v_mfma_f32_16x16x32_bf16 v[40:43], v[172:175], v[152:155], v[40:43]
    ds_read_b128 v[204:207], v241 offset:4096
    v_mfma_f32_16x16x32_bf16 v[44:47], v[172:175], v[156:159], v[44:47]
    v_mfma_f32_16x16x32_bf16 v[48:51], v[172:175], v[160:163], v[48:51]
    ds_read_b128 v[208:211], v241 offset:6144
    v_mfma_f32_16x16x32_bf16 v[52:55], v[172:175], v[164:167], v[52:55]
    ds_read_b64_tr_b16 v[216:217], v243 offset:4096
    v_mfma_f32_16x16x32_bf16 v[56:59], v[176:179], v[152:155], v[56:59]
    v_mfma_f32_16x16x32_bf16 v[60:63], v[176:179], v[156:159], v[60:63]
    ds_read_b64_tr_b16 v[218:219], v243 offset:4608
    v_mfma_f32_16x16x32_bf16 v[64:67], v[176:179], v[160:163], v[64:67]
    ds_read_b64_tr_b16 v[220:221], v242 offset:12288
    v_mfma_f32_16x16x32_bf16 v[68:71], v[176:179], v[164:167], v[68:71]
    v_mfma_f32_16x16x32_bf16 v[140:143], v[176:179], v[20:23], v[140:143]
    ds_read_b64_tr_b16 v[222:223], v242 offset:12800
    v_mfma_f32_16x16x32_bf16 v[72:75], v[180:183], v[152:155], v[72:75]
    ds_read_b64_tr_b16 v[224:225], v243 offset:12288
    v_mfma_f32_16x16x32_bf16 v[76:79], v[180:183], v[156:159], v[76:79]
    ds_read_b64_tr_b16 v[226:227], v243 offset:12800
    v_mfma_f32_16x16x32_bf16 v[80:83], v[180:183], v[160:163], v[80:83]
    v_mfma_f32_16x16x32_bf16 v[84:87], v[180:183], v[164:167], v[84:87]
    ds_read_b64_tr_b16 v[228:229], v242 offset:20480
    v_mfma_f32_16x16x32_bf16 v[88:91], v[184:187], v[152:155], v[88:91]
    ds_read_b64_tr_b16 v[230:231], v242 offset:20992
    v_mfma_f32_16x16x32_bf16 v[92:95], v[184:187], v[156:159], v[92:95]
    v_mfma_f32_16x16x32_bf16 v[96:99], v[184:187], v[160:163], v[96:99]
    ds_read_b64_tr_b16 v[232:233], v243 offset:20480
    v_mfma_f32_16x16x32_bf16 v[100:103], v[184:187], v[164:167], v[100:103]
    ds_read_b64_tr_b16 v[234:235], v243 offset:20992
    v_mfma_f32_16x16x32_bf16 v[144:147], v[184:187], v[20:23], v[144:147]
    v_mfma_f32_16x16x32_bf16 v[104:107], v[188:191], v[152:155], v[104:107]
    ds_read_b64_tr_b16 v[236:237], v244 offset:2048
    v_mfma_f32_16x16x32_bf16 v[108:111], v[188:191], v[156:159], v[108:111]
    ds_read_b64_tr_b16 v[238:239], v244 offset:2304
    v_mfma_f32_16x16x32_bf16 v[112:115], v[188:191], v[160:163], v[112:115]
    v_mfma_f32_16x16x32_bf16 v[116:119], v[188:191], v[164:167], v[116:119]
    v_mfma_f32_16x16x32_bf16 v[120:123], v[192:195], v[152:155], v[120:123]
    v_mfma_f32_16x16x32_bf16 v[124:127], v[192:195], v[156:159], v[124:127]
    v_mfma_f32_16x16x32_bf16 v[128:131], v[192:195], v[160:163], v[128:131]
    v_mfma_f32_16x16x32_bf16 v[132:135], v[192:195], v[164:167], v[132:135]
    s_add_u32 s58, s58, 1
    v_mfma_f32_16x16x32_bf16 v[148:151], v[192:195], v[20:23], v[148:151]
    s_waitcnt lgkmcnt(0)
    s_barrier
    v_mfma_f32_16x16x32_bf16 v[24:27], v[212:215], v[196:199], v[24:27]
    ds_read_b64_tr_b16 v[168:169], v247 offset:0
    v_mfma_f32_16x16x32_bf16 v[28:31], v[212:215], v[200:203], v[28:31]
    ds_read_b64_tr_b16 v[170:171], v247 offset:512
    v_mfma_f32_16x16x32_bf16 v[32:35], v[212:215], v[204:207], v[32:35]
    ds_read_b128 v[152:155], v245 offset:0
    v_mfma_f32_16x16x32_bf16 v[36:39], v[212:215], v[208:211], v[36:39]
    v_mfma_f32_16x16x32_bf16 v[136:139], v[212:215], v[20:23], v[136:139]
    ds_read_b128 v[156:159], v245 offset:2048
    v_mfma_f32_16x16x32_bf16 v[40:43], v[216:219], v[196:199], v[40:43]
    ds_read_b128 v[160:163], v245 offset:4096
    v_mfma_f32_16x16x32_bf16 v[44:47], v[216:219], v[200:203], v[44:47]
    v_mfma_f32_16x16x32_bf16 v[48:51], v[216:219], v[204:207], v[48:51]
    ds_read_b128 v[164:167], v245 offset:6144
    v_mfma_f32_16x16x32_bf16 v[52:55], v[216:219], v[208:211], v[52:55]
    ds_read_b64_tr_b16 v[172:173], v248 offset:0
    v_mfma_f32_16x16x32_bf16 v[56:59], v[220:223], v[196:199], v[56:59]
    v_mfma_f32_16x16x32_bf16 v[60:63], v[220:223], v[200:203], v[60:63]
    ds_read_b64_tr_b16 v[174:175], v248 offset:512
    v_mfma_f32_16x16x32_bf16 v[64:67], v[220:223], v[204:207], v[64:67]
    ds_read_b64_tr_b16 v[176:177], v247 offset:8192
    v_mfma_f32_16x16x32_bf16 v[68:71], v[220:223], v[208:211], v[68:71]
    v_mfma_f32_16x16x32_bf16 v[140:143], v[220:223], v[20:23], v[140:143]
    ds_read_b64_tr_b16 v[178:179], v247 offset:8704
    v_mfma_f32_16x16x32_bf16 v[72:75], v[224:227], v[196:199], v[72:75]
    ds_read_b64_tr_b16 v[180:181], v248 offset:8192
    v_mfma_f32_16x16x32_bf16 v[76:79], v[224:227], v[200:203], v[76:79]
    ds_read_b64_tr_b16 v[182:183], v248 offset:8704
    v_mfma_f32_16x16x32_bf16 v[80:83], v[224:227], v[204:207], v[80:83]
    v_mfma_f32_16x16x32_bf16 v[84:87], v[224:227], v[208:211], v[84:87]
    ds_read_b64_tr_b16 v[184:185], v247 offset:16384
    v_mfma_f32_16x16x32_bf16 v[88:91], v[228:231], v[196:199], v[88:91]
    ds_read_b64_tr_b16 v[186:187], v247 offset:16896
    v_mfma_f32_16x16x32_bf16 v[92:95], v[228:231], v[200:203], v[92:95]
    v_mfma_f32_16x16x32_bf16 v[96:99], v[228:231], v[204:207], v[96:99]
    ds_read_b64_tr_b16 v[188:189], v248 offset:16384
    v_mfma_f32_16x16x32_bf16 v[100:103], v[228:231], v[208:211], v[100:103]
    ds_read_b64_tr_b16 v[190:191], v248 offset:16896
    v_mfma_f32_16x16x32_bf16 v[144:147], v[228:231], v[20:23], v[144:147]
    v_mfma_f32_16x16x32_bf16 v[104:107], v[232:235], v[196:199], v[104:107]
    ds_read_b64_tr_b16 v[192:193], v249 offset:0
    v_mfma_f32_16x16x32_bf16 v[108:111], v[232:235], v[200:203], v[108:111]
    ds_read_b64_tr_b16 v[194:195], v249 offset:256
    v_mfma_f32_16x16x32_bf16 v[112:115], v[232:235], v[204:207], v[112:115]
    v_mfma_f32_16x16x32_bf16 v[116:119], v[232:235], v[208:211], v[116:119]
    v_mfma_f32_16x16x32_bf16 v[120:123], v[236:239], v[196:199], v[120:123]
    v_mfma_f32_16x16x32_bf16 v[124:127], v[236:239], v[200:203], v[124:127]
    v_mfma_f32_16x16x32_bf16 v[128:131], v[236:239], v[204:207], v[128:131]
    v_mfma_f32_16x16x32_bf16 v[132:135], v[236:239], v[208:211], v[132:135]
    s_cmp_lt_u32 s58, 16
    v_mfma_f32_16x16x32_bf16 v[148:151], v[236:239], v[20:23], v[148:151]
    s_waitcnt lgkmcnt(0)
    s_cbranch_scc0 Lcx_28
    v_mfma_f32_16x16x32_bf16 v[24:27], v[168:171], v[152:155], v[24:27]
    ds_read_b64_tr_b16 v[212:213], v247 offset:4096
    v_mfma_f32_16x16x32_bf16 v[28:31], v[168:171], v[156:159], v[28:31]
    ds_read_b64_tr_b16 v[214:215], v247 offset:4608
    v_mfma_f32_16x16x32_bf16 v[32:35], v[168:171], v[160:163], v[32:35]
    ds_read_b128 v[196:199], v246 offset:0
    v_mfma_f32_16x16x32_bf16 v[36:39], v[168:171], v[164:167], v[36:39]
    v_mfma_f32_16x16x32_bf16 v[136:139], v[168:171], v[20:23], v[136:139]
    ds_read_b128 v[200:203], v246 offset:2048
    v_mfma_f32_16x16x32_bf16 v[40:43], v[172:175], v[152:155], v[40:43]
    ds_read_b128 v[204:207], v246 offset:4096
    v_mfma_f32_16x16x32_bf16 v[44:47], v[172:175], v[156:159], v[44:47]
    v_mfma_f32_16x16x32_bf16 v[48:51], v[172:175], v[160:163], v[48:51]
    ds_read_b128 v[208:211], v246 offset:6144
    v_mfma_f32_16x16x32_bf16 v[52:55], v[172:175], v[164:167], v[52:55]
    ds_read_b64_tr_b16 v[216:217], v248 offset:4096
    v_mfma_f32_16x16x32_bf16 v[56:59], v[176:179], v[152:155], v[56:59]
    v_mfma_f32_16x16x32_bf16 v[60:63], v[176:179], v[156:159], v[60:63]
    ds_read_b64_tr_b16 v[218:219], v248 offset:4608
    v_mfma_f32_16x16x32_bf16 v[64:67], v[176:179], v[160:163], v[64:67]
    ds_read_b64_tr_b16 v[220:221], v247 offset:12288
    v_mfma_f32_16x16x32_bf16 v[68:71], v[176:179], v[164:167], v[68:71]
    v_mfma_f32_16x16x32_bf16 v[140:143], v[176:179], v[20:23], v[140:143]
    ds_read_b64_tr_b16 v[222:223], v247 offset:12800
    v_mfma_f32_16x16x32_bf16 v[72:75], v[180:183], v[152:155], v[72:75]
    ds_read_b64_tr_b16 v[224:225], v248 offset:12288
    v_mfma_f32_16x16x32_bf16 v[76:79], v[180:183], v[156:159], v[76:79]
    ds_read_b64_tr_b16 v[226:227], v248 offset:12800
    v_mfma_f32_16x16x32_bf16 v[80:83], v[180:183], v[160:163], v[80:83]
    v_mfma_f32_16x16x32_bf16 v[84:87], v[180:183], v[164:167], v[84:87]
    ds_read_b64_tr_b16 v[228:229], v247 offset:20480
    v_mfma_f32_16x16x32_bf16 v[88:91], v[184:187], v[152:155], v[88:91]
    ds_read_b64_tr_b16 v[230:231], v247 offset:20992
    v_mfma_f32_16x16x32_bf16 v[92:95], v[184:187], v[156:159], v[92:95]
    v_mfma_f32_16x16x32_bf16 v[96:99], v[184:187], v[160:163], v[96:99]
    ds_read_b64_tr_b16 v[232:233], v248 offset:20480
    v_mfma_f32_16x16x32_bf16 v[100:103], v[184:187], v[164:167], v[100:103]
    ds_read_b64_tr_b16 v[234:235], v248 offset:20992
    v_mfma_f32_16x16x32_bf16 v[144:147], v[184:187], v[20:23], v[144:147]
    v_mfma_f32_16x16x32_bf16 v[104:107], v[188:191], v[152:155], v[104:107]
    ds_read_b64_tr_b16 v[236:237], v249 offset:2048
    v_mfma_f32_16x16x32_bf16 v[108:111], v[188:191], v[156:159], v[108:111]
    ds_read_b64_tr_b16 v[238:239], v249 offset:2304
    v_mfma_f32_16x16x32_bf16 v[112:115], v[188:191], v[160:163], v[112:115]
    v_mfma_f32_16x16x32_bf16 v[116:119], v[188:191], v[164:167], v[116:119]
    v_mfma_f32_16x16x32_bf16 v[120:123], v[192:195], v[152:155], v[120:123]
    v_mfma_f32_16x16x32_bf16 v[124:127], v[192:195], v[156:159], v[124:127]
    v_mfma_f32_16x16x32_bf16 v[128:131], v[192:195], v[160:163], v[128:131]
    v_mfma_f32_16x16x32_bf16 v[132:135], v[192:195], v[164:167], v[132:135]
    s_add_u32 s58, s58, 1
    v_mfma_f32_16x16x32_bf16 v[148:151], v[192:195], v[20:23], v[148:151]
    s_waitcnt lgkmcnt(0)
    s_barrier
    v_mfma_f32_16x16x32_bf16 v[24:27], v[212:215], v[196:199], v[24:27]
    ds_read_b64_tr_b16 v[168:169], v10 offset:0
    v_mfma_f32_16x16x32_bf16 v[28:31], v[212:215], v[200:203], v[28:31]
    ds_read_b64_tr_b16 v[170:171], v10 offset:512
    v_mfma_f32_16x16x32_bf16 v[32:35], v[212:215], v[204:207], v[32:35]
    ds_read_b128 v[152:155], v8 offset:0
    v_mfma_f32_16x16x32_bf16 v[36:39], v[212:215], v[208:211], v[36:39]
    v_mfma_f32_16x16x32_bf16 v[136:139], v[212:215], v[20:23], v[136:139]
    ds_read_b128 v[156:159], v8 offset:2048
    v_mfma_f32_16x16x32_bf16 v[40:43], v[216:219], v[196:199], v[40:43]
    ds_read_b128 v[160:163], v8 offset:4096
    v_mfma_f32_16x16x32_bf16 v[44:47], v[216:219], v[200:203], v[44:47]
    v_mfma_f32_16x16x32_bf16 v[48:51], v[216:219], v[204:207], v[48:51]
    ds_read_b128 v[164:167], v8 offset:6144
    v_mfma_f32_16x16x32_bf16 v[52:55], v[216:219], v[208:211], v[52:55]
    ds_read_b64_tr_b16 v[172:173], v11 offset:0
    v_mfma_f32_16x16x32_bf16 v[56:59], v[220:223], v[196:199], v[56:59]
    v_mfma_f32_16x16x32_bf16 v[60:63], v[220:223], v[200:203], v[60:63]
    ds_read_b64_tr_b16 v[174:175], v11 offset:512
    v_mfma_f32_16x16x32_bf16 v[64:67], v[220:223], v[204:207], v[64:67]
    ds_read_b64_tr_b16 v[176:177], v10 offset:8192
    v_mfma_f32_16x16x32_bf16 v[68:71], v[220:223], v[208:211], v[68:71]
    v_mfma_f32_16x16x32_bf16 v[140:143], v[220:223], v[20:23], v[140:143]
    ds_read_b64_tr_b16 v[178:179], v10 offset:8704
    v_mfma_f32_16x16x32_bf16 v[72:75], v[224:227], v[196:199], v[72:75]
    ds_read_b64_tr_b16 v[180:181], v11 offset:8192
    v_mfma_f32_16x16x32_bf16 v[76:79], v[224:227], v[200:203], v[76:79]
    ds_read_b64_tr_b16 v[182:183], v11 offset:8704
    v_mfma_f32_16x16x32_bf16 v[80:83], v[224:227], v[204:207], v[80:83]
    v_mfma_f32_16x16x32_bf16 v[84:87], v[224:227], v[208:211], v[84:87]
    ds_read_b64_tr_b16 v[184:185], v10 offset:16384
    v_mfma_f32_16x16x32_bf16 v[88:91], v[228:231], v[196:199], v[88:91]
    ds_read_b64_tr_b16 v[186:187], v10 offset:16896
    v_mfma_f32_16x16x32_bf16 v[92:95], v[228:231], v[200:203], v[92:95]
    v_mfma_f32_16x16x32_bf16 v[96:99], v[228:231], v[204:207], v[96:99]
    ds_read_b64_tr_b16 v[188:189], v11 offset:16384
    v_mfma_f32_16x16x32_bf16 v[100:103], v[228:231], v[208:211], v[100:103]
    ds_read_b64_tr_b16 v[190:191], v11 offset:16896
    v_mfma_f32_16x16x32_bf16 v[144:147], v[228:231], v[20:23], v[144:147]
    v_mfma_f32_16x16x32_bf16 v[104:107], v[232:235], v[196:199], v[104:107]
    ds_read_b64_tr_b16 v[192:193], v12 offset:0
    v_mfma_f32_16x16x32_bf16 v[108:111], v[232:235], v[200:203], v[108:111]
    ds_read_b64_tr_b16 v[194:195], v12 offset:256
    v_mfma_f32_16x16x32_bf16 v[112:115], v[232:235], v[204:207], v[112:115]
    v_mfma_f32_16x16x32_bf16 v[116:119], v[232:235], v[208:211], v[116:119]
    v_mfma_f32_16x16x32_bf16 v[120:123], v[236:239], v[196:199], v[120:123]
    v_mfma_f32_16x16x32_bf16 v[124:127], v[236:239], v[200:203], v[124:127]
    v_mfma_f32_16x16x32_bf16 v[128:131], v[236:239], v[204:207], v[128:131]
    v_mfma_f32_16x16x32_bf16 v[132:135], v[236:239], v[208:211], v[132:135]
    v_mfma_f32_16x16x32_bf16 v[148:151], v[236:239], v[20:23], v[148:151]
    s_waitcnt lgkmcnt(0)
    v_mfma_f32_16x16x32_bf16 v[24:27], v[168:171], v[152:155], v[24:27]
    ds_read_b64_tr_b16 v[212:213], v10 offset:4096
    v_mfma_f32_16x16x32_bf16 v[28:31], v[168:171], v[156:159], v[28:31]
    ds_read_b64_tr_b16 v[214:215], v10 offset:4608
    v_mfma_f32_16x16x32_bf16 v[32:35], v[168:171], v[160:163], v[32:35]
    ds_read_b128 v[196:199], v9 offset:0
    v_mfma_f32_16x16x32_bf16 v[36:39], v[168:171], v[164:167], v[36:39]
    v_mfma_f32_16x16x32_bf16 v[136:139], v[168:171], v[20:23], v[136:139]
    ds_read_b128 v[200:203], v9 offset:2048
    v_mfma_f32_16x16x32_bf16 v[40:43], v[172:175], v[152:155], v[40:43]
    ds_read_b128 v[204:207], v9 offset:4096
    v_mfma_f32_16x16x32_bf16 v[44:47], v[172:175], v[156:159], v[44:47]
    v_mfma_f32_16x16x32_bf16 v[48:51], v[172:175], v[160:163], v[48:51]
    ds_read_b128 v[208:211], v9 offset:6144
    v_mfma_f32_16x16x32_bf16 v[52:55], v[172:175], v[164:167], v[52:55]
    ds_read_b64_tr_b16 v[216:217], v11 offset:4096
    v_mfma_f32_16x16x32_bf16 v[56:59], v[176:179], v[152:155], v[56:59]
    v_mfma_f32_16x16x32_bf16 v[60:63], v[176:179], v[156:159], v[60:63]
    ds_read_b64_tr_b16 v[218:219], v11 offset:4608
    v_mfma_f32_16x16x32_bf16 v[64:67], v[176:179], v[160:163], v[64:67]
    ds_read_b64_tr_b16 v[220:221], v10 offset:12288
    v_mfma_f32_16x16x32_bf16 v[68:71], v[176:179], v[164:167], v[68:71]
    v_mfma_f32_16x16x32_bf16 v[140:143], v[176:179], v[20:23], v[140:143]
    ds_read_b64_tr_b16 v[222:223], v10 offset:12800
    v_mfma_f32_16x16x32_bf16 v[72:75], v[180:183], v[152:155], v[72:75]
    ds_read_b64_tr_b16 v[224:225], v11 offset:12288
    v_mfma_f32_16x16x32_bf16 v[76:79], v[180:183], v[156:159], v[76:79]
    ds_read_b64_tr_b16 v[226:227], v11 offset:12800
    v_mfma_f32_16x16x32_bf16 v[80:83], v[180:183], v[160:163], v[80:83]
    v_mfma_f32_16x16x32_bf16 v[84:87], v[180:183], v[164:167], v[84:87]
    ds_read_b64_tr_b16 v[228:229], v10 offset:20480
    v_mfma_f32_16x16x32_bf16 v[88:91], v[184:187], v[152:155], v[88:91]
    ds_read_b64_tr_b16 v[230:231], v10 offset:20992
    v_mfma_f32_16x16x32_bf16 v[92:95], v[184:187], v[156:159], v[92:95]
    v_mfma_f32_16x16x32_bf16 v[96:99], v[184:187], v[160:163], v[96:99]
    ds_read_b64_tr_b16 v[232:233], v11 offset:20480
    v_mfma_f32_16x16x32_bf16 v[100:103], v[184:187], v[164:167], v[100:103]
    ds_read_b64_tr_b16 v[234:235], v11 offset:20992
    v_mfma_f32_16x16x32_bf16 v[144:147], v[184:187], v[20:23], v[144:147]
    v_mfma_f32_16x16x32_bf16 v[104:107], v[188:191], v[152:155], v[104:107]
    ds_read_b64_tr_b16 v[236:237], v12 offset:2048
    v_mfma_f32_16x16x32_bf16 v[108:111], v[188:191], v[156:159], v[108:111]
    ds_read_b64_tr_b16 v[238:239], v12 offset:2304
    v_mfma_f32_16x16x32_bf16 v[112:115], v[188:191], v[160:163], v[112:115]
    v_mfma_f32_16x16x32_bf16 v[116:119], v[188:191], v[164:167], v[116:119]
    v_mfma_f32_16x16x32_bf16 v[120:123], v[192:195], v[152:155], v[120:123]
    v_mfma_f32_16x16x32_bf16 v[124:127], v[192:195], v[156:159], v[124:127]
    v_mfma_f32_16x16x32_bf16 v[128:131], v[192:195], v[160:163], v[128:131]
    v_mfma_f32_16x16x32_bf16 v[132:135], v[192:195], v[164:167], v[132:135]
    s_add_u32 s58, s58, 1
    v_mfma_f32_16x16x32_bf16 v[148:151], v[192:195], v[20:23], v[148:151]
    s_waitcnt lgkmcnt(0)
    s_barrier
    v_mfma_f32_16x16x32_bf16 v[24:27], v[212:215], v[196:199], v[24:27]
    ds_read_b64_tr_b16 v[168:169], v242 offset:0
    v_mfma_f32_16x16x32_bf16 v[28:31], v[212:215], v[200:203], v[28:31]
    ds_read_b64_tr_b16 v[170:171], v242 offset:512
    v_mfma_f32_16x16x32_bf16 v[32:35], v[212:215], v[204:207], v[32:35]
    ds_read_b128 v[152:155], v240 offset:0
    v_mfma_f32_16x16x32_bf16 v[36:39], v[212:215], v[208:211], v[36:39]
    v_mfma_f32_16x16x32_bf16 v[136:139], v[212:215], v[20:23], v[136:139]
    ds_read_b128 v[156:159], v240 offset:2048
    v_mfma_f32_16x16x32_bf16 v[40:43], v[216:219], v[196:199], v[40:43]
    ds_read_b128 v[160:163], v240 offset:4096
    v_mfma_f32_16x16x32_bf16 v[44:47], v[216:219], v[200:203], v[44:47]
    v_mfma_f32_16x16x32_bf16 v[48:51], v[216:219], v[204:207], v[48:51]
    ds_read_b128 v[164:167], v240 offset:6144
    v_mfma_f32_16x16x32_bf16 v[52:55], v[216:219], v[208:211], v[52:55]
    ds_read_b64_tr_b16 v[172:173], v243 offset:0
    v_mfma_f32_16x16x32_bf16 v[56:59], v[220:223], v[196:199], v[56:59]
    v_mfma_f32_16x16x32_bf16 v[60:63], v[220:223], v[200:203], v[60:63]
    ds_read_b64_tr_b16 v[174:175], v243 offset:512
    v_mfma_f32_16x16x32_bf16 v[64:67], v[220:223], v[204:207], v[64:67]
    ds_read_b64_tr_b16 v[176:177], v242 offset:8192
    v_mfma_f32_16x16x32_bf16 v[68:71], v[220:223], v[208:211], v[68:71]
    v_mfma_f32_16x16x32_bf16 v[140:143], v[220:223], v[20:23], v[140:143]
    ds_read_b64_tr_b16 v[178:179], v242 offset:8704
    v_mfma_f32_16x16x32_bf16 v[72:75], v[224:227], v[196:199], v[72:75]
    ds_read_b64_tr_b16 v[180:181], v243 offset:8192
    v_mfma_f32_16x16x32_bf16 v[76:79], v[224:227], v[200:203], v[76:79]
    ds_read_b64_tr_b16 v[182:183], v243 offset:8704
    v_mfma_f32_16x16x32_bf16 v[80:83], v[224:227], v[204:207], v[80:83]
    v_mfma_f32_16x16x32_bf16 v[84:87], v[224:227], v[208:211], v[84:87]
    ds_read_b64_tr_b16 v[184:185], v242 offset:16384
    v_mfma_f32_16x16x32_bf16 v[88:91], v[228:231], v[196:199], v[88:91]
    ds_read_b64_tr_b16 v[186:187], v242 offset:16896
    v_mfma_f32_16x16x32_bf16 v[92:95], v[228:231], v[200:203], v[92:95]
    v_mfma_f32_16x16x32_bf16 v[96:99], v[228:231], v[204:207], v[96:99]
    ds_read_b64_tr_b16 v[188:189], v243 offset:16384
    v_mfma_f32_16x16x32_bf16 v[100:103], v[228:231], v[208:211], v[100:103]
    ds_read_b64_tr_b16 v[190:191], v243 offset:16896
    v_mfma_f32_16x16x32_bf16 v[144:147], v[228:231], v[20:23], v[144:147]
    v_mfma_f32_16x16x32_bf16 v[104:107], v[232:235], v[196:199], v[104:107]
    ds_read_b64_tr_b16 v[192:193], v244 offset:0
    v_mfma_f32_16x16x32_bf16 v[108:111], v[232:235], v[200:203], v[108:111]
    ds_read_b64_tr_b16 v[194:195], v244 offset:256
    v_mfma_f32_16x16x32_bf16 v[112:115], v[232:235], v[204:207], v[112:115]
    v_mfma_f32_16x16x32_bf16 v[116:119], v[232:235], v[208:211], v[116:119]
    v_mfma_f32_16x16x32_bf16 v[120:123], v[236:239], v[196:199], v[120:123]
    v_mfma_f32_16x16x32_bf16 v[124:127], v[236:239], v[200:203], v[124:127]
    v_mfma_f32_16x16x32_bf16 v[128:131], v[236:239], v[204:207], v[128:131]
    v_mfma_f32_16x16x32_bf16 v[132:135], v[236:239], v[208:211], v[132:135]
    v_mfma_f32_16x16x32_bf16 v[148:151], v[236:239], v[20:23], v[148:151]
    s_waitcnt lgkmcnt(0)
    s_branch Lcl_27
Lcx_28:
    ds_read_b128 v[152:155], v15 offset:0
    ds_read_b128 v[156:159], v15 offset:256
    ds_read_b128 v[160:163], v15 offset:512
    ds_read_b128 v[164:167], v15 offset:768
    v_xor_b32 v196, 64, v16
    v_xor_b32 v197, 32, v13
    v_add_u32 v198, 0x10000, v13
    v_xor_b32 v199, 32, v198
    v_cmp_eq_u32 vcc, 0, v1
    s_and_saveexec_b64 s[64:65], vcc
    ds_write_b128 v16, v[136:139] offset:0
    ds_write_b128 v16, v[140:143] offset:256
    ds_write_b128 v16, v[144:147] offset:512
    s_mov_b64 exec, s[64:65]
    s_waitcnt lgkmcnt(0)
    s_barrier
    ds_read_b128 v[168:171], v196 offset:0
    ds_read_b128 v[172:175], v196 offset:256
    ds_read_b128 v[176:179], v196 offset:512
    v_pk_fma_f32 v[120:121], v[148:149], v[152:153], v[120:121] op_sel_hi:[1,0,1] neg_lo:[0,1,0] neg_hi:[0,1,0]
    v_pk_fma_f32 v[122:123], v[150:151], v[152:153], v[122:123] op_sel_hi:[1,0,1] neg_lo:[0,1,0] neg_hi:[0,1,0]
    v_pk_fma_f32 v[124:125], v[148:149], v[156:157], v[124:125] op_sel_hi:[1,0,1] neg_lo:[0,1,0] neg_hi:[0,1,0]
    v_pk_fma_f32 v[126:127], v[150:151], v[156:157], v[126:127] op_sel_hi:[1,0,1] neg_lo:[0,1,0] neg_hi:[0,1,0]
    v_pk_mul_f32 v[180:181], v[120:121], v[154:155] op_sel_hi:[1,0]
    v_pk_mul_f32 v[182:183], v[122:123], v[154:155] op_sel_hi:[1,0]
    v_pk_mul_f32 v[184:185], v[124:125], v[158:159] op_sel_hi:[1,0]
    v_pk_mul_f32 v[186:187], v[126:127], v[158:159] op_sel_hi:[1,0]
    v_exp_f32 v180, v180
    v_exp_f32 v181, v181
    v_exp_f32 v182, v182
    v_exp_f32 v183, v183
    v_exp_f32 v184, v184
    v_exp_f32 v185, v185
    v_exp_f32 v186, v186
    v_exp_f32 v187, v187
    s_nop 0
    v_pk_fma_f32 v[180:181], v[180:181], v[152:153], v[152:153] op_sel:[0,1,1] op_sel_hi:[1,1,1]
    v_pk_fma_f32 v[182:183], v[182:183], v[152:153], v[152:153] op_sel:[0,1,1] op_sel_hi:[1,1,1]
    v_pk_fma_f32 v[184:185], v[184:185], v[156:157], v[156:157] op_sel:[0,1,1] op_sel_hi:[1,1,1]
    v_pk_fma_f32 v[186:187], v[186:187], v[156:157], v[156:157] op_sel:[0,1,1] op_sel_hi:[1,1,1]
    v_rcp_f32 v180, v180
    v_rcp_f32 v181, v181
    v_rcp_f32 v182, v182
    v_rcp_f32 v183, v183
    v_rcp_f32 v184, v184
    v_rcp_f32 v185, v185
    v_rcp_f32 v186, v186
    v_rcp_f32 v187, v187
    s_nop 0
    v_pk_mul_f32 v[120:121], v[120:121], v[180:181]
    v_pk_mul_f32 v[122:123], v[122:123], v[182:183]
    v_pk_mul_f32 v[124:125], v[124:125], v[184:185]
    v_pk_mul_f32 v[126:127], v[126:127], v[186:187]
    v_cvt_pk_bf16_f32 v120, v120, v121
    v_cvt_pk_bf16_f32 v121, v122, v123
    v_cvt_pk_bf16_f32 v124, v124, v125
    v_cvt_pk_bf16_f32 v125, v126, v127
    v_pk_fma_f32 v[128:129], v[148:149], v[160:161], v[128:129] op_sel_hi:[1,0,1] neg_lo:[0,1,0] neg_hi:[0,1,0]
    v_pk_fma_f32 v[130:131], v[150:151], v[160:161], v[130:131] op_sel_hi:[1,0,1] neg_lo:[0,1,0] neg_hi:[0,1,0]
    v_pk_fma_f32 v[132:133], v[148:149], v[164:165], v[132:133] op_sel_hi:[1,0,1] neg_lo:[0,1,0] neg_hi:[0,1,0]
    v_pk_fma_f32 v[134:135], v[150:151], v[164:165], v[134:135] op_sel_hi:[1,0,1] neg_lo:[0,1,0] neg_hi:[0,1,0]
    v_pk_mul_f32 v[180:181], v[128:129], v[162:163] op_sel_hi:[1,0]
    v_pk_mul_f32 v[182:183], v[130:131], v[162:163] op_sel_hi:[1,0]
    v_pk_mul_f32 v[184:185], v[132:133], v[166:167] op_sel_hi:[1,0]
    v_pk_mul_f32 v[186:187], v[134:135], v[166:167] op_sel_hi:[1,0]
    v_exp_f32 v180, v180
    v_exp_f32 v181, v181
    ds_write_b64 v14, v[120:121] offset:0
    v_exp_f32 v182, v182
    v_exp_f32 v183, v183
    ds_write_b64 v14, v[124:125] offset:1280
    v_exp_f32 v184, v184
    v_exp_f32 v185, v185
    v_exp_f32 v186, v186
    v_exp_f32 v187, v187
    s_nop 0
    v_pk_fma_f32 v[180:181], v[180:181], v[160:161], v[160:161] op_sel:[0,1,1] op_sel_hi:[1,1,1]
    v_pk_fma_f32 v[182:183], v[182:183], v[160:161], v[160:161] op_sel:[0,1,1] op_sel_hi:[1,1,1]
    v_pk_fma_f32 v[184:185], v[184:185], v[164:165], v[164:165] op_sel:[0,1,1] op_sel_hi:[1,1,1]
    v_pk_fma_f32 v[186:187], v[186:187], v[164:165], v[164:165] op_sel:[0,1,1] op_sel_hi:[1,1,1]
    v_rcp_f32 v180, v180
    v_rcp_f32 v181, v181
    v_rcp_f32 v182, v182
    v_rcp_f32 v183, v183
    v_rcp_f32 v184, v184
    v_rcp_f32 v185, v185
    v_rcp_f32 v186, v186
    v_rcp_f32 v187, v187
    s_nop 0
    v_pk_mul_f32 v[128:129], v[128:129], v[180:181]
    v_pk_mul_f32 v[130:131], v[130:131], v[182:183]
    v_pk_mul_f32 v[132:133], v[132:133], v[184:185]
    v_pk_mul_f32 v[134:135], v[134:135], v[186:187]
    v_cvt_pk_bf16_f32 v128, v128, v129
    v_cvt_pk_bf16_f32 v129, v130, v131
    v_cvt_pk_bf16_f32 v132, v132, v133
    v_cvt_pk_bf16_f32 v133, v134, v135
    ds_write_b64 v14, v[128:129] offset:2560
    ds_write_b64 v14, v[132:133] offset:3840
    s_waitcnt lgkmcnt(0)
    s_barrier
    v_pk_fma_f32 v[24:25], v[136:137], v[152:153], v[24:25] op_sel_hi:[1,0,1] neg_lo:[0,1,0] neg_hi:[0,1,0]
    v_pk_fma_f32 v[26:27], v[138:139], v[152:153], v[26:27] op_sel_hi:[1,0,1] neg_lo:[0,1,0] neg_hi:[0,1,0]
    v_pk_fma_f32 v[40:41], v[168:169], v[152:153], v[40:41] op_sel_hi:[1,0,1] neg_lo:[0,1,0] neg_hi:[0,1,0]
    v_pk_fma_f32 v[42:43], v[170:171], v[152:153], v[42:43] op_sel_hi:[1,0,1] neg_lo:[0,1,0] neg_hi:[0,1,0]
    v_pk_mul_f32 v[180:181], v[24:25], v[154:155] op_sel_hi:[1,0]
    v_pk_mul_f32 v[182:183], v[26:27], v[154:155] op_sel_hi:[1,0]
    v_pk_mul_f32 v[184:185], v[40:41], v[154:155] op_sel_hi:[1,0]
    v_pk_mul_f32 v[186:187], v[42:43], v[154:155] op_sel_hi:[1,0]
    v_exp_f32 v180, v180
    v_exp_f32 v181, v181
    v_exp_f32 v182, v182
    v_exp_f32 v183, v183
    v_exp_f32 v184, v184
    v_exp_f32 v185, v185
    v_exp_f32 v186, v186
    v_exp_f32 v187, v187
    s_nop 0
    v_pk_fma_f32 v[180:181], v[180:181], v[152:153], v[152:153] op_sel:[0,1,1] op_sel_hi:[1,1,1]
    v_pk_fma_f32 v[182:183], v[182:183], v[152:153], v[152:153] op_sel:[0,1,1] op_sel_hi:[1,1,1]
    v_pk_fma_f32 v[184:185], v[184:185], v[152:153], v[152:153] op_sel:[0,1,1] op_sel_hi:[1,1,1]
    v_pk_fma_f32 v[186:187], v[186:187], v[152:153], v[152:153] op_sel:[0,1,1] op_sel_hi:[1,1,1]
    v_rcp_f32 v180, v180
    v_rcp_f32 v181, v181
    v_rcp_f32 v182, v182
    v_rcp_f32 v183, v183
    v_rcp_f32 v184, v184
    v_rcp_f32 v185, v185
    v_rcp_f32 v186, v186
    v_rcp_f32 v187, v187
    s_nop 0
    v_pk_mul_f32 v[24:25], v[24:25], v[180:181]
    v_pk_mul_f32 v[26:27], v[26:27], v[182:183]
    v_pk_mul_f32 v[40:41], v[40:41], v[184:185]
    v_pk_mul_f32 v[42:43], v[42:43], v[186:187]
    v_cvt_pk_bf16_f32 v24, v24, v25
    v_cvt_pk_bf16_f32 v25, v26, v27
    v_cvt_pk_bf16_f32 v40, v40, v41
    v_cvt_pk_bf16_f32 v41, v42, v43
    v_pk_fma_f32 v[28:29], v[136:137], v[156:157], v[28:29] op_sel_hi:[1,0,1] neg_lo:[0,1,0] neg_hi:[0,1,0]
    v_pk_fma_f32 v[30:31], v[138:139], v[156:157], v[30:31] op_sel_hi:[1,0,1] neg_lo:[0,1,0] neg_hi:[0,1,0]
    v_pk_fma_f32 v[44:45], v[168:169], v[156:157], v[44:45] op_sel_hi:[1,0,1] neg_lo:[0,1,0] neg_hi:[0,1,0]
    v_pk_fma_f32 v[46:47], v[170:171], v[156:157], v[46:47] op_sel_hi:[1,0,1] neg_lo:[0,1,0] neg_hi:[0,1,0]
    v_pk_mul_f32 v[180:181], v[28:29], v[158:159] op_sel_hi:[1,0]
    v_pk_mul_f32 v[182:183], v[30:31], v[158:159] op_sel_hi:[1,0]
    v_pk_mul_f32 v[184:185], v[44:45], v[158:159] op_sel_hi:[1,0]
    v_pk_mul_f32 v[186:187], v[46:47], v[158:159] op_sel_hi:[1,0]
    v_exp_f32 v180, v180
    v_exp_f32 v181, v181
    ds_write_b64 v13, v[24:25] offset:0
    v_exp_f32 v182, v182
    v_exp_f32 v183, v183
    ds_write_b64 v197, v[40:41] offset:0
    v_exp_f32 v184, v184
    v_exp_f32 v185, v185
    v_exp_f32 v186, v186
    v_exp_f32 v187, v187
    s_nop 0
    v_pk_fma_f32 v[180:181], v[180:181], v[156:157], v[156:157] op_sel:[0,1,1] op_sel_hi:[1,1,1]
    v_pk_fma_f32 v[182:183], v[182:183], v[156:157], v[156:157] op_sel:[0,1,1] op_sel_hi:[1,1,1]
    v_pk_fma_f32 v[184:185], v[184:185], v[156:157], v[156:157] op_sel:[0,1,1] op_sel_hi:[1,1,1]
    v_pk_fma_f32 v[186:187], v[186:187], v[156:157], v[156:157] op_sel:[0,1,1] op_sel_hi:[1,1,1]
    v_rcp_f32 v180, v180
    v_rcp_f32 v181, v181
    v_rcp_f32 v182, v182
    v_rcp_f32 v183, v183
    v_rcp_f32 v184, v184
    v_rcp_f32 v185, v185
    v_rcp_f32 v186, v186
    v_rcp_f32 v187, v187
    s_nop 0
    v_pk_mul_f32 v[28:29], v[28:29], v[180:181]
    v_pk_mul_f32 v[30:31], v[30:31], v[182:183]
    v_pk_mul_f32 v[44:45], v[44:45], v[184:185]
    v_pk_mul_f32 v[46:47], v[46:47], v[186:187]
    v_cvt_pk_bf16_f32 v28, v28, v29
    v_cvt_pk_bf16_f32 v29, v30, v31
    v_cvt_pk_bf16_f32 v44, v44, v45
    v_cvt_pk_bf16_f32 v45, v46, v47
    v_pk_fma_f32 v[32:33], v[136:137], v[160:161], v[32:33] op_sel_hi:[1,0,1] neg_lo:[0,1,0] neg_hi:[0,1,0]
    v_pk_fma_f32 v[34:35], v[138:139], v[160:161], v[34:35] op_sel_hi:[1,0,1] neg_lo:[0,1,0] neg_hi:[0,1,0]
    v_pk_fma_f32 v[48:49], v[168:169], v[160:161], v[48:49] op_sel_hi:[1,0,1] neg_lo:[0,1,0] neg_hi:[0,1,0]
    v_pk_fma_f32 v[50:51], v[170:171], v[160:161], v[50:51] op_sel_hi:[1,0,1] neg_lo:[0,1,0] neg_hi:[0,1,0]
    v_pk_mul_f32 v[180:181], v[32:33], v[162:163] op_sel_hi:[1,0]
    v_pk_mul_f32 v[182:183], v[34:35], v[162:163] op_sel_hi:[1,0]
    v_pk_mul_f32 v[184:185], v[48:49], v[162:163] op_sel_hi:[1,0]
    v_pk_mul_f32 v[186:187], v[50:51], v[162:163] op_sel_hi:[1,0]
    v_exp_f32 v180, v180
    v_exp_f32 v181, v181
    ds_write_b64 v13, v[28:29] offset:2048
    v_exp_f32 v182, v182
    v_exp_f32 v183, v183
    ds_write_b64 v197, v[44:45] offset:2048
    v_exp_f32 v184, v184
    v_exp_f32 v185, v185
    v_exp_f32 v186, v186
    v_exp_f32 v187, v187
    s_nop 0
    v_pk_fma_f32 v[180:181], v[180:181], v[160:161], v[160:161] op_sel:[0,1,1] op_sel_hi:[1,1,1]
    v_pk_fma_f32 v[182:183], v[182:183], v[160:161], v[160:161] op_sel:[0,1,1] op_sel_hi:[1,1,1]
    v_pk_fma_f32 v[184:185], v[184:185], v[160:161], v[160:161] op_sel:[0,1,1] op_sel_hi:[1,1,1]
    v_pk_fma_f32 v[186:187], v[186:187], v[160:161], v[160:161] op_sel:[0,1,1] op_sel_hi:[1,1,1]
    v_rcp_f32 v180, v180
    v_rcp_f32 v181, v181
    v_rcp_f32 v182, v182
    v_rcp_f32 v183, v183
    v_rcp_f32 v184, v184
    v_rcp_f32 v185, v185
    v_rcp_f32 v186, v186
    v_rcp_f32 v187, v187
    s_nop 0
    v_pk_mul_f32 v[32:33], v[32:33], v[180:181]
    v_pk_mul_f32 v[34:35], v[34:35], v[182:183]
    v_pk_mul_f32 v[48:49], v[48:49], v[184:185]
    v_pk_mul_f32 v[50:51], v[50:51], v[186:187]
    v_cvt_pk_bf16_f32 v32, v32, v33
    v_cvt_pk_bf16_f32 v33, v34, v35
    v_cvt_pk_bf16_f32 v48, v48, v49
    v_cvt_pk_bf16_f32 v49, v50, v51
    v_pk_fma_f32 v[36:37], v[136:137], v[164:165], v[36:37] op_sel_hi:[1,0,1] neg_lo:[0,1,0] neg_hi:[0,1,0]
    v_pk_fma_f32 v[38:39], v[138:139], v[164:165], v[38:39] op_sel_hi:[1,0,1] neg_lo:[0,1,0] neg_hi:[0,1,0]
    v_pk_fma_f32 v[52:53], v[168:169], v[164:165], v[52:53] op_sel_hi:[1,0,1] neg_lo:[0,1,0] neg_hi:[0,1,0]
    v_pk_fma_f32 v[54:55], v[170:171], v[164:165], v[54:55] op_sel_hi:[1,0,1] neg_lo:[0,1,0] neg_hi:[0,1,0]
    v_pk_mul_f32 v[180:181], v[36:37], v[166:167] op_sel_hi:[1,0]
    v_pk_mul_f32 v[182:183], v[38:39], v[166:167] op_sel_hi:[1,0]
    v_pk_mul_f32 v[184:185], v[52:53], v[166:167] op_sel_hi:[1,0]
    v_pk_mul_f32 v[186:187], v[54:55], v[166:167] op_sel_hi:[1,0]
    v_exp_f32 v180, v180
    v_exp_f32 v181, v181
    ds_write_b64 v13, v[32:33] offset:4096
    v_exp_f32 v182, v182
    v_exp_f32 v183, v183
    ds_write_b64 v197, v[48:49] offset:4096
    v_exp_f32 v184, v184
    v_exp_f32 v185, v185
    v_exp_f32 v186, v186
    v_exp_f32 v187, v187
    s_nop 0
    v_pk_fma_f32 v[180:181], v[180:181], v[164:165], v[164:165] op_sel:[0,1,1] op_sel_hi:[1,1,1]
    v_pk_fma_f32 v[182:183], v[182:183], v[164:165], v[164:165] op_sel:[0,1,1] op_sel_hi:[1,1,1]
    v_pk_fma_f32 v[184:185], v[184:185], v[164:165], v[164:165] op_sel:[0,1,1] op_sel_hi:[1,1,1]
    v_pk_fma_f32 v[186:187], v[186:187], v[164:165], v[164:165] op_sel:[0,1,1] op_sel_hi:[1,1,1]
    v_rcp_f32 v180, v180
    v_rcp_f32 v181, v181
    v_rcp_f32 v182, v182
    v_rcp_f32 v183, v183
    v_rcp_f32 v184, v184
    v_rcp_f32 v185, v185
    v_rcp_f32 v186, v186
    v_rcp_f32 v187, v187
    s_nop 0
    v_pk_mul_f32 v[36:37], v[36:37], v[180:181]
    v_pk_mul_f32 v[38:39], v[38:39], v[182:183]
    v_pk_mul_f32 v[52:53], v[52:53], v[184:185]
    v_pk_mul_f32 v[54:55], v[54:55], v[186:187]
    v_cvt_pk_bf16_f32 v36, v36, v37
    v_cvt_pk_bf16_f32 v37, v38, v39
    v_cvt_pk_bf16_f32 v52, v52, v53
    v_cvt_pk_bf16_f32 v53, v54, v55
    ds_write_b64 v13, v[36:37] offset:6144
    ds_write_b64 v197, v[52:53] offset:6144
    s_waitcnt lgkmcnt(0)
    s_barrier
    v_pk_fma_f32 v[56:57], v[140:141], v[152:153], v[56:57] op_sel_hi:[1,0,1] neg_lo:[0,1,0] neg_hi:[0,1,0]
    v_pk_fma_f32 v[58:59], v[142:143], v[152:153], v[58:59] op_sel_hi:[1,0,1] neg_lo:[0,1,0] neg_hi:[0,1,0]
    v_pk_fma_f32 v[72:73], v[172:173], v[152:153], v[72:73] op_sel_hi:[1,0,1] neg_lo:[0,1,0] neg_hi:[0,1,0]
    v_pk_fma_f32 v[74:75], v[174:175], v[152:153], v[74:75] op_sel_hi:[1,0,1] neg_lo:[0,1,0] neg_hi:[0,1,0]
    v_pk_mul_f32 v[180:181], v[56:57], v[154:155] op_sel_hi:[1,0]
    v_pk_mul_f32 v[182:183], v[58:59], v[154:155] op_sel_hi:[1,0]
    v_pk_mul_f32 v[184:185], v[72:73], v[154:155] op_sel_hi:[1,0]
    v_pk_mul_f32 v[186:187], v[74:75], v[154:155] op_sel_hi:[1,0]
    v_exp_f32 v180, v180
    v_exp_f32 v181, v181
    v_exp_f32 v182, v182
    v_exp_f32 v183, v183
    v_exp_f32 v184, v184
    v_exp_f32 v185, v185
    v_exp_f32 v186, v186
    v_exp_f32 v187, v187
    s_nop 0
    v_pk_fma_f32 v[180:181], v[180:181], v[152:153], v[152:153] op_sel:[0,1,1] op_sel_hi:[1,1,1]
    v_pk_fma_f32 v[182:183], v[182:183], v[152:153], v[152:153] op_sel:[0,1,1] op_sel_hi:[1,1,1]
    v_pk_fma_f32 v[184:185], v[184:185], v[152:153], v[152:153] op_sel:[0,1,1] op_sel_hi:[1,1,1]
    v_pk_fma_f32 v[186:187], v[186:187], v[152:153], v[152:153] op_sel:[0,1,1] op_sel_hi:[1,1,1]
    v_rcp_f32 v180, v180
    v_rcp_f32 v181, v181
    v_rcp_f32 v182, v182
    v_rcp_f32 v183, v183
    v_rcp_f32 v184, v184
    v_rcp_f32 v185, v185
    v_rcp_f32 v186, v186
    v_rcp_f32 v187, v187
    s_nop 0
    v_pk_mul_f32 v[56:57], v[56:57], v[180:181]
    v_pk_mul_f32 v[58:59], v[58:59], v[182:183]
    v_pk_mul_f32 v[72:73], v[72:73], v[184:185]
    v_pk_mul_f32 v[74:75], v[74:75], v[186:187]
    v_cvt_pk_bf16_f32 v56, v56, v57
    v_cvt_pk_bf16_f32 v57, v58, v59
    v_cvt_pk_bf16_f32 v72, v72, v73
    v_cvt_pk_bf16_f32 v73, v74, v75
    v_pk_fma_f32 v[60:61], v[140:141], v[156:157], v[60:61] op_sel_hi:[1,0,1] neg_lo:[0,1,0] neg_hi:[0,1,0]
    v_pk_fma_f32 v[62:63], v[142:143], v[156:157], v[62:63] op_sel_hi:[1,0,1] neg_lo:[0,1,0] neg_hi:[0,1,0]
    v_pk_fma_f32 v[76:77], v[172:173], v[156:157], v[76:77] op_sel_hi:[1,0,1] neg_lo:[0,1,0] neg_hi:[0,1,0]
    v_pk_fma_f32 v[78:79], v[174:175], v[156:157], v[78:79] op_sel_hi:[1,0,1] neg_lo:[0,1,0] neg_hi:[0,1,0]
    v_pk_mul_f32 v[180:181], v[60:61], v[158:159] op_sel_hi:[1,0]
    v_pk_mul_f32 v[182:183], v[62:63], v[158:159] op_sel_hi:[1,0]
    v_pk_mul_f32 v[184:185], v[76:77], v[158:159] op_sel_hi:[1,0]
    v_pk_mul_f32 v[186:187], v[78:79], v[158:159] op_sel_hi:[1,0]
    v_exp_f32 v180, v180
    v_exp_f32 v181, v181
    ds_write_b64 v13, v[56:57] offset:32768
    v_exp_f32 v182, v182
    v_exp_f32 v183, v183
    ds_write_b64 v197, v[72:73] offset:32768
    v_exp_f32 v184, v184
    v_exp_f32 v185, v185
    v_exp_f32 v186, v186
    v_exp_f32 v187, v187
    s_nop 0
    v_pk_fma_f32 v[180:181], v[180:181], v[156:157], v[156:157] op_sel:[0,1,1] op_sel_hi:[1,1,1]
    v_pk_fma_f32 v[182:183], v[182:183], v[156:157], v[156:157] op_sel:[0,1,1] op_sel_hi:[1,1,1]
    v_pk_fma_f32 v[184:185], v[184:185], v[156:157], v[156:157] op_sel:[0,1,1] op_sel_hi:[1,1,1]
    v_pk_fma_f32 v[186:187], v[186:187], v[156:157], v[156:157] op_sel:[0,1,1] op_sel_hi:[1,1,1]
    v_rcp_f32 v180, v180
    v_rcp_f32 v181, v181
    v_rcp_f32 v182, v182
    v_rcp_f32 v183, v183
    v_rcp_f32 v184, v184
    v_rcp_f32 v185, v185
    v_rcp_f32 v186, v186
    v_rcp_f32 v187, v187
    s_nop 0
    v_pk_mul_f32 v[60:61], v[60:61], v[180:181]
    v_pk_mul_f32 v[62:63], v[62:63], v[182:183]
    v_pk_mul_f32 v[76:77], v[76:77], v[184:185]
    v_pk_mul_f32 v[78:79], v[78:79], v[186:187]
    v_cvt_pk_bf16_f32 v60, v60, v61
    v_cvt_pk_bf16_f32 v61, v62, v63
    v_cvt_pk_bf16_f32 v76, v76, v77
    v_cvt_pk_bf16_f32 v77, v78, v79
    v_pk_fma_f32 v[64:65], v[140:141], v[160:161], v[64:65] op_sel_hi:[1,0,1] neg_lo:[0,1,0] neg_hi:[0,1,0]
    v_pk_fma_f32 v[66:67], v[142:143], v[160:161], v[66:67] op_sel_hi:[1,0,1] neg_lo:[0,1,0] neg_hi:[0,1,0]
    v_pk_fma_f32 v[80:81], v[172:173], v[160:161], v[80:81] op_sel_hi:[1,0,1] neg_lo:[0,1,0] neg_hi:[0,1,0]
    v_pk_fma_f32 v[82:83], v[174:175], v[160:161], v[82:83] op_sel_hi:[1,0,1] neg_lo:[0,1,0] neg_hi:[0,1,0]
    v_pk_mul_f32 v[180:181], v[64:65], v[162:163] op_sel_hi:[1,0]
    v_pk_mul_f32 v[182:183], v[66:67], v[162:163] op_sel_hi:[1,0]
    v_pk_mul_f32 v[184:185], v[80:81], v[162:163] op_sel_hi:[1,0]
    v_pk_mul_f32 v[186:187], v[82:83], v[162:163] op_sel_hi:[1,0]
    v_exp_f32 v180, v180
    v_exp_f32 v181, v181
    ds_write_b64 v13, v[60:61] offset:34816
    v_exp_f32 v182, v182
    v_exp_f32 v183, v183
    ds_write_b64 v197, v[76:77] offset:34816
    v_exp_f32 v184, v184
    v_exp_f32 v185, v185
    v_exp_f32 v186, v186
    v_exp_f32 v187, v187
    s_nop 0
    v_pk_fma_f32 v[180:181], v[180:181], v[160:161], v[160:161] op_sel:[0,1,1] op_sel_hi:[1,1,1]
    v_pk_fma_f32 v[182:183], v[182:183], v[160:161], v[160:161] op_sel:[0,1,1] op_sel_hi:[1,1,1]
    v_pk_fma_f32 v[184:185], v[184:185], v[160:161], v[160:161] op_sel:[0,1,1] op_sel_hi:[1,1,1]
    v_pk_fma_f32 v[186:187], v[186:187], v[160:161], v[160:161] op_sel:[0,1,1] op_sel_hi:[1,1,1]
    v_rcp_f32 v180, v180
    v_rcp_f32 v181, v181
    v_rcp_f32 v182, v182
    v_rcp_f32 v183, v183
    v_rcp_f32 v184, v184
    v_rcp_f32 v185, v185
    v_rcp_f32 v186, v186
    v_rcp_f32 v187, v187
    s_nop 0
    v_pk_mul_f32 v[64:65], v[64:65], v[180:181]
    v_pk_mul_f32 v[66:67], v[66:67], v[182:183]
    v_pk_mul_f32 v[80:81], v[80:81], v[184:185]
    v_pk_mul_f32 v[82:83], v[82:83], v[186:187]
    v_cvt_pk_bf16_f32 v64, v64, v65
    v_cvt_pk_bf16_f32 v65, v66, v67
    v_cvt_pk_bf16_f32 v80, v80, v81
    v_cvt_pk_bf16_f32 v81, v82, v83
    v_pk_fma_f32 v[68:69], v[140:141], v[164:165], v[68:69] op_sel_hi:[1,0,1] neg_lo:[0,1,0] neg_hi:[0,1,0]
    v_pk_fma_f32 v[70:71], v[142:143], v[164:165], v[70:71] op_sel_hi:[1,0,1] neg_lo:[0,1,0] neg_hi:[0,1,0]
    v_pk_fma_f32 v[84:85], v[172:173], v[164:165], v[84:85] op_sel_hi:[1,0,1] neg_lo:[0,1,0] neg_hi:[0,1,0]
    v_pk_fma_f32 v[86:87], v[174:175], v[164:165], v[86:87] op_sel_hi:[1,0,1] neg_lo:[0,1,0] neg_hi:[0,1,0]
    v_pk_mul_f32 v[180:181], v[68:69], v[166:167] op_sel_hi:[1,0]
    v_pk_mul_f32 v[182:183], v[70:71], v[166:167] op_sel_hi:[1,0]
    v_pk_mul_f32 v[184:185], v[84:85], v[166:167] op_sel_hi:[1,0]
    v_pk_mul_f32 v[186:187], v[86:87], v[166:167] op_sel_hi:[1,0]
    v_exp_f32 v180, v180
    v_exp_f32 v181, v181
    ds_write_b64 v13, v[64:65] offset:36864
    v_exp_f32 v182, v182
    v_exp_f32 v183, v183
    ds_write_b64 v197, v[80:81] offset:36864
    v_exp_f32 v184, v184
    v_exp_f32 v185, v185
    v_exp_f32 v186, v186
    v_exp_f32 v187, v187
    s_nop 0
    v_pk_fma_f32 v[180:181], v[180:181], v[164:165], v[164:165] op_sel:[0,1,1] op_sel_hi:[1,1,1]
    v_pk_fma_f32 v[182:183], v[182:183], v[164:165], v[164:165] op_sel:[0,1,1] op_sel_hi:[1,1,1]
    v_pk_fma_f32 v[184:185], v[184:185], v[164:165], v[164:165] op_sel:[0,1,1] op_sel_hi:[1,1,1]
    v_pk_fma_f32 v[186:187], v[186:187], v[164:165], v[164:165] op_sel:[0,1,1] op_sel_hi:[1,1,1]
    v_rcp_f32 v180, v180
    v_rcp_f32 v181, v181
    v_rcp_f32 v182, v182
    v_rcp_f32 v183, v183
    v_rcp_f32 v184, v184
    v_rcp_f32 v185, v185
    v_rcp_f32 v186, v186
    v_rcp_f32 v187, v187
    s_nop 0
    v_pk_mul_f32 v[68:69], v[68:69], v[180:181]
    v_pk_mul_f32 v[70:71], v[70:71], v[182:183]
    v_pk_mul_f32 v[84:85], v[84:85], v[184:185]
    v_pk_mul_f32 v[86:87], v[86:87], v[186:187]
    v_cvt_pk_bf16_f32 v68, v68, v69
    v_cvt_pk_bf16_f32 v69, v70, v71
    v_cvt_pk_bf16_f32 v84, v84, v85
    v_cvt_pk_bf16_f32 v85, v86, v87
    ds_write_b64 v13, v[68:69] offset:38912
    ds_write_b64 v197, v[84:85] offset:38912
    s_waitcnt lgkmcnt(0)
    s_barrier
    v_pk_fma_f32 v[88:89], v[144:145], v[152:153], v[88:89] op_sel_hi:[1,0,1] neg_lo:[0,1,0] neg_hi:[0,1,0]
    v_pk_fma_f32 v[90:91], v[146:147], v[152:153], v[90:91] op_sel_hi:[1,0,1] neg_lo:[0,1,0] neg_hi:[0,1,0]
    v_pk_fma_f32 v[104:105], v[176:177], v[152:153], v[104:105] op_sel_hi:[1,0,1] neg_lo:[0,1,0] neg_hi:[0,1,0]
    v_pk_fma_f32 v[106:107], v[178:179], v[152:153], v[106:107] op_sel_hi:[1,0,1] neg_lo:[0,1,0] neg_hi:[0,1,0]
    v_pk_mul_f32 v[180:181], v[88:89], v[154:155] op_sel_hi:[1,0]
    v_pk_mul_f32 v[182:183], v[90:91], v[154:155] op_sel_hi:[1,0]
    v_pk_mul_f32 v[184:185], v[104:105], v[154:155] op_sel_hi:[1,0]
    v_pk_mul_f32 v[186:187], v[106:107], v[154:155] op_sel_hi:[1,0]
    v_exp_f32 v180, v180
    v_exp_f32 v181, v181
    v_exp_f32 v182, v182
    v_exp_f32 v183, v183
    v_exp_f32 v184, v184
    v_exp_f32 v185, v185
    v_exp_f32 v186, v186
    v_exp_f32 v187, v187
    s_nop 0
    v_pk_fma_f32 v[180:181], v[180:181], v[152:153], v[152:153] op_sel:[0,1,1] op_sel_hi:[1,1,1]
    v_pk_fma_f32 v[182:183], v[182:183], v[152:153], v[152:153] op_sel:[0,1,1] op_sel_hi:[1,1,1]
    v_pk_fma_f32 v[184:185], v[184:185], v[152:153], v[152:153] op_sel:[0,1,1] op_sel_hi:[1,1,1]
    v_pk_fma_f32 v[186:187], v[186:187], v[152:153], v[152:153] op_sel:[0,1,1] op_sel_hi:[1,1,1]
    v_rcp_f32 v180, v180
    v_rcp_f32 v181, v181
    v_rcp_f32 v182, v182
    v_rcp_f32 v183, v183
    v_rcp_f32 v184, v184
    v_rcp_f32 v185, v185
    v_rcp_f32 v186, v186
    v_rcp_f32 v187, v187
    s_nop 0
    v_pk_mul_f32 v[88:89], v[88:89], v[180:181]
    v_pk_mul_f32 v[90:91], v[90:91], v[182:183]
    v_pk_mul_f32 v[104:105], v[104:105], v[184:185]
    v_pk_mul_f32 v[106:107], v[106:107], v[186:187]
    v_cvt_pk_bf16_f32 v88, v88, v89
    v_cvt_pk_bf16_f32 v89, v90, v91
    v_cvt_pk_bf16_f32 v104, v104, v105
    v_cvt_pk_bf16_f32 v105, v106, v107
    v_pk_fma_f32 v[92:93], v[144:145], v[156:157], v[92:93] op_sel_hi:[1,0,1] neg_lo:[0,1,0] neg_hi:[0,1,0]
    v_pk_fma_f32 v[94:95], v[146:147], v[156:157], v[94:95] op_sel_hi:[1,0,1] neg_lo:[0,1,0] neg_hi:[0,1,0]
    v_pk_fma_f32 v[108:109], v[176:177], v[156:157], v[108:109] op_sel_hi:[1,0,1] neg_lo:[0,1,0] neg_hi:[0,1,0]
    v_pk_fma_f32 v[110:111], v[178:179], v[156:157], v[110:111] op_sel_hi:[1,0,1] neg_lo:[0,1,0] neg_hi:[0,1,0]
    v_pk_mul_f32 v[180:181], v[92:93], v[158:159] op_sel_hi:[1,0]
    v_pk_mul_f32 v[182:183], v[94:95], v[158:159] op_sel_hi:[1,0]
    v_pk_mul_f32 v[184:185], v[108:109], v[158:159] op_sel_hi:[1,0]
    v_pk_mul_f32 v[186:187], v[110:111], v[158:159] op_sel_hi:[1,0]
    v_exp_f32 v180, v180
    v_exp_f32 v181, v181
    ds_write_b64 v198, v[88:89] offset:0
    v_exp_f32 v182, v182
    v_exp_f32 v183, v183
    ds_write_b64 v199, v[104:105] offset:0
    v_exp_f32 v184, v184
    v_exp_f32 v185, v185
    v_exp_f32 v186, v186
    v_exp_f32 v187, v187
    s_nop 0
    v_pk_fma_f32 v[180:181], v[180:181], v[156:157], v[156:157] op_sel:[0,1,1] op_sel_hi:[1,1,1]
    v_pk_fma_f32 v[182:183], v[182:183], v[156:157], v[156:157] op_sel:[0,1,1] op_sel_hi:[1,1,1]
    v_pk_fma_f32 v[184:185], v[184:185], v[156:157], v[156:157] op_sel:[0,1,1] op_sel_hi:[1,1,1]
    v_pk_fma_f32 v[186:187], v[186:187], v[156:157], v[156:157] op_sel:[0,1,1] op_sel_hi:[1,1,1]
    v_rcp_f32 v180, v180
    v_rcp_f32 v181, v181
    v_rcp_f32 v182, v182
    v_rcp_f32 v183, v183
    v_rcp_f32 v184, v184
    v_rcp_f32 v185, v185
    v_rcp_f32 v186, v186
    v_rcp_f32 v187, v187
    s_nop 0
    v_pk_mul_f32 v[92:93], v[92:93], v[180:181]
    v_pk_mul_f32 v[94:95], v[94:95], v[182:183]
    v_pk_mul_f32 v[108:109], v[108:109], v[184:185]
    v_pk_mul_f32 v[110:111], v[110:111], v[186:187]
    v_cvt_pk_bf16_f32 v92, v92, v93
    v_cvt_pk_bf16_f32 v93, v94, v95
    v_cvt_pk_bf16_f32 v108, v108, v109
    v_cvt_pk_bf16_f32 v109, v110, v111
    v_pk_fma_f32 v[96:97], v[144:145], v[160:161], v[96:97] op_sel_hi:[1,0,1] neg_lo:[0,1,0] neg_hi:[0,1,0]
    v_pk_fma_f32 v[98:99], v[146:147], v[160:161], v[98:99] op_sel_hi:[1,0,1] neg_lo:[0,1,0] neg_hi:[0,1,0]
    v_pk_fma_f32 v[112:113], v[176:177], v[160:161], v[112:113] op_sel_hi:[1,0,1] neg_lo:[0,1,0] neg_hi:[0,1,0]
    v_pk_fma_f32 v[114:115], v[178:179], v[160:161], v[114:115] op_sel_hi:[1,0,1] neg_lo:[0,1,0] neg_hi:[0,1,0]
    v_pk_mul_f32 v[180:181], v[96:97], v[162:163] op_sel_hi:[1,0]
    v_pk_mul_f32 v[182:183], v[98:99], v[162:163] op_sel_hi:[1,0]
    v_pk_mul_f32 v[184:185], v[112:113], v[162:163] op_sel_hi:[1,0]
    v_pk_mul_f32 v[186:187], v[114:115], v[162:163] op_sel_hi:[1,0]
    v_exp_f32 v180, v180
    v_exp_f32 v181, v181
    ds_write_b64 v198, v[92:93] offset:2048
    v_exp_f32 v182, v182
    v_exp_f32 v183, v183
    ds_write_b64 v199, v[108:109] offset:2048
    v_exp_f32 v184, v184
    v_exp_f32 v185, v185
    v_exp_f32 v186, v186
    v_exp_f32 v187, v187
    s_nop 0
    v_pk_fma_f32 v[180:181], v[180:181], v[160:161], v[160:161] op_sel:[0,1,1] op_sel_hi:[1,1,1]
    v_pk_fma_f32 v[182:183], v[182:183], v[160:161], v[160:161] op_sel:[0,1,1] op_sel_hi:[1,1,1]
    v_pk_fma_f32 v[184:185], v[184:185], v[160:161], v[160:161] op_sel:[0,1,1] op_sel_hi:[1,1,1]
    v_pk_fma_f32 v[186:187], v[186:187], v[160:161], v[160:161] op_sel:[0,1,1] op_sel_hi:[1,1,1]
    v_rcp_f32 v180, v180
    v_rcp_f32 v181, v181
    v_rcp_f32 v182, v182
    v_rcp_f32 v183, v183
    v_rcp_f32 v184, v184
    v_rcp_f32 v185, v185
    v_rcp_f32 v186, v186
    v_rcp_f32 v187, v187
    s_nop 0
    v_pk_mul_f32 v[96:97], v[96:97], v[180:181]
    v_pk_mul_f32 v[98:99], v[98:99], v[182:183]
    v_pk_mul_f32 v[112:113], v[112:113], v[184:185]
    v_pk_mul_f32 v[114:115], v[114:115], v[186:187]
    v_cvt_pk_bf16_f32 v96, v96, v97
    v_cvt_pk_bf16_f32 v97, v98, v99
    v_cvt_pk_bf16_f32 v112, v112, v113
    v_cvt_pk_bf16_f32 v113, v114, v115
    v_pk_fma_f32 v[100:101], v[144:145], v[164:165], v[100:101] op_sel_hi:[1,0,1] neg_lo:[0,1,0] neg_hi:[0,1,0]
    v_pk_fma_f32 v[102:103], v[146:147], v[164:165], v[102:103] op_sel_hi:[1,0,1] neg_lo:[0,1,0] neg_hi:[0,1,0]
    v_pk_fma_f32 v[116:117], v[176:177], v[164:165], v[116:117] op_sel_hi:[1,0,1] neg_lo:[0,1,0] neg_hi:[0,1,0]
    v_pk_fma_f32 v[118:119], v[178:179], v[164:165], v[118:119] op_sel_hi:[1,0,1] neg_lo:[0,1,0] neg_hi:[0,1,0]
    v_pk_mul_f32 v[180:181], v[100:101], v[166:167] op_sel_hi:[1,0]
    v_pk_mul_f32 v[182:183], v[102:103], v[166:167] op_sel_hi:[1,0]
    v_pk_mul_f32 v[184:185], v[116:117], v[166:167] op_sel_hi:[1,0]
    v_pk_mul_f32 v[186:187], v[118:119], v[166:167] op_sel_hi:[1,0]
    v_exp_f32 v180, v180
    v_exp_f32 v181, v181
    ds_write_b64 v198, v[96:97] offset:4096
    v_exp_f32 v182, v182
    v_exp_f32 v183, v183
    ds_write_b64 v199, v[112:113] offset:4096
    v_exp_f32 v184, v184
    v_exp_f32 v185, v185
    v_exp_f32 v186, v186
    v_exp_f32 v187, v187
    s_nop 0
    v_pk_fma_f32 v[180:181], v[180:181], v[164:165], v[164:165] op_sel:[0,1,1] op_sel_hi:[1,1,1]
    v_pk_fma_f32 v[182:183], v[182:183], v[164:165], v[164:165] op_sel:[0,1,1] op_sel_hi:[1,1,1]
    v_pk_fma_f32 v[184:185], v[184:185], v[164:165], v[164:165] op_sel:[0,1,1] op_sel_hi:[1,1,1]
    v_pk_fma_f32 v[186:187], v[186:187], v[164:165], v[164:165] op_sel:[0,1,1] op_sel_hi:[1,1,1]
    v_rcp_f32 v180, v180
    v_rcp_f32 v181, v181
    v_rcp_f32 v182, v182
    v_rcp_f32 v183, v183
    v_rcp_f32 v184, v184
    v_rcp_f32 v185, v185
    v_rcp_f32 v186, v186
    v_rcp_f32 v187, v187
    s_nop 0
    v_pk_mul_f32 v[100:101], v[100:101], v[180:181]
    v_pk_mul_f32 v[102:103], v[102:103], v[182:183]
    v_pk_mul_f32 v[116:117], v[116:117], v[184:185]
    v_pk_mul_f32 v[118:119], v[118:119], v[186:187]
    v_cvt_pk_bf16_f32 v100, v100, v101
    v_cvt_pk_bf16_f32 v101, v102, v103
    v_cvt_pk_bf16_f32 v116, v116, v117
    v_cvt_pk_bf16_f32 v117, v118, v119
    ds_write_b64 v198, v[100:101] offset:6144
    ds_write_b64 v199, v[116:117] offset:6144
    s_waitcnt lgkmcnt(0)
    s_barrier
    s_branch P4_cons
P3_ld:
    s_setprio 3
    s_add_u32 s24, s56, 41943040
    s_addc_u32 s25, s57, 0
    s_mov_b32 s26, 262144
    s_mov_b32 s27, 0x20000
    v_lshl_add_u32 v11, s63, 6, v0
    s_lshl_b32 s61, s4, 14
    v_and_b32 v12, 1, v11
    v_lshlrev_b32 v12, 13, v12
    v_add_u32 v12, s61, v12
    v_lshrrev_b32 v11, 1, v11
    v_lshl_add_u32 v12, v11, 3, v12
    v_add_u32 v13, 4096, v12
    v_lshlrev_b32 v11, 4, v11
    v_add_u32 v11, 135168, v11
    v_subrev_u32 v239, 1, v0
    v_cmp_le_i32 vcc, s5, v239
    s_nop 1
    v_addc_co_u32 v239, vcc, 0, v239, vcc
    v_and_b32 v239, 15, v239
    s_mov_b32 s61, s76
    v_lshl_add_u32 v239, v239, 2, s61
    v_add_u32 v240, s36, v236
    s_add_u32 m0, s80, 45056
    s_nop 0
    buffer_load_dwordx4 v240, s[8:11], 0 offen sc1 lds
    s_add_u32 m0, s80, 49152
    s_nop 0
    buffer_load_dwordx4 v240, s[8:11], s81 offen sc1 lds
    s_add_u32 m0, s80, 53248
    s_nop 0
    buffer_load_dwordx4 v240, s[8:11], s82 offen sc1 lds
    s_add_u32 m0, s80, 57344
    s_nop 0
    buffer_load_dwordx4 v240, s[8:11], s83 offen sc1 lds
    s_cmp_le_u32 s5, 0
    s_addc_u32 s61, 0, 0
    s_mul_i32 s37, s61, 458752
    s_cmp_ge_u32 s61, 3
    s_addc_u32 s36, s61, 0
    s_cmp_ge_u32 s61, 10
    s_addc_u32 s61, s36, 0
    s_lshl_b32 s36, s61, 7
    v_add_u32 v241, s37, v237
    v_add_u32 v242, s37, v238
    s_add_u32 m0, s80, 106496
    s_nop 0
    buffer_load_dwordx4 v241, s[12:15], 0 offen  lds
    s_add_u32 m0, s80, 110592
    s_nop 0
    buffer_load_dwordx4 v241, s[12:15], s84 offen  lds
    s_add_u32 m0, s80, 114688
    s_nop 0
    buffer_load_dwordx4 v241, s[12:15], s85 offen  lds
    s_add_u32 m0, s80, 118784
    s_nop 0
    buffer_load_dwordx4 v241, s[12:15], s86 offen  lds
    s_add_u32 m0, s80, 122880
    s_nop 0
    buffer_load_dwordx4 v241, s[12:15], s87 offen  lds
    s_add_u32 m0, s80, 126976
    s_nop 0
    buffer_load_dwordx4 v241, s[12:15], s88 offen  lds
    s_add_u32 m0, s80, 131072
    s_nop 0
    buffer_load_dwordx4 v242, s[12:15], 0 offen  lds
    s_cmp_le_u32 s5, 1
    s_addc_u32 s61, 1, 0
    s_mul_i32 s37, s61, 458752
    s_cmp_ge_u32 s61, 3
    s_addc_u32 s36, s61, 0
    s_cmp_ge_u32 s61, 10
    s_addc_u32 s61, s36, 0
    s_lshl_b32 s36, s61, 7
    v_add_u32 v241, s37, v237
    v_add_u32 v242, s37, v238
    s_add_u32 m0, s80, 16384
    s_nop 0
    buffer_load_dwordx4 v241, s[12:15], 0 offen  lds
    s_add_u32 m0, s80, 20480
    s_nop 0
    buffer_load_dwordx4 v241, s[12:15], s84 offen  lds
    s_add_u32 m0, s80, 24576
    s_nop 0
    buffer_load_dwordx4 v241, s[12:15], s85 offen  lds
    s_add_u32 m0, s80, 28672
    s_nop 0
    buffer_load_dwordx4 v241, s[12:15], s86 offen  lds
    s_add_u32 m0, s80, 32768
    s_nop 0
    buffer_load_dwordx4 v241, s[12:15], s87 offen  lds
    s_add_u32 m0, s80, 36864
    s_nop 0
    buffer_load_dwordx4 v241, s[12:15], s88 offen  lds
    s_add_u32 m0, s80, 40960
    s_nop 0
    buffer_load_dwordx4 v242, s[12:15], 0 offen  lds
    s_mov_b32 s61, 4587964
    s_load_dwordx2 s[78:79], s[46:47], s61
    s_mov_b32 s61, 4588092
    s_load_dwordx2 s[78:79], s[46:47], s61
    s_mov_b32 s61, 4588220
    s_load_dwordx2 s[78:79], s[46:47], s61
    s_mov_b32 s61, 4588348
    s_load_dwordx2 s[78:79], s[46:47], s61
    s_mov_b32 s61, 5505084
    s_load_dwordx2 s[78:79], s[46:47], s61
    s_mov_b32 s61, 5505212
    s_load_dwordx2 s[78:79], s[46:47], s61
    s_mov_b32 s61, 5505340
    s_load_dwordx2 s[78:79], s[46:47], s61
    s_waitcnt vmcnt(14)
    s_barrier
    s_mov_b32 s59, 0
    s_bitcmp1_b32 s59, 1
    s_cbranch_scc1 Lpk_29
    s_mov_b32 s60, 20000
Lpk_29_p:
    buffer_load_dword v248, v239, s[32:35], 0 offen offset:128 sc1
    s_waitcnt vmcnt(0)
    v_cmp_ne_u32 vcc, 0, v248
    s_nop 1
    s_and_b32 s59, vcc_lo, 0xffff
    s_sub_u32 s60, s60, 1
    s_cselect_b32 s59, 0xffff, s59
    s_bitcmp1_b32 s59, 1
    s_cbranch_scc0 Lpk_29_p
Lpk_29:
    s_cmp_le_u32 s5, 0
    s_addc_u32 s61, 0, 0
    s_mul_i32 s37, s61, 458752
    s_cmp_ge_u32 s61, 3
    s_addc_u32 s36, s61, 0
    s_cmp_ge_u32 s61, 10
    s_addc_u32 s61, s36, 0
    s_lshl_b32 s36, s61, 7
    v_add_u32 v240, s36, v236
    s_add_u32 m0, s80, 90112
    s_nop 0
    buffer_load_dwordx4 v240, s[8:11], 0 offen sc1 lds
    s_add_u32 m0, s80, 94208
    s_nop 0
    buffer_load_dwordx4 v240, s[8:11], s81 offen sc1 lds
    s_add_u32 m0, s80, 98304
    s_nop 0
    buffer_load_dwordx4 v240, s[8:11], s82 offen sc1 lds
    s_add_u32 m0, s80, 102400
    s_nop 0
    buffer_load_dwordx4 v240, s[8:11], s83 offen sc1 lds
    s_bitcmp1_b32 s59, 2
    s_cbranch_scc1 Lpk_30
    s_mov_b32 s60, 20000
Lpk_30_p:
    buffer_load_dword v248, v239, s[32:35], 0 offen offset:128 sc1
    s_waitcnt vmcnt(0)
    v_cmp_ne_u32 vcc, 0, v248
    s_nop 1
    s_and_b32 s59, vcc_lo, 0xffff
    s_sub_u32 s60, s60, 1
    s_cselect_b32 s59, 0xffff, s59
    s_bitcmp1_b32 s59, 2
    s_cbranch_scc0 Lpk_30_p
Lpk_30:
    s_cmp_le_u32 s5, 1
    s_addc_u32 s61, 1, 0
    s_mul_i32 s37, s61, 458752
    s_cmp_ge_u32 s61, 3
    s_addc_u32 s36, s61, 0
    s_cmp_ge_u32 s61, 10
    s_addc_u32 s61, s36, 0
    s_lshl_b32 s36, s61, 7
    v_add_u32 v240, s36, v236
    s_add_u32 m0, s80, 0
    s_nop 0
    buffer_load_dwordx4 v240, s[8:11], 0 offen sc1 lds
    s_add_u32 m0, s80, 4096
    s_nop 0
    buffer_load_dwordx4 v240, s[8:11], s81 offen sc1 lds
    s_add_u32 m0, s80, 8192
    s_nop 0
    buffer_load_dwordx4 v240, s[8:11], s82 offen sc1 lds
    s_add_u32 m0, s80, 12288
    s_nop 0
    buffer_load_dwordx4 v240, s[8:11], s83 offen sc1 lds
    s_setprio 0
    s_waitcnt vmcnt(4)
    s_barrier
    s_bitcmp1_b32 s59, 3
    s_cbranch_scc1 Lpk_31
    s_mov_b32 s60, 20000
Lpk_31_p:
    buffer_load_dword v248, v239, s[32:35], 0 offen offset:128 sc1
    s_waitcnt vmcnt(0)
    v_cmp_ne_u32 vcc, 0, v248
    s_nop 1
    s_and_b32 s59, vcc_lo, 0xffff
    s_sub_u32 s60, s60, 1
    s_cselect_b32 s59, 0xffff, s59
    s_bitcmp1_b32 s59, 3
    s_cbranch_scc0 Lpk_31_p
Lpk_31:
    s_cmp_le_u32 s5, 2
    s_addc_u32 s61, 2, 0
    s_mul_i32 s37, s61, 458752
    s_cmp_ge_u32 s61, 3
    s_addc_u32 s36, s61, 0
    s_cmp_ge_u32 s61, 10
    s_addc_u32 s61, s36, 0
    s_lshl_b32 s36, s61, 7
    v_add_u32 v240, s36, v236
    s_add_u32 m0, s80, 45056
    s_nop 0
    buffer_load_dwordx4 v240, s[8:11], 0 offen sc1 lds
    s_add_u32 m0, s80, 49152
    s_nop 0
    buffer_load_dwordx4 v240, s[8:11], s81 offen sc1 lds
    s_add_u32 m0, s80, 53248
    s_nop 0
    buffer_load_dwordx4 v240, s[8:11], s82 offen sc1 lds
    s_add_u32 m0, s80, 57344
    s_nop 0
    buffer_load_dwordx4 v240, s[8:11], s83 offen sc1 lds
    v_add_u32 v241, s37, v237
    v_add_u32 v242, s37, v238
    s_add_u32 m0, s80, 61440
    s_nop 0
    buffer_load_dwordx4 v241, s[12:15], 0 offen  lds
    s_add_u32 m0, s80, 65536
    s_nop 0
    buffer_load_dwordx4 v241, s[12:15], s84 offen  lds
    s_add_u32 m0, s80, 69632
    s_nop 0
    buffer_load_dwordx4 v241, s[12:15], s85 offen  lds
    s_add_u32 m0, s80, 73728
    s_nop 0
    buffer_load_dwordx4 v241, s[12:15], s86 offen  lds
    s_add_u32 m0, s80, 77824
    s_nop 0
    buffer_load_dwordx4 v241, s[12:15], s87 offen  lds
    s_add_u32 m0, s80, 81920
    s_nop 0
    buffer_load_dwordx4 v241, s[12:15], s88 offen  lds
    s_add_u32 m0, s80, 86016
    s_nop 0
    buffer_load_dwordx4 v242, s[12:15], 0 offen  lds
    s_mov_b32 s61, 5505468
    s_load_dwordx2 s[78:79], s[46:47], s61
    s_mov_b32 s61, 5505596
    s_load_dwordx2 s[78:79], s[46:47], s61
    s_mov_b32 s61, 5505724
    s_load_dwordx2 s[78:79], s[46:47], s61
    s_mov_b32 s61, 5505852
    s_load_dwordx2 s[78:79], s[46:47], s61
    s_mov_b32 s61, 6422588
    s_load_dwordx2 s[78:79], s[46:47], s61
    s_waitcnt vmcnt(11)
    s_barrier
    s_bitcmp1_b32 s59, 4
    s_cbranch_scc1 Lpk_32
    s_mov_b32 s60, 20000
Lpk_32_p:
    buffer_load_dword v248, v239, s[32:35], 0 offen offset:128 sc1
    s_waitcnt vmcnt(0)
    v_cmp_ne_u32 vcc, 0, v248
    s_nop 1
    s_and_b32 s59, vcc_lo, 0xffff
    s_sub_u32 s60, s60, 1
    s_cselect_b32 s59, 0xffff, s59
    s_bitcmp1_b32 s59, 4
    s_cbranch_scc0 Lpk_32_p
Lpk_32:
    s_cmp_le_u32 s5, 3
    s_addc_u32 s61, 3, 0
    s_mul_i32 s37, s61, 458752
    s_cmp_ge_u32 s61, 3
    s_addc_u32 s36, s61, 0
    s_cmp_ge_u32 s61, 10
    s_addc_u32 s61, s36, 0
    s_lshl_b32 s36, s61, 7
    v_add_u32 v240, s36, v236
    s_add_u32 m0, s80, 90112
    s_nop 0
    buffer_load_dwordx4 v240, s[8:11], 0 offen sc1 lds
    s_add_u32 m0, s80, 94208
    s_nop 0
    buffer_load_dwordx4 v240, s[8:11], s81 offen sc1 lds
    s_add_u32 m0, s80, 98304
    s_nop 0
    buffer_load_dwordx4 v240, s[8:11], s82 offen sc1 lds
    s_add_u32 m0, s80, 102400
    s_nop 0
    buffer_load_dwordx4 v240, s[8:11], s83 offen sc1 lds
    v_add_u32 v241, s37, v237
    v_add_u32 v242, s37, v238
    s_add_u32 m0, s80, 106496
    s_nop 0
    buffer_load_dwordx4 v241, s[12:15], 0 offen  lds
    s_add_u32 m0, s80, 110592
    s_nop 0
    buffer_load_dwordx4 v241, s[12:15], s84 offen  lds
    s_add_u32 m0, s80, 114688
    s_nop 0
    buffer_load_dwordx4 v241, s[12:15], s85 offen  lds
    s_add_u32 m0, s80, 118784
    s_nop 0
    buffer_load_dwordx4 v241, s[12:15], s86 offen  lds
    s_add_u32 m0, s80, 122880
    s_nop 0
    buffer_load_dwordx4 v241, s[12:15], s87 offen  lds
    s_add_u32 m0, s80, 126976
    s_nop 0
    buffer_load_dwordx4 v241, s[12:15], s88 offen  lds
    s_add_u32 m0, s80, 131072
    s_nop 0
    buffer_load_dwordx4 v242, s[12:15], 0 offen  lds
    s_mov_b32 s61, 6422716
    s_load_dwordx2 s[78:79], s[46:47], s61
    s_mov_b32 s61, 6422844
    s_load_dwordx2 s[78:79], s[46:47], s61
    s_mov_b32 s61, 6422972
    s_load_dwordx2 s[78:79], s[46:47], s61
    s_mov_b32 s61, 6423100
    s_load_dwordx2 s[78:79], s[46:47], s61
    s_mov_b32 s61, 6423228
    s_load_dwordx2 s[78:79], s[46:47], s61
    s_waitcnt vmcnt(11)
    s_barrier
    s_bitcmp1_b32 s59, 5
    s_cbranch_scc1 Lpk_33
    s_mov_b32 s60, 20000
Lpk_33_p:
    buffer_load_dword v248, v239, s[32:35], 0 offen offset:128 sc1
    s_waitcnt vmcnt(0)
    v_cmp_ne_u32 vcc, 0, v248
    s_nop 1
    s_and_b32 s59, vcc_lo, 0xffff
    s_sub_u32 s60, s60, 1
    s_cselect_b32 s59, 0xffff, s59
    s_bitcmp1_b32 s59, 5
    s_cbranch_scc0 Lpk_33_p
Lpk_33:
    s_cmp_le_u32 s5, 4
    s_addc_u32 s61, 4, 0
    s_mul_i32 s37, s61, 458752
    s_cmp_ge_u32 s61, 3
    s_addc_u32 s36, s61, 0
    s_cmp_ge_u32 s61, 10
    s_addc_u32 s61, s36, 0
    s_lshl_b32 s36, s61, 7
    v_add_u32 v240, s36, v236
    s_add_u32 m0, s80, 0
    s_nop 0
    buffer_load_dwordx4 v240, s[8:11], 0 offen sc1 lds
    s_add_u32 m0, s80, 4096
    s_nop 0
    buffer_load_dwordx4 v240, s[8:11], s81 offen sc1 lds
    s_add_u32 m0, s80, 8192
    s_nop 0
    buffer_load_dwordx4 v240, s[8:11], s82 offen sc1 lds
    s_add_u32 m0, s80, 12288
    s_nop 0
    buffer_load_dwordx4 v240, s[8:11], s83 offen sc1 lds
    v_add_u32 v241, s37, v237
    v_add_u32 v242, s37, v238
    s_add_u32 m0, s80, 16384
    s_nop 0
    buffer_load_dwordx4 v241, s[12:15], 0 offen  lds
    s_add_u32 m0, s80, 20480
    s_nop 0
    buffer_load_dwordx4 v241, s[12:15], s84 offen  lds
    s_add_u32 m0, s80, 24576
    s_nop 0
    buffer_load_dwordx4 v241, s[12:15], s85 offen  lds
    s_add_u32 m0, s80, 28672
    s_nop 0
    buffer_load_dwordx4 v241, s[12:15], s86 offen  lds
    s_add_u32 m0, s80, 32768
    s_nop 0
    buffer_load_dwordx4 v241, s[12:15], s87 offen  lds
    s_add_u32 m0, s80, 36864
    s_nop 0
    buffer_load_dwordx4 v241, s[12:15], s88 offen  lds
    s_add_u32 m0, s80, 40960
    s_nop 0
    buffer_load_dwordx4 v242, s[12:15], 0 offen  lds
    s_mov_b32 s61, 6423356
    s_load_dwordx2 s[78:79], s[46:47], s61
    s_lshl_b32 s46, s2, 2
    s_add_u32 s46, s46, s63
    s_lshl_b32 s46, s46, 7
    s_add_u32 s46, s46, 640
    s_and_b32 s46, s46, 130944
    s_add_u32 s61, s46, 393276
    s_load_dwordx2 s[78:79], s[50:51], s61
    s_add_u32 s46, s46, 640
    s_and_b32 s46, s46, 130944
    s_add_u32 s61, s46, 4063292
    s_load_dwordx2 s[78:79], s[50:51], s61
    s_add_u32 s46, s46, 640
    s_and_b32 s46, s46, 130944
    s_add_u32 s61, s46, 1310780
    s_load_dwordx2 s[78:79], s[50:51], s61
    s_add_u32 s46, s46, 640
    s_and_b32 s46, s46, 130944
    s_add_u32 s61, s46, 4980796
    s_load_dwordx2 s[78:79], s[50:51], s61
    s_waitcnt vmcnt(11)
    s_barrier
    s_bitcmp1_b32 s59, 6
    s_cbranch_scc1 Lpk_34
    s_mov_b32 s60, 20000
Lpk_34_p:
    buffer_load_dword v248, v239, s[32:35], 0 offen offset:128 sc1
    s_waitcnt vmcnt(0)
    v_cmp_ne_u32 vcc, 0, v248
    s_nop 1
    s_and_b32 s59, vcc_lo, 0xffff
    s_sub_u32 s60, s60, 1
    s_cselect_b32 s59, 0xffff, s59
    s_bitcmp1_b32 s59, 6
    s_cbranch_scc0 Lpk_34_p
Lpk_34:
    s_cmp_le_u32 s5, 5
    s_addc_u32 s61, 5, 0
    s_mul_i32 s37, s61, 458752
    s_cmp_ge_u32 s61, 3
    s_addc_u32 s36, s61, 0
    s_cmp_ge_u32 s61, 10
    s_addc_u32 s61, s36, 0
    s_lshl_b32 s36, s61, 7
    v_add_u32 v240, s36, v236
    s_add_u32 m0, s80, 45056
    s_nop 0
    buffer_load_dwordx4 v240, s[8:11], 0 offen sc1 lds
    s_add_u32 m0, s80, 49152
    s_nop 0
    buffer_load_dwordx4 v240, s[8:11], s81 offen sc1 lds
    s_add_u32 m0, s80, 53248
    s_nop 0
    buffer_load_dwordx4 v240, s[8:11], s82 offen sc1 lds
    s_add_u32 m0, s80, 57344
    s_nop 0
    buffer_load_dwordx4 v240, s[8:11], s83 offen sc1 lds
    v_add_u32 v241, s37, v237
    v_add_u32 v242, s37, v238
    s_add_u32 m0, s80, 61440
    s_nop 0
    buffer_load_dwordx4 v241, s[12:15], 0 offen  lds
    s_add_u32 m0, s80, 65536
    s_nop 0
    buffer_load_dwordx4 v241, s[12:15], s84 offen  lds
    s_add_u32 m0, s80, 69632
    s_nop 0
    buffer_load_dwordx4 v241, s[12:15], s85 offen  lds
    s_add_u32 m0, s80, 73728
    s_nop 0
    buffer_load_dwordx4 v241, s[12:15], s86 offen  lds
    s_add_u32 m0, s80, 77824
    s_nop 0
    buffer_load_dwordx4 v241, s[12:15], s87 offen  lds
    s_add_u32 m0, s80, 81920
    s_nop 0
    buffer_load_dwordx4 v241, s[12:15], s88 offen  lds
    s_add_u32 m0, s80, 86016
    s_nop 0
    buffer_load_dwordx4 v242, s[12:15], 0 offen  lds
    s_add_u32 s46, s46, 640
    s_and_b32 s46, s46, 130944
    s_add_u32 s61, s46, 2228284
    s_load_dwordx2 s[78:79], s[50:51], s61
    s_add_u32 s46, s46, 640
    s_and_b32 s46, s46, 130944
    s_add_u32 s61, s46, 5898300
    s_load_dwordx2 s[78:79], s[50:51], s61
    s_add_u32 s46, s46, 640
    s_and_b32 s46, s46, 130944
    s_add_u32 s61, s46, 3145788
    s_load_dwordx2 s[78:79], s[50:51], s61
    s_add_u32 s46, s46, 640
    s_and_b32 s46, s46, 130944
    s_add_u32 s61, s46, 6815804
    s_load_dwordx2 s[78:79], s[50:51], s61
    s_add_u32 s46, s46, 640
    s_and_b32 s46, s46, 130944
    s_add_u32 s61, s46, 60
    s_load_dwordx2 s[78:79], s[50:51], s61
    s_waitcnt vmcnt(11)
    s_barrier
    s_bitcmp1_b32 s59, 7
    s_cbranch_scc1 Lpk_35
    s_mov_b32 s60, 20000
Lpk_35_p:
    buffer_load_dword v248, v239, s[32:35], 0 offen offset:128 sc1
    s_waitcnt vmcnt(0)
    v_cmp_ne_u32 vcc, 0, v248
    s_nop 1
    s_and_b32 s59, vcc_lo, 0xffff
    s_sub_u32 s60, s60, 1
    s_cselect_b32 s59, 0xffff, s59
    s_bitcmp1_b32 s59, 7
    s_cbranch_scc0 Lpk_35_p
Lpk_35:
    s_cmp_le_u32 s5, 6
    s_addc_u32 s61, 6, 0
    s_mul_i32 s37, s61, 458752
    s_cmp_ge_u32 s61, 3
    s_addc_u32 s36, s61, 0
    s_cmp_ge_u32 s61, 10
    s_addc_u32 s61, s36, 0
    s_lshl_b32 s36, s61, 7
    v_add_u32 v240, s36, v236
    s_add_u32 m0, s80, 90112
    s_nop 0
    buffer_load_dwordx4 v240, s[8:11], 0 offen sc1 lds
    s_add_u32 m0, s80, 94208
    s_nop 0
    buffer_load_dwordx4 v240, s[8:11], s81 offen sc1 lds
    s_add_u32 m0, s80, 98304
    s_nop 0
    buffer_load_dwordx4 v240, s[8:11], s82 offen sc1 lds
    s_add_u32 m0, s80, 102400
    s_nop 0
    buffer_load_dwordx4 v240, s[8:11], s83 offen sc1 lds
    v_add_u32 v241, s37, v237
    v_add_u32 v242, s37, v238
    s_add_u32 m0, s80, 106496
    s_nop 0
    buffer_load_dwordx4 v241, s[12:15], 0 offen  lds
    s_add_u32 m0, s80, 110592
    s_nop 0
    buffer_load_dwordx4 v241, s[12:15], s84 offen  lds
    s_add_u32 m0, s80, 114688
    s_nop 0
    buffer_load_dwordx4 v241, s[12:15], s85 offen  lds
    s_add_u32 m0, s80, 118784
    s_nop 0
    buffer_load_dwordx4 v241, s[12:15], s86 offen  lds
    s_add_u32 m0, s80, 122880
    s_nop 0
    buffer_load_dwordx4 v241, s[12:15], s87 offen  lds
    s_add_u32 m0, s80, 126976
    s_nop 0
    buffer_load_dwordx4 v241, s[12:15], s88 offen  lds
    s_add_u32 m0, s80, 131072
    s_nop 0
    buffer_load_dwordx4 v242, s[12:15], 0 offen  lds
    s_add_u32 s46, s46, 640
    s_and_b32 s46, s46, 130944
    s_add_u32 s61, s46, 3670076
    s_load_dwordx2 s[78:79], s[50:51], s61
    s_add_u32 s46, s46, 640
    s_and_b32 s46, s46, 130944
    s_add_u32 s61, s46, 524348
    s_load_dwordx2 s[78:79], s[50:51], s61
    s_add_u32 s46, s46, 640
    s_and_b32 s46, s46, 130944
    s_add_u32 s61, s46, 4194364
    s_load_dwordx2 s[78:79], s[50:51], s61
    s_add_u32 s46, s46, 640
    s_and_b32 s46, s46, 130944
    s_add_u32 s61, s46, 917564
    s_load_dwordx2 s[78:79], s[50:51], s61
    s_add_u32 s46, s46, 640
    s_and_b32 s46, s46, 130944
    s_add_u32 s61, s46, 4587580
    s_load_dwordx2 s[78:79], s[50:51], s61
    s_waitcnt vmcnt(11)
    s_barrier
    s_bitcmp1_b32 s59, 8
    s_cbranch_scc1 Lpk_36
    s_mov_b32 s60, 20000
Lpk_36_p:
    buffer_load_dword v248, v239, s[32:35], 0 offen offset:128 sc1
    s_waitcnt vmcnt(0)
    v_cmp_ne_u32 vcc, 0, v248
    s_nop 1
    s_and_b32 s59, vcc_lo, 0xffff
    s_sub_u32 s60, s60, 1
    s_cselect_b32 s59, 0xffff, s59
    s_bitcmp1_b32 s59, 8
    s_cbranch_scc0 Lpk_36_p
Lpk_36:
    s_cmp_le_u32 s5, 7
    s_addc_u32 s61, 7, 0
    s_mul_i32 s37, s61, 458752
    s_cmp_ge_u32 s61, 3
    s_addc_u32 s36, s61, 0
    s_cmp_ge_u32 s61, 10
    s_addc_u32 s61, s36, 0
    s_lshl_b32 s36, s61, 7
    v_add_u32 v240, s36, v236
    s_add_u32 m0, s80, 0
    s_nop 0
    buffer_load_dwordx4 v240, s[8:11], 0 offen sc1 lds
    s_add_u32 m0, s80, 4096
    s_nop 0
    buffer_load_dwordx4 v240, s[8:11], s81 offen sc1 lds
    s_add_u32 m0, s80, 8192
    s_nop 0
    buffer_load_dwordx4 v240, s[8:11], s82 offen sc1 lds
    s_add_u32 m0, s80, 12288
    s_nop 0
    buffer_load_dwordx4 v240, s[8:11], s83 offen sc1 lds
    v_add_u32 v241, s37, v237
    v_add_u32 v242, s37, v238
    s_add_u32 m0, s80, 16384
    s_nop 0
    buffer_load_dwordx4 v241, s[12:15], 0 offen  lds
    s_add_u32 m0, s80, 20480
    s_nop 0
    buffer_load_dwordx4 v241, s[12:15], s84 offen  lds
    s_add_u32 m0, s80, 24576
    s_nop 0
    buffer_load_dwordx4 v241, s[12:15], s85 offen  lds
    s_add_u32 m0, s80, 28672
    s_nop 0
    buffer_load_dwordx4 v241, s[12:15], s86 offen  lds
    s_add_u32 m0, s80, 32768
    s_nop 0
    buffer_load_dwordx4 v241, s[12:15], s87 offen  lds
    s_add_u32 m0, s80, 36864
    s_nop 0
    buffer_load_dwordx4 v241, s[12:15], s88 offen  lds
    s_add_u32 m0, s80, 40960
    s_nop 0
    buffer_load_dwordx4 v242, s[12:15], 0 offen  lds
    s_add_u32 s46, s46, 640
    s_and_b32 s46, s46, 130944
    s_add_u32 s61, s46, 1441852
    s_load_dwordx2 s[78:79], s[50:51], s61
    s_add_u32 s46, s46, 640
    s_and_b32 s46, s46, 130944
    s_add_u32 s61, s46, 5111868
    s_load_dwordx2 s[78:79], s[50:51], s61
    s_add_u32 s46, s46, 640
    s_and_b32 s46, s46, 130944
    s_add_u32 s61, s46, 1835068
    s_load_dwordx2 s[78:79], s[50:51], s61
    s_add_u32 s46, s46, 640
    s_and_b32 s46, s46, 130944
    s_add_u32 s61, s46, 5505084
    s_load_dwordx2 s[78:79], s[50:51], s61
    s_add_u32 s46, s46, 640
    s_and_b32 s46, s46, 130944
    s_add_u32 s61, s46, 2359356
    s_load_dwordx2 s[78:79], s[50:51], s61
    s_waitcnt vmcnt(11)
    s_barrier
    s_bitcmp1_b32 s59, 9
    s_cbranch_scc1 Lpk_37
    s_mov_b32 s60, 20000
Lpk_37_p:
    buffer_load_dword v248, v239, s[32:35], 0 offen offset:128 sc1
    s_waitcnt vmcnt(0)
    v_cmp_ne_u32 vcc, 0, v248
    s_nop 1
    s_and_b32 s59, vcc_lo, 0xffff
    s_sub_u32 s60, s60, 1
    s_cselect_b32 s59, 0xffff, s59
    s_bitcmp1_b32 s59, 9
    s_cbranch_scc0 Lpk_37_p
Lpk_37:
    s_cmp_le_u32 s5, 8
    s_addc_u32 s61, 8, 0
    s_mul_i32 s37, s61, 458752
    s_cmp_ge_u32 s61, 3
    s_addc_u32 s36, s61, 0
    s_cmp_ge_u32 s61, 10
    s_addc_u32 s61, s36, 0
    s_lshl_b32 s36, s61, 7
    v_add_u32 v240, s36, v236
    s_add_u32 m0, s80, 45056
    s_nop 0
    buffer_load_dwordx4 v240, s[8:11], 0 offen sc1 lds
    s_add_u32 m0, s80, 49152
    s_nop 0
    buffer_load_dwordx4 v240, s[8:11], s81 offen sc1 lds
    s_add_u32 m0, s80, 53248
    s_nop 0
    buffer_load_dwordx4 v240, s[8:11], s82 offen sc1 lds
    s_add_u32 m0, s80, 57344
    s_nop 0
    buffer_load_dwordx4 v240, s[8:11], s83 offen sc1 lds
    v_add_u32 v241, s37, v237
    v_add_u32 v242, s37, v238
    s_add_u32 m0, s80, 61440
    s_nop 0
    buffer_load_dwordx4 v241, s[12:15], 0 offen  lds
    s_add_u32 m0, s80, 65536
    s_nop 0
    buffer_load_dwordx4 v241, s[12:15], s84 offen  lds
    s_add_u32 m0, s80, 69632
    s_nop 0
    buffer_load_dwordx4 v241, s[12:15], s85 offen  lds
    s_add_u32 m0, s80, 73728
    s_nop 0
    buffer_load_dwordx4 v241, s[12:15], s86 offen  lds
    s_add_u32 m0, s80, 77824
    s_nop 0
    buffer_load_dwordx4 v241, s[12:15], s87 offen  lds
    s_add_u32 m0, s80, 81920
    s_nop 0
    buffer_load_dwordx4 v241, s[12:15], s88 offen  lds
    s_add_u32 m0, s80, 86016
    s_nop 0
    buffer_load_dwordx4 v242, s[12:15], 0 offen  lds
    s_add_u32 s46, s46, 640
    s_and_b32 s46, s46, 130944
    s_add_u32 s61, s46, 6029372
    s_load_dwordx2 s[78:79], s[50:51], s61
    s_add_u32 s46, s46, 640
    s_and_b32 s46, s46, 130944
    s_add_u32 s61, s46, 2752572
    s_load_dwordx2 s[78:79], s[50:51], s61
    s_add_u32 s46, s46, 640
    s_and_b32 s46, s46, 130944
    s_add_u32 s61, s46, 6422588
    s_load_dwordx2 s[78:79], s[50:51], s61
    s_add_u32 s46, s46, 640
    s_and_b32 s46, s46, 130944
    s_add_u32 s61, s46, 3276860
    s_load_dwordx2 s[78:79], s[50:51], s61
    s_add_u32 s46, s46, 640
    s_and_b32 s46, s46, 130944
    s_add_u32 s61, s46, 6946876
    s_load_dwordx2 s[78:79], s[50:51], s61
    s_waitcnt vmcnt(11)
    s_barrier
    s_bitcmp1_b32 s59, 10
    s_cbranch_scc1 Lpk_38
    s_mov_b32 s60, 20000
Lpk_38_p:
    buffer_load_dword v248, v239, s[32:35], 0 offen offset:128 sc1
    s_waitcnt vmcnt(0)
    v_cmp_ne_u32 vcc, 0, v248
    s_nop 1
    s_and_b32 s59, vcc_lo, 0xffff
    s_sub_u32 s60, s60, 1
    s_cselect_b32 s59, 0xffff, s59
    s_bitcmp1_b32 s59, 10
    s_cbranch_scc0 Lpk_38_p
Lpk_38:
    s_cmp_le_u32 s5, 9
    s_addc_u32 s61, 9, 0
    s_mul_i32 s37, s61, 458752
    s_cmp_ge_u32 s61, 3
    s_addc_u32 s36, s61, 0
    s_cmp_ge_u32 s61, 10
    s_addc_u32 s61, s36, 0
    s_lshl_b32 s36, s61, 7
    v_add_u32 v240, s36, v236
    s_add_u32 m0, s80, 90112
    s_nop 0
    buffer_load_dwordx4 v240, s[8:11], 0 offen sc1 lds
    s_add_u32 m0, s80, 94208
    s_nop 0
    buffer_load_dwordx4 v240, s[8:11], s81 offen sc1 lds
    s_add_u32 m0, s80, 98304
    s_nop 0
    buffer_load_dwordx4 v240, s[8:11], s82 offen sc1 lds
    s_add_u32 m0, s80, 102400
    s_nop 0
    buffer_load_dwordx4 v240, s[8:11], s83 offen sc1 lds
    v_add_u32 v241, s37, v237
    v_add_u32 v242, s37, v238
    s_add_u32 m0, s80, 106496
    s_nop 0
    buffer_load_dwordx4 v241, s[12:15], 0 offen  lds
    s_add_u32 m0, s80, 110592
    s_nop 0
    buffer_load_dwordx4 v241, s[12:15], s84 offen  lds
    s_add_u32 m0, s80, 114688
    s_nop 0
    buffer_load_dwordx4 v241, s[12:15], s85 offen  lds
    s_add_u32 m0, s80, 118784
    s_nop 0
    buffer_load_dwordx4 v241, s[12:15], s86 offen  lds
    s_add_u32 m0, s80, 122880
    s_nop 0
    buffer_load_dwordx4 v241, s[12:15], s87 offen  lds
    s_add_u32 m0, s80, 126976
    s_nop 0
    buffer_load_dwordx4 v241, s[12:15], s88 offen  lds
    s_add_u32 m0, s80, 131072
    s_nop 0
    buffer_load_dwordx4 v242, s[12:15], 0 offen  lds
    s_add_u32 s46, s46, 640
    s_and_b32 s46, s46, 130944
    s_add_u32 s61, s46, 131132
    s_load_dwordx2 s[78:79], s[50:51], s61
    s_add_u32 s46, s46, 640
    s_and_b32 s46, s46, 130944
    s_add_u32 s61, s46, 3801148
    s_load_dwordx2 s[78:79], s[50:51], s61
    s_add_u32 s46, s46, 640
    s_and_b32 s46, s46, 130944
    s_add_u32 s61, s46, 655420
    s_load_dwordx2 s[78:79], s[50:51], s61
    s_add_u32 s46, s46, 640
    s_and_b32 s46, s46, 130944
    s_add_u32 s61, s46, 4325436
    s_load_dwordx2 s[78:79], s[50:51], s61
    s_add_u32 s46, s46, 640
    s_and_b32 s46, s46, 130944
    s_add_u32 s61, s46, 1048636
    s_load_dwordx2 s[78:79], s[50:51], s61
    s_waitcnt vmcnt(11)
    s_barrier
    s_bitcmp1_b32 s59, 11
    s_cbranch_scc1 Lpk_39
    s_mov_b32 s60, 20000
Lpk_39_p:
    buffer_load_dword v248, v239, s[32:35], 0 offen offset:128 sc1
    s_waitcnt vmcnt(0)
    v_cmp_ne_u32 vcc, 0, v248
    s_nop 1
    s_and_b32 s59, vcc_lo, 0xffff
    s_sub_u32 s60, s60, 1
    s_cselect_b32 s59, 0xffff, s59
    s_bitcmp1_b32 s59, 11
    s_cbranch_scc0 Lpk_39_p
Lpk_39:
    s_cmp_le_u32 s5, 10
    s_addc_u32 s61, 10, 0
    s_mul_i32 s37, s61, 458752
    s_cmp_ge_u32 s61, 3
    s_addc_u32 s36, s61, 0
    s_cmp_ge_u32 s61, 10
    s_addc_u32 s61, s36, 0
    s_lshl_b32 s36, s61, 7
    v_add_u32 v240, s36, v236
    s_add_u32 m0, s80, 0
    s_nop 0
    buffer_load_dwordx4 v240, s[8:11], 0 offen sc1 lds
    s_add_u32 m0, s80, 4096
    s_nop 0
    buffer_load_dwordx4 v240, s[8:11], s81 offen sc1 lds
    s_add_u32 m0, s80, 8192
    s_nop 0
    buffer_load_dwordx4 v240, s[8:11], s82 offen sc1 lds
    s_add_u32 m0, s80, 12288
    s_nop 0
    buffer_load_dwordx4 v240, s[8:11], s83 offen sc1 lds
    v_add_u32 v241, s37, v237
    v_add_u32 v242, s37, v238
    s_add_u32 m0, s80, 16384
    s_nop 0
    buffer_load_dwordx4 v241, s[12:15], 0 offen  lds
    s_add_u32 m0, s80, 20480
    s_nop 0
    buffer_load_dwordx4 v241, s[12:15], s84 offen  lds
    s_add_u32 m0, s80, 24576
    s_nop 0
    buffer_load_dwordx4 v241, s[12:15], s85 offen  lds
    s_add_u32 m0, s80, 28672
    s_nop 0
    buffer_load_dwordx4 v241, s[12:15], s86 offen  lds
    s_add_u32 m0, s80, 32768
    s_nop 0
    buffer_load_dwordx4 v241, s[12:15], s87 offen  lds
    s_add_u32 m0, s80, 36864
    s_nop 0
    buffer_load_dwordx4 v241, s[12:15], s88 offen  lds
    s_add_u32 m0, s80, 40960
    s_nop 0
    buffer_load_dwordx4 v242, s[12:15], 0 offen  lds
    s_add_u32 s46, s46, 640
    s_and_b32 s46, s46, 130944
    s_add_u32 s61, s46, 4718652
    s_load_dwordx2 s[78:79], s[50:51], s61
    s_add_u32 s46, s46, 640
    s_and_b32 s46, s46, 130944
    s_add_u32 s61, s46, 1572924
    s_load_dwordx2 s[78:79], s[50:51], s61
    s_add_u32 s46, s46, 640
    s_and_b32 s46, s46, 130944
    s_add_u32 s61, s46, 5242940
    s_load_dwordx2 s[78:79], s[50:51], s61
    s_add_u32 s46, s46, 640
    s_and_b32 s46, s46, 130944
    s_add_u32 s61, s46, 1966140
    s_load_dwordx2 s[78:79], s[50:51], s61
    s_add_u32 s46, s46, 640
    s_and_b32 s46, s46, 130944
    s_add_u32 s61, s46, 5636156
    s_load_dwordx2 s[78:79], s[50:51], s61
    s_waitcnt vmcnt(11)
    s_barrier
    s_bitcmp1_b32 s59, 12
    s_cbranch_scc1 Lpk_40
    s_mov_b32 s60, 20000
Lpk_40_p:
    buffer_load_dword v248, v239, s[32:35], 0 offen offset:128 sc1
    s_waitcnt vmcnt(0)
    v_cmp_ne_u32 vcc, 0, v248
    s_nop 1
    s_and_b32 s59, vcc_lo, 0xffff
    s_sub_u32 s60, s60, 1
    s_cselect_b32 s59, 0xffff, s59
    s_bitcmp1_b32 s59, 12
    s_cbranch_scc0 Lpk_40_p
Lpk_40:
    s_cmp_le_u32 s5, 11
    s_addc_u32 s61, 11, 0
    s_mul_i32 s37, s61, 458752
    s_cmp_ge_u32 s61, 3
    s_addc_u32 s36, s61, 0
    s_cmp_ge_u32 s61, 10
    s_addc_u32 s61, s36, 0
    s_lshl_b32 s36, s61, 7
    v_add_u32 v240, s36, v236
    s_add_u32 m0, s80, 45056
    s_nop 0
    buffer_load_dwordx4 v240, s[8:11], 0 offen sc1 lds
    s_add_u32 m0, s80, 49152
    s_nop 0
    buffer_load_dwordx4 v240, s[8:11], s81 offen sc1 lds
    s_add_u32 m0, s80, 53248
    s_nop 0
    buffer_load_dwordx4 v240, s[8:11], s82 offen sc1 lds
    s_add_u32 m0, s80, 57344
    s_nop 0
    buffer_load_dwordx4 v240, s[8:11], s83 offen sc1 lds
    v_add_u32 v241, s37, v237
    v_add_u32 v242, s37, v238
    s_add_u32 m0, s80, 61440
    s_nop 0
    buffer_load_dwordx4 v241, s[12:15], 0 offen  lds
    s_add_u32 m0, s80, 65536
    s_nop 0
    buffer_load_dwordx4 v241, s[12:15], s84 offen  lds
    s_add_u32 m0, s80, 69632
    s_nop 0
    buffer_load_dwordx4 v241, s[12:15], s85 offen  lds
    s_add_u32 m0, s80, 73728
    s_nop 0
    buffer_load_dwordx4 v241, s[12:15], s86 offen  lds
    s_add_u32 m0, s80, 77824
    s_nop 0
    buffer_load_dwordx4 v241, s[12:15], s87 offen  lds
    s_add_u32 m0, s80, 81920
    s_nop 0
    buffer_load_dwordx4 v241, s[12:15], s88 offen  lds
    s_add_u32 m0, s80, 86016
    s_nop 0
    buffer_load_dwordx4 v242, s[12:15], 0 offen  lds
    s_add_u32 s46, s46, 640
    s_and_b32 s46, s46, 130944
    s_add_u32 s61, s46, 2490428
    s_load_dwordx2 s[78:79], s[50:51], s61
    s_add_u32 s46, s46, 640
    s_and_b32 s46, s46, 130944
    s_add_u32 s61, s46, 6160444
    s_load_dwordx2 s[78:79], s[50:51], s61
    s_add_u32 s46, s46, 640
    s_and_b32 s46, s46, 130944
    s_add_u32 s61, s46, 2883644
    s_load_dwordx2 s[78:79], s[50:51], s61
    s_add_u32 s46, s46, 640
    s_and_b32 s46, s46, 130944
    s_add_u32 s61, s46, 6553660
    s_load_dwordx2 s[78:79], s[50:51], s61
    s_add_u32 s46, s46, 640
    s_and_b32 s46, s46, 130944
    s_add_u32 s61, s46, 3407932
    s_load_dwordx2 s[78:79], s[50:51], s61
    s_waitcnt vmcnt(11)
    s_barrier
    s_bitcmp1_b32 s59, 13
    s_cbranch_scc1 Lpk_41
    s_mov_b32 s60, 20000
Lpk_41_p:
    buffer_load_dword v248, v239, s[32:35], 0 offen offset:128 sc1
    s_waitcnt vmcnt(0)
    v_cmp_ne_u32 vcc, 0, v248
    s_nop 1
    s_and_b32 s59, vcc_lo, 0xffff
    s_sub_u32 s60, s60, 1
    s_cselect_b32 s59, 0xffff, s59
    s_bitcmp1_b32 s59, 13
    s_cbranch_scc0 Lpk_41_p
Lpk_41:
    s_cmp_le_u32 s5, 12
    s_addc_u32 s61, 12, 0
    s_mul_i32 s37, s61, 458752
    s_cmp_ge_u32 s61, 3
    s_addc_u32 s36, s61, 0
    s_cmp_ge_u32 s61, 10
    s_addc_u32 s61, s36, 0
    s_lshl_b32 s36, s61, 7
    v_add_u32 v240, s36, v236
    s_add_u32 m0, s80, 90112
    s_nop 0
    buffer_load_dwordx4 v240, s[8:11], 0 offen sc1 lds
    s_add_u32 m0, s80, 94208
    s_nop 0
    buffer_load_dwordx4 v240, s[8:11], s81 offen sc1 lds
    s_add_u32 m0, s80, 98304
    s_nop 0
    buffer_load_dwordx4 v240, s[8:11], s82 offen sc1 lds
    s_add_u32 m0, s80, 102400
    s_nop 0
    buffer_load_dwordx4 v240, s[8:11], s83 offen sc1 lds
    v_add_u32 v241, s37, v237
    v_add_u32 v242, s37, v238
    s_add_u32 m0, s80, 106496
    s_nop 0
    buffer_load_dwordx4 v241, s[12:15], 0 offen  lds
    s_add_u32 m0, s80, 110592
    s_nop 0
    buffer_load_dwordx4 v241, s[12:15], s84 offen  lds
    s_add_u32 m0, s80, 114688
    s_nop 0
    buffer_load_dwordx4 v241, s[12:15], s85 offen  lds
    s_add_u32 m0, s80, 118784
    s_nop 0
    buffer_load_dwordx4 v241, s[12:15], s86 offen  lds
    s_add_u32 m0, s80, 122880
    s_nop 0
    buffer_load_dwordx4 v241, s[12:15], s87 offen  lds
    s_add_u32 m0, s80, 126976
    s_nop 0
    buffer_load_dwordx4 v241, s[12:15], s88 offen  lds
    s_add_u32 m0, s80, 131072
    s_nop 0
    buffer_load_dwordx4 v242, s[12:15], 0 offen  lds
    s_add_u32 s46, s46, 640
    s_and_b32 s46, s46, 130944
    s_add_u32 s61, s46, 7077948
    s_load_dwordx2 s[78:79], s[50:51], s61
    s_add_u32 s46, s46, 640
    s_and_b32 s46, s46, 130944
    s_add_u32 s61, s46, 262204
    s_load_dwordx2 s[78:79], s[50:51], s61
    s_add_u32 s46, s46, 640
    s_and_b32 s46, s46, 130944
    s_add_u32 s61, s46, 3932220
    s_load_dwordx2 s[78:79], s[50:51], s61
    s_add_u32 s46, s46, 640
    s_and_b32 s46, s46, 130944
    s_add_u32 s61, s46, 786492
    s_load_dwordx2 s[78:79], s[50:51], s61
    s_add_u32 s46, s46, 640
    s_and_b32 s46, s46, 130944
    s_add_u32 s61, s46, 4456508
    s_load_dwordx2 s[78:79], s[50:51], s61
    s_waitcnt vmcnt(11)
    s_barrier
    s_bitcmp1_b32 s59, 14
    s_cbranch_scc1 Lpk_42
    s_mov_b32 s60, 20000
Lpk_42_p:
    buffer_load_dword v248, v239, s[32:35], 0 offen offset:128 sc1
    s_waitcnt vmcnt(0)
    v_cmp_ne_u32 vcc, 0, v248
    s_nop 1
    s_and_b32 s59, vcc_lo, 0xffff
    s_sub_u32 s60, s60, 1
    s_cselect_b32 s59, 0xffff, s59
    s_bitcmp1_b32 s59, 14
    s_cbranch_scc0 Lpk_42_p
Lpk_42:
    s_cmp_le_u32 s5, 13
    s_addc_u32 s61, 13, 0
    s_mul_i32 s37, s61, 458752
    s_cmp_ge_u32 s61, 3
    s_addc_u32 s36, s61, 0
    s_cmp_ge_u32 s61, 10
    s_addc_u32 s61, s36, 0
    s_lshl_b32 s36, s61, 7
    v_add_u32 v240, s36, v236
    s_add_u32 m0, s80, 0
    s_nop 0
    buffer_load_dwordx4 v240, s[8:11], 0 offen sc1 lds
    s_add_u32 m0, s80, 4096
    s_nop 0
    buffer_load_dwordx4 v240, s[8:11], s81 offen sc1 lds
    s_add_u32 m0, s80, 8192
    s_nop 0
    buffer_load_dwordx4 v240, s[8:11], s82 offen sc1 lds
    s_add_u32 m0, s80, 12288
    s_nop 0
    buffer_load_dwordx4 v240, s[8:11], s83 offen sc1 lds
    v_add_u32 v241, s37, v237
    v_add_u32 v242, s37, v238
    s_add_u32 m0, s80, 16384
    s_nop 0
    buffer_load_dwordx4 v241, s[12:15], 0 offen  lds
    s_add_u32 m0, s80, 20480
    s_nop 0
    buffer_load_dwordx4 v241, s[12:15], s84 offen  lds
    s_add_u32 m0, s80, 24576
    s_nop 0
    buffer_load_dwordx4 v241, s[12:15], s85 offen  lds
    s_add_u32 m0, s80, 28672
    s_nop 0
    buffer_load_dwordx4 v241, s[12:15], s86 offen  lds
    s_add_u32 m0, s80, 32768
    s_nop 0
    buffer_load_dwordx4 v241, s[12:15], s87 offen  lds
    s_add_u32 m0, s80, 36864
    s_nop 0
    buffer_load_dwordx4 v241, s[12:15], s88 offen  lds
    s_add_u32 m0, s80, 40960
    s_nop 0
    buffer_load_dwordx4 v242, s[12:15], 0 offen  lds
    s_add_u32 s46, s46, 640
    s_and_b32 s46, s46, 130944
    s_add_u32 s61, s46, 1179708
    s_load_dwordx2 s[78:79], s[50:51], s61
    s_add_u32 s46, s46, 640
    s_and_b32 s46, s46, 130944
    s_add_u32 s61, s46, 4849724
    s_load_dwordx2 s[78:79], s[50:51], s61
    s_add_u32 s46, s46, 640
    s_and_b32 s46, s46, 130944
    s_add_u32 s61, s46, 1703996
    s_load_dwordx2 s[78:79], s[50:51], s61
    s_add_u32 s46, s46, 640
    s_and_b32 s46, s46, 130944
    s_add_u32 s61, s46, 5374012
    s_load_dwordx2 s[78:79], s[50:51], s61
    s_add_u32 s46, s46, 640
    s_and_b32 s46, s46, 130944
    s_add_u32 s61, s46, 2097212
    s_load_dwordx2 s[78:79], s[50:51], s61
    s_waitcnt vmcnt(11)
    s_barrier
    s_bitcmp1_b32 s59, 15
    s_cbranch_scc1 Lpk_43
    s_mov_b32 s60, 20000
Lpk_43_p:
    buffer_load_dword v248, v239, s[32:35], 0 offen offset:128 sc1
    s_waitcnt vmcnt(0)
    v_cmp_ne_u32 vcc, 0, v248
    s_nop 1
    s_and_b32 s59, vcc_lo, 0xffff
    s_sub_u32 s60, s60, 1
    s_cselect_b32 s59, 0xffff, s59
    s_bitcmp1_b32 s59, 15
    s_cbranch_scc0 Lpk_43_p
Lpk_43:
    s_cmp_le_u32 s5, 14
    s_addc_u32 s61, 14, 0
    s_mul_i32 s37, s61, 458752
    s_cmp_ge_u32 s61, 3
    s_addc_u32 s36, s61, 0
    s_cmp_ge_u32 s61, 10
    s_addc_u32 s61, s36, 0
    s_lshl_b32 s36, s61, 7
    v_add_u32 v240, s36, v236
    s_add_u32 m0, s80, 45056
    s_nop 0
    buffer_load_dwordx4 v240, s[8:11], 0 offen sc1 lds
    s_add_u32 m0, s80, 49152
    s_nop 0
    buffer_load_dwordx4 v240, s[8:11], s81 offen sc1 lds
    s_add_u32 m0, s80, 53248
    s_nop 0
    buffer_load_dwordx4 v240, s[8:11], s82 offen sc1 lds
    s_add_u32 m0, s80, 57344
    s_nop 0
    buffer_load_dwordx4 v240, s[8:11], s83 offen sc1 lds
    v_add_u32 v241, s37, v237
    v_add_u32 v242, s37, v238
    s_add_u32 m0, s80, 61440
    s_nop 0
    buffer_load_dwordx4 v241, s[12:15], 0 offen  lds
    s_add_u32 m0, s80, 65536
    s_nop 0
    buffer_load_dwordx4 v241, s[12:15], s84 offen  lds
    s_add_u32 m0, s80, 69632
    s_nop 0
    buffer_load_dwordx4 v241, s[12:15], s85 offen  lds
    s_add_u32 m0, s80, 73728
    s_nop 0
    buffer_load_dwordx4 v241, s[12:15], s86 offen  lds
    s_add_u32 m0, s80, 77824
    s_nop 0
    buffer_load_dwordx4 v241, s[12:15], s87 offen  lds
    s_add_u32 m0, s80, 81920
    s_nop 0
    buffer_load_dwordx4 v241, s[12:15], s88 offen  lds
    s_add_u32 m0, s80, 86016
    s_nop 0
    buffer_load_dwordx4 v242, s[12:15], 0 offen  lds
    s_add_u32 s46, s46, 640
    s_and_b32 s46, s46, 130944
    s_add_u32 s61, s46, 5767228
    s_load_dwordx2 s[78:79], s[50:51], s61
    s_add_u32 s46, s46, 640
    s_and_b32 s46, s46, 130944
    s_add_u32 s61, s46, 2621500
    s_load_dwordx2 s[78:79], s[50:51], s61
    s_add_u32 s46, s46, 640
    s_and_b32 s46, s46, 130944
    s_add_u32 s61, s46, 6291516
    s_load_dwordx2 s[78:79], s[50:51], s61
    s_add_u32 s46, s46, 640
    s_and_b32 s46, s46, 130944
    s_add_u32 s61, s46, 3014716
    s_load_dwordx2 s[78:79], s[50:51], s61
    s_add_u32 s46, s46, 640
    s_and_b32 s46, s46, 130944
    s_add_u32 s61, s46, 6684732
    s_load_dwordx2 s[78:79], s[50:51], s61
    buffer_load_dwordx2 v[16:17], v12, s[24:27], 0 offen offset:0 sc1
    buffer_load_dwordx2 v[18:19], v12, s[24:27], 0 offen offset:1024 sc1
    buffer_load_dwordx2 v[20:21], v12, s[24:27], 0 offen offset:2048 sc1
    buffer_load_dwordx2 v[22:23], v12, s[24:27], 0 offen offset:3072 sc1
    buffer_load_dwordx2 v[24:25], v13, s[24:27], 0 offen offset:0 sc1
    buffer_load_dwordx2 v[26:27], v13, s[24:27], 0 offen offset:1024 sc1
    buffer_load_dwordx2 v[28:29], v13, s[24:27], 0 offen offset:2048 sc1
    buffer_load_dwordx2 v[30:31], v13, s[24:27], 0 offen offset:3072 sc1
    s_waitcnt vmcnt(19)
    s_barrier
    s_waitcnt vmcnt(8)
    s_barrier
    s_waitcnt vmcnt(0)
    v_pk_add_f32 v[16:17], v[16:17], v[18:19]
    v_pk_add_f32 v[20:21], v[20:21], v[22:23]
    v_pk_add_f32 v[24:25], v[24:25], v[26:27]
    v_pk_add_f32 v[28:29], v[28:29], v[30:31]
    v_pk_add_f32 v[16:17], v[16:17], v[20:21]
    v_pk_add_f32 v[24:25], v[24:25], v[28:29]
    v_pk_add_f32 v[16:17], v[16:17], v[24:25]
    s_nop 1
    v_add_f32_dpp v16, v16, v16 quad_perm:[1,0,3,2] row_mask:0xf bank_mask:0xf
    v_add_f32_dpp v17, v17, v17 quad_perm:[1,0,3,2] row_mask:0xf bank_mask:0xf
    v_mul_f32 v16, 0x3a800000, v16
    v_mul_f32 v18, v16, v16
    v_mov_b32 v19, 0x3a800000
    v_fma_f32 v17, v17, v19, -v18
    v_max_f32 v17, 0, v17
    v_add_f32 v17, 0x3727c5ac, v17
    v_rsq_f32 v18, v17
    v_sqrt_f32 v17, v17
    v_mul_f32 v18, 0xbfb8aa3b, v18
    ds_write_b128 v11, v[16:19]
    s_waitcnt lgkmcnt(0)
    s_barrier
    s_barrier
    s_cmp_lt_u32 s63, 2
    s_cbranch_scc1 P3_S
    s_add_u32 s46, s46, 640
    s_and_b32 s46, s46, 130944
    s_add_u32 s61, s46, 3539004
    s_load_dwordx2 s[78:79], s[50:51], s61
    s_add_u32 s46, s46, 640
    s_and_b32 s46, s46, 130944
    s_add_u32 s61, s46, 7209020
    s_load_dwordx2 s[78:79], s[50:51], s61
    s_sub_u32 s66, s63, 2
    v_lshrrev_b32 v243, 3, v0
    v_and_b32 v244, 7, v0
    v_lshrrev_b32 v245, 4, v0
    s_lshl_b32 s61, s4, 7
    s_lshl_b32 s80, s66, 3
    s_add_u32 s61, s61, s80
    v_add_u32 v246, s61, v243
    v_lshlrev_b32 v246, 13, v246
    s_and_b32 s82, s66, 1
    s_lshl_b32 s82, s82, 2
    v_xor_b32 v247, v244, v245
    v_xor_b32 v247, s82, v247
    v_lshl_add_u32 v240, v247, 4, v246
    v_add_u32 v246, s80, v243
    v_mul_u32_u24 v246, 2048, v246
    v_and_b32 v247, 2, v243
    v_xor_b32 v247, v244, v247
    v_xor_b32 v247, s82, v247
    v_lshl_add_u32 v241, v247, 4, v246
    s_lshl_b32 s61, s7, 8
    v_add_u32 v241, s61, v241
    s_lshl_b32 s80, s66, 10
    s_mov_b32 s81, 131072
    s_mov_b32 s82, 262144
    s_mov_b32 s83, 393216
    s_mov_b32 s84, 524288
    s_mov_b32 s85, 655360
    s_mov_b32 s86, 786432
    s_mov_b32 s87, 917504
    s_mov_b32 s88, 32768
    s_mov_b32 s89, 65536
    s_mov_b32 s90, 98304
    s_mov_b32 s91, 128
    s_mov_b32 s67, 32896
    s_mov_b32 s68, 65664
    s_mov_b32 s69, 98432
    s_add_u32 s8, s56, 16777216
    s_addc_u32 s9, s57, 0
    s_mov_b32 s10, 16777216
    s_mov_b32 s11, 0x20000
    s_mov_b32 s12, s50
    s_mov_b32 s13, s51
    s_mov_b32 s14, 7340032
    s_mov_b32 s15, 0x20000
    s_mul_i32 s62, s6, 4096
    v_add_u32 v240, s62, v240
    s_mul_i32 s62, s6, 3670016
    v_add_u32 v241, s62, v241
    s_mov_b32 s71, s62
    v_mov_b32 v236, v240
    v_mov_b32 v237, v241
    s_add_u32 s61, s7, 0
    s_and_b32 s61, s61, 7
    s_mul_i32 s61, s61, 7
    s_add_u32 s61, s61, 1
    s_lshr_b32 s61, s61, 1
    s_lshl_b32 s61, s61, 17
    v_add_u32 v241, s61, v237
    s_add_u32 m0, s80, 81920
    s_nop 0
    buffer_load_dwordx4 v241, s[12:15], 0 offen  lds
    s_add_u32 m0, s80, 83968
    s_nop 0
    buffer_load_dwordx4 v241, s[12:15], s88 offen  lds
    s_add_u32 m0, s80, 86016
    s_nop 0
    buffer_load_dwordx4 v241, s[12:15], s89 offen  lds
    s_add_u32 m0, s80, 88064
    s_nop 0
    buffer_load_dwordx4 v241, s[12:15], s90 offen  lds
    s_add_u32 m0, s80, 90112
    s_nop 0
    buffer_load_dwordx4 v241, s[12:15], s91 offen  lds
    s_add_u32 m0, s80, 92160
    s_nop 0
    buffer_load_dwordx4 v241, s[12:15], s67 offen  lds
    s_add_u32 m0, s80, 94208
    s_nop 0
    buffer_load_dwordx4 v241, s[12:15], s68 offen  lds
    s_add_u32 m0, s80, 96256
    s_nop 0
    buffer_load_dwordx4 v241, s[12:15], s69 offen  lds
    s_barrier
    s_add_u32 s61, s7, 0
    s_and_b32 s61, s61, 7
    s_mul_i32 s61, s61, 7
    s_add_u32 s61, s61, 3
    s_lshr_b32 s61, s61, 1
    s_lshl_b32 s61, s61, 17
    v_add_u32 v241, s61, v237
    s_add_u32 m0, s80, 114688
    s_nop 0
    buffer_load_dwordx4 v241, s[12:15], 0 offen  lds
    s_add_u32 m0, s80, 116736
    s_nop 0
    buffer_load_dwordx4 v241, s[12:15], s88 offen  lds
    s_add_u32 m0, s80, 118784
    s_nop 0
    buffer_load_dwordx4 v241, s[12:15], s89 offen  lds
    s_add_u32 m0, s80, 120832
    s_nop 0
    buffer_load_dwordx4 v241, s[12:15], s90 offen  lds
    s_add_u32 m0, s80, 122880
    s_nop 0
    buffer_load_dwordx4 v241, s[12:15], s91 offen  lds
    s_add_u32 m0, s80, 124928
    s_nop 0
    buffer_load_dwordx4 v241, s[12:15], s67 offen  lds
    s_add_u32 m0, s80, 126976
    s_nop 0
    buffer_load_dwordx4 v241, s[12:15], s68 offen  lds
    s_add_u32 m0, s80, 129024
    s_nop 0
    buffer_load_dwordx4 v241, s[12:15], s69 offen  lds
    s_add_u32 s61, s7, 0
    s_and_b32 s61, s61, 7
    s_mul_i32 s61, s61, 7
    s_add_u32 s61, s61, 5
    s_lshr_b32 s61, s61, 1
    s_lshl_b32 s61, s61, 17
    v_add_u32 v241, s61, v237
    s_add_u32 m0, s80, 147456
    s_nop 0
    buffer_load_dwordx4 v241, s[12:15], 0 offen  lds
    s_add_u32 m0, s80, 149504
    s_nop 0
    buffer_load_dwordx4 v241, s[12:15], s88 offen  lds
    s_add_u32 m0, s80, 151552
    s_nop 0
    buffer_load_dwordx4 v241, s[12:15], s89 offen  lds
    s_add_u32 m0, s80, 153600
    s_nop 0
    buffer_load_dwordx4 v241, s[12:15], s90 offen  lds
    s_add_u32 m0, s80, 155648
    s_nop 0
    buffer_load_dwordx4 v241, s[12:15], s91 offen  lds
    s_add_u32 m0, s80, 157696
    s_nop 0
    buffer_load_dwordx4 v241, s[12:15], s67 offen  lds
    s_add_u32 m0, s80, 159744
    s_nop 0
    buffer_load_dwordx4 v241, s[12:15], s68 offen  lds
    s_add_u32 m0, s80, 161792
    s_nop 0
    buffer_load_dwordx4 v241, s[12:15], s69 offen  lds
    s_mov_b32 s28, s50
    s_mov_b32 s29, s51
    s_mov_b32 s30, 7340032
    s_mov_b32 s31, 0x20000
    s_lshr_b32 s61, s2, 3
    s_lshl_b32 s61, s61, 1
    s_add_u32 s61, s61, s66
    s_mul_i32 s61, s61, 57344
    s_add_u32 s61, s61, s71
    s_add_u32 s61, s61, 384
    v_lshlrev_b32 v3, 10, v0
    v_cmp_gt_u32 vcc, 56, v0
    v_mov_b32 v4, 0x80000000
    s_nop 0
    v_cndmask_b32 v3, v4, v3, vcc
    buffer_load_dword v250, v3, s[28:31], s61 offen
    s_lshl_b32 s61, s6, 9
    v_add_u32 v20, s61, v254
    s_barrier
    s_barrier
    buffer_load_dword v21, v20, s[32:35], 0 offen offset:640 sc1
    s_mov_b32 s71, 0
    s_waitcnt vmcnt(0)
    v_readfirstlane_b32 s61, v21
    s_cmp_ge_u32 s61, 16
    s_cbranch_scc0 P3_D1
    v_add_u32 v240, 0, v236
    s_add_u32 m0, s80, 32768
    s_nop 0
    buffer_load_dwordx4 v240, s[8:11], 0 offen sc1 lds
    s_add_u32 m0, s80, 34816
    s_nop 0
    buffer_load_dwordx4 v240, s[8:11], s81 offen sc1 lds
    s_add_u32 m0, s80, 36864
    s_nop 0
    buffer_load_dwordx4 v240, s[8:11], s82 offen sc1 lds
    s_add_u32 m0, s80, 38912
    s_nop 0
    buffer_load_dwordx4 v240, s[8:11], s83 offen sc1 lds
    s_add_u32 m0, s80, 40960
    s_nop 0
    buffer_load_dwordx4 v240, s[8:11], s84 offen sc1 lds
    s_add_u32 m0, s80, 43008
    s_nop 0
    buffer_load_dwordx4 v240, s[8:11], s85 offen sc1 lds
    s_add_u32 m0, s80, 45056
    s_nop 0
    buffer_load_dwordx4 v240, s[8:11], s86 offen sc1 lds
    s_add_u32 m0, s80, 47104
    s_nop 0
    buffer_load_dwordx4 v240, s[8:11], s87 offen sc1 lds
    v_add_u32 v241, 393216, v237
    s_add_u32 m0, s80, 49152
    s_nop 0
    buffer_load_dwordx4 v241, s[12:15], 0 offen  lds
    s_add_u32 m0, s80, 51200
    s_nop 0
    buffer_load_dwordx4 v241, s[12:15], s88 offen  lds
    s_add_u32 m0, s80, 53248
    s_nop 0
    buffer_load_dwordx4 v241, s[12:15], s89 offen  lds
    s_add_u32 m0, s80, 55296
    s_nop 0
    buffer_load_dwordx4 v241, s[12:15], s90 offen  lds
    s_add_u32 m0, s80, 57344
    s_nop 0
    buffer_load_dwordx4 v241, s[12:15], s91 offen  lds
    s_add_u32 m0, s80, 59392
    s_nop 0
    buffer_load_dwordx4 v241, s[12:15], s67 offen  lds
    s_add_u32 m0, s80, 61440
    s_nop 0
    buffer_load_dwordx4 v241, s[12:15], s68 offen  lds
    s_add_u32 m0, s80, 63488
    s_nop 0
    buffer_load_dwordx4 v241, s[12:15], s69 offen  lds
    s_mov_b32 s71, 1
P3_D1:
    s_barrier
    s_branch P4_D
P3_S:
    v_lshl_add_u32 v3, s63, 6, v0
    v_lshlrev_b32 v8, 4, v3
    v_add_u32 v8, 0x10000, v8
    v_add_u32 v14, 0x10000, v8
    v_lshrrev_b32 v4, 3, v3
    v_lshrrev_b32 v5, 4, v3
    v_xor_b32 v5, v5, v3
    v_and_b32 v5, 7, v5
    s_lshl_b32 s61, s4, 7
    v_add_u32 v4, s61, v4
    v_lshlrev_b32 v4, 13, v4
    v_lshl_add_u32 v9, v5, 4, v4
    v_lshrrev_b32 v4, 2, v3
    v_and_b32 v5, 3, v3
    v_mul_u32_u24 v6, 80, v4
    v_lshl_add_u32 v10, v5, 4, v6
    v_add_u32 v4, s61, v4
    v_lshlrev_b32 v4, 13, v4
    v_lshl_add_u32 v11, v5, 4, v4
    v_mov_b32 v12, s75
    v_mov_b32 v13, 1
    s_add_u32 s80, s7, 4
    s_add_u32 s61, s80, 4
    s_mul_i32 s61, s61, 147
    s_lshr_b32 s61, s61, 10
    s_add_u32 s80, s80, s61
    s_mul_i32 s61, s6, 32
    s_add_u32 s80, s80, s61
    s_lshl_b32 s80, s80, 7
    s_add_u32 s81, s7, 12
    s_add_u32 s61, s81, 4
    s_mul_i32 s61, s61, 147
    s_lshr_b32 s61, s61, 10
    s_add_u32 s81, s81, s61
    s_mul_i32 s61, s6, 32
    s_add_u32 s81, s81, s61
    s_lshl_b32 s81, s81, 7
    s_add_u32 s82, s7, 20
    s_add_u32 s61, s82, 4
    s_mul_i32 s61, s61, 147
    s_lshr_b32 s61, s61, 10
    s_add_u32 s82, s82, s61
    s_mul_i32 s61, s6, 32
    s_add_u32 s82, s82, s61
    s_lshl_b32 s82, s82, 7
    s_lshr_b32 s83, s7, 1
    s_add_u32 s61, s83, 4
    s_mul_i32 s61, s61, 147
    s_lshr_b32 s61, s61, 10
    s_add_u32 s83, s83, s61
    s_mul_i32 s61, s6, 32
    s_add_u32 s83, s83, s61
    s_lshl_b32 s83, s83, 7
    s_and_b32 s61, s7, 1
    s_lshl_b32 s61, s61, 6
    s_add_u32 s83, s83, s61
    s_add_u32 s16, s56, 16777216
    s_addc_u32 s17, s57, 0
    s_mov_b32 s18, 16777216
    s_mov_b32 s19, 0x20000
    s_barrier
    ds_read_b128 v[112:115], v10 offset:0
    ds_read_b128 v[116:119], v10 offset:2560
    ds_read_b128 v[120:123], v10 offset:5120
    ds_read_b128 v[124:127], v10 offset:7680
    s_waitcnt lgkmcnt(0)
    s_add_u32 s61, s83, 0
    buffer_store_dwordx4 v[112:115], v11, s[16:19], s61 offen sc1
    s_add_u32 s61, s83, 262144
    buffer_store_dwordx4 v[116:119], v11, s[16:19], s61 offen sc1
    s_add_u32 s61, s83, 524288
    buffer_store_dwordx4 v[120:123], v11, s[16:19], s61 offen sc1
    s_add_u32 s61, s83, 786432
    buffer_store_dwordx4 v[124:127], v11, s[16:19], s61 offen sc1
    s_barrier
    ds_read_b128 v[16:19], v8 offset:0
    ds_read_b128 v[20:23], v8 offset:2048
    ds_read_b128 v[24:27], v8 offset:4096
    ds_read_b128 v[28:31], v8 offset:6144
    ds_read_b128 v[32:35], v8 offset:8192
    ds_read_b128 v[36:39], v8 offset:10240
    ds_read_b128 v[40:43], v8 offset:12288
    ds_read_b128 v[44:47], v8 offset:14336
    s_waitcnt lgkmcnt(0)
    s_waitcnt vmcnt(0)
    s_mov_b64 exec, 1
    buffer_atomic_add v13, v12, s[32:35], 0 offen offset:640 sc1
    s_mov_b64 exec, -1
    s_add_u32 s61, s80, 0
    buffer_store_dwordx4 v[16:19], v9, s[16:19], s61 offen sc1
    s_add_u32 s61, s80, 131072
    buffer_store_dwordx4 v[20:23], v9, s[16:19], s61 offen sc1
    s_add_u32 s61, s80, 262144
    buffer_store_dwordx4 v[24:27], v9, s[16:19], s61 offen sc1
    s_add_u32 s61, s80, 393216
    buffer_store_dwordx4 v[28:31], v9, s[16:19], s61 offen sc1
    s_add_u32 s61, s80, 524288
    buffer_store_dwordx4 v[32:35], v9, s[16:19], s61 offen sc1
    s_add_u32 s61, s80, 655360
    buffer_store_dwordx4 v[36:39], v9, s[16:19], s61 offen sc1
    s_add_u32 s61, s80, 786432
    buffer_store_dwordx4 v[40:43], v9, s[16:19], s61 offen sc1
    s_add_u32 s61, s80, 917504
    buffer_store_dwordx4 v[44:47], v9, s[16:19], s61 offen sc1
    s_barrier
    ds_read_b128 v[48:51], v8 offset:32768
    ds_read_b128 v[52:55], v8 offset:34816
    ds_read_b128 v[56:59], v8 offset:36864
    ds_read_b128 v[60:63], v8 offset:38912
    ds_read_b128 v[64:67], v8 offset:40960
    ds_read_b128 v[68:71], v8 offset:43008
    ds_read_b128 v[72:75], v8 offset:45056
    ds_read_b128 v[76:79], v8 offset:47104
    s_waitcnt lgkmcnt(0)
    s_add_u32 s61, s81, 0
    buffer_store_dwordx4 v[48:51], v9, s[16:19], s61 offen sc1
    s_add_u32 s61, s81, 131072
    buffer_store_dwordx4 v[52:55], v9, s[16:19], s61 offen sc1
    s_add_u32 s61, s81, 262144
    buffer_store_dwordx4 v[56:59], v9, s[16:19], s61 offen sc1
    s_add_u32 s61, s81, 393216
    buffer_store_dwordx4 v[60:63], v9, s[16:19], s61 offen sc1
    s_add_u32 s61, s81, 524288
    buffer_store_dwordx4 v[64:67], v9, s[16:19], s61 offen sc1
    s_add_u32 s61, s81, 655360
    buffer_store_dwordx4 v[68:71], v9, s[16:19], s61 offen sc1
    s_add_u32 s61, s81, 786432
    buffer_store_dwordx4 v[72:75], v9, s[16:19], s61 offen sc1
    s_add_u32 s61, s81, 917504
    buffer_store_dwordx4 v[76:79], v9, s[16:19], s61 offen sc1
    s_waitcnt vmcnt(8)
    s_mov_b64 exec, 1
    buffer_atomic_add v13, v12, s[32:35], 0 offen offset:256 sc1
    s_mov_b64 exec, -1
    s_barrier
    ds_read_b128 v[80:83], v14 offset:0
    ds_read_b128 v[84:87], v14 offset:2048
    ds_read_b128 v[88:91], v14 offset:4096
    ds_read_b128 v[92:95], v14 offset:6144
    ds_read_b128 v[96:99], v14 offset:8192
    ds_read_b128 v[100:103], v14 offset:10240
    ds_read_b128 v[104:107], v14 offset:12288
    ds_read_b128 v[108:111], v14 offset:14336
    s_waitcnt lgkmcnt(0)
    s_add_u32 s61, s82, 0
    buffer_store_dwordx4 v[80:83], v9, s[16:19], s61 offen sc1
    s_add_u32 s61, s82, 131072
    buffer_store_dwordx4 v[84:87], v9, s[16:19], s61 offen sc1
    s_add_u32 s61, s82, 262144
    buffer_store_dwordx4 v[88:91], v9, s[16:19], s61 offen sc1
    s_add_u32 s61, s82, 393216
    buffer_store_dwordx4 v[92:95], v9, s[16:19], s61 offen sc1
    s_add_u32 s61, s82, 524288
    buffer_store_dwordx4 v[96:99], v9, s[16:19], s61 offen sc1
    s_add_u32 s61, s82, 655360
    buffer_store_dwordx4 v[100:103], v9, s[16:19], s61 offen sc1
    s_add_u32 s61, s82, 786432
    buffer_store_dwordx4 v[104:107], v9, s[16:19], s61 offen sc1
    s_add_u32 s61, s82, 917504
    buffer_store_dwordx4 v[108:111], v9, s[16:19], s61 offen sc1
    s_waitcnt lgkmcnt(0)
    s_add_u32 s46, s46, 640
    s_and_b32 s46, s46, 130944
    s_add_u32 s61, s46, 3539004
    s_load_dwordx2 s[78:79], s[50:51], s61
    s_add_u32 s46, s46, 640
    s_and_b32 s46, s46, 130944
    s_add_u32 s61, s46, 7209020
    s_load_dwordx2 s[78:79], s[50:51], s61
    s_branch P4_S
P4_cons:
    s_and_b32 s61, s3, 1
    s_lshl_b32 s61, s61, 13
    v_and_b32 v1, 15, v0
    v_lshrrev_b32 v2, 4, v0
    v_lshrrev_b32 v3, 1, v1
    v_xor_b32 v3, v2, v3
    v_lshlrev_b32 v4, 7, v1
    v_lshl_add_u32 v8, v3, 4, v4
    v_add_u32 v8, s61, v8
    v_xor_b32 v9, 64, v8
    v_add_u32 v8, 32768, v8
    v_add_u32 v9, 32768, v9
    v_lshrrev_b32 v3, 2, v1
    v_lshlrev_b32 v3, 7, v3
    v_lshl_add_u32 v3, v2, 10, v3
    v_and_b32 v4, 3, v1
    v_lshl_add_u32 v5, v4, 3, v3
    v_add_u32 v5, 49152, v5
    v_lshrrev_b32 v3, 3, v1
    v_and_b32 v4, 1, v2
    v_lshl_add_u32 v6, v4, 1, v3
    s_lshr_b32 s61, s3, 1
    s_lshl_b32 s62, s61, 13
    v_lshl_add_u32 v10, v6, 5, v5
    v_add_u32 v10, s62, v10
    v_xor_b32 v11, 32, v10
    v_xor_b32 v12, 64, v10
    v_xor_b32 v13, 0x60, v10
    s_lshl_b32 s61, s61, 8
    s_and_b32 s62, s3, 1
    s_mul_i32 s62, s62, 16896
    s_add_u32 s61, s61, s62
    v_mul_u32_u24 v7, 528, v1
    v_lshl_add_u32 v7, v2, 4, v7
    v_add_u32 v14, s61, v7
    v_lshrrev_b32 v3, 3, v0
    v_and_b32 v4, 7, v0
    v_lshlrev_b32 v3, 12, v3
    v_lshl_add_u32 v15, v4, 4, v3
    s_lshl_b32 s66, s4, 2
    s_add_u32 s66, s66, s3
    s_lshl_b32 s66, s66, 17
    s_xor_b32 s67, s5, 8
    s_cmp_ge_u32 s67, 3
    s_addc_u32 s61, s67, 0
    s_cmp_ge_u32 s67, 10
    s_addc_u32 s67, s61, 0
    s_lshl_b32 s67, s67, 7
    s_add_u32 s67, s67, s66
    s_add_u32 s66, s66, s77
    s_lshl_b32 s68, s2, 7
    s_lshl_b32 s61, s3, 2
    s_add_u32 s68, s68, s61
    s_add_u32 s68, s68, 0x10000
    s_xor_b32 s69, s68, 512
    s_mov_b32 s20, s56
    s_mov_b32 s21, s57
    s_mov_b32 s22, 8388608
    s_mov_b32 s23, 0x20000
    v_mov_b32 v16, 0
    v_mov_b32 v17, 0
    v_mov_b32 v18, 0
    v_mov_b32 v19, 0
    v_mov_b32 v20, 0
    v_mov_b32 v21, 0
    v_mov_b32 v22, 0
    v_mov_b32 v23, 0
    v_mov_b32 v24, 0
    v_mov_b32 v25, 0
    v_mov_b32 v26, 0
    v_mov_b32 v27, 0
    v_mov_b32 v28, 0
    v_mov_b32 v29, 0
    v_mov_b32 v30, 0
    v_mov_b32 v31, 0
    v_mov_b32 v32, 0
    v_mov_b32 v33, 0
    v_mov_b32 v34, 0
    v_mov_b32 v35, 0
    v_mov_b32 v36, 0
    v_mov_b32 v37, 0
    v_mov_b32 v38, 0
    v_mov_b32 v39, 0
    v_mov_b32 v40, 0
    v_mov_b32 v41, 0
    v_mov_b32 v42, 0
    v_mov_b32 v43, 0
    v_mov_b32 v44, 0
    v_mov_b32 v45, 0
    v_mov_b32 v46, 0
    v_mov_b32 v47, 0
    v_mov_b32 v48, 0
    v_mov_b32 v49, 0
    v_mov_b32 v50, 0
    v_mov_b32 v51, 0
    v_mov_b32 v52, 0
    v_mov_b32 v53, 0
    v_mov_b32 v54, 0
    v_mov_b32 v55, 0
    v_mov_b32 v56, 0
    v_mov_b32 v57, 0
    v_mov_b32 v58, 0
    v_mov_b32 v59, 0
    v_mov_b32 v60, 0
    v_mov_b32 v61, 0
    v_mov_b32 v62, 0
    v_mov_b32 v63, 0
    v_mov_b32 v64, 0
    v_mov_b32 v65, 0
    v_mov_b32 v66, 0
    v_mov_b32 v67, 0
    v_mov_b32 v68, 0
    v_mov_b32 v69, 0
    v_mov_b32 v70, 0
    v_mov_b32 v71, 0
    v_mov_b32 v72, 0
    v_mov_b32 v73, 0
    v_mov_b32 v74, 0
    v_mov_b32 v75, 0
    v_mov_b32 v76, 0
    v_mov_b32 v77, 0
    v_mov_b32 v78, 0
    v_mov_b32 v79, 0
    v_add_u32 v150, 65536, v8
    v_add_u32 v151, 65536, v9
    v_add_u32 v152, 65536, v10
    v_add_u32 v153, 65536, v11
    v_add_u32 v154, 65536, v12
    v_add_u32 v155, 65536, v13
    s_mov_b32 s58, 0
    s_barrier
    ds_read_b64_tr_b16 v[96:97], v10 offset:32768
    ds_read_b64_tr_b16 v[98:99], v10 offset:33280
    ds_read_b128 v[80:83], v8 offset:32768
    ds_read_b128 v[84:87], v8 offset:34816
    ds_read_b128 v[88:91], v8 offset:36864
    ds_read_b128 v[92:95], v8 offset:38912
    ds_read_b64_tr_b16 v[100:101], v11 offset:32768
    ds_read_b64_tr_b16 v[102:103], v11 offset:33280
    ds_read_b64_tr_b16 v[104:105], v12 offset:32768
    ds_read_b64_tr_b16 v[106:107], v12 offset:33280
    ds_read_b64_tr_b16 v[108:109], v13 offset:32768
    ds_read_b64_tr_b16 v[110:111], v13 offset:33280
    s_waitcnt lgkmcnt(0)
Lcl_44:
    v_mfma_f32_16x16x32_bf16 v[16:19], v[96:99], v[80:83], v[16:19]
    ds_read_b64_tr_b16 v[128:129], v10 offset:36864
    v_mfma_f32_16x16x32_bf16 v[32:35], v[96:99], v[84:87], v[32:35]
    ds_read_b64_tr_b16 v[130:131], v10 offset:37376
    v_mfma_f32_16x16x32_bf16 v[48:51], v[96:99], v[88:91], v[48:51]
    ds_read_b128 v[112:115], v9 offset:32768
    v_mfma_f32_16x16x32_bf16 v[64:67], v[96:99], v[92:95], v[64:67]
    ds_read_b128 v[116:119], v9 offset:34816
    v_mfma_f32_16x16x32_bf16 v[20:23], v[100:103], v[80:83], v[20:23]
    ds_read_b128 v[120:123], v9 offset:36864
    v_mfma_f32_16x16x32_bf16 v[36:39], v[100:103], v[84:87], v[36:39]
    ds_read_b128 v[124:127], v9 offset:38912
    v_mfma_f32_16x16x32_bf16 v[52:55], v[100:103], v[88:91], v[52:55]
    ds_read_b64_tr_b16 v[132:133], v11 offset:36864
    v_mfma_f32_16x16x32_bf16 v[68:71], v[100:103], v[92:95], v[68:71]
    ds_read_b64_tr_b16 v[134:135], v11 offset:37376
    v_mfma_f32_16x16x32_bf16 v[24:27], v[104:107], v[80:83], v[24:27]
    ds_read_b64_tr_b16 v[136:137], v12 offset:36864
    v_mfma_f32_16x16x32_bf16 v[40:43], v[104:107], v[84:87], v[40:43]
    ds_read_b64_tr_b16 v[138:139], v12 offset:37376
    v_mfma_f32_16x16x32_bf16 v[56:59], v[104:107], v[88:91], v[56:59]
    ds_read_b64_tr_b16 v[140:141], v13 offset:36864
    v_mfma_f32_16x16x32_bf16 v[72:75], v[104:107], v[92:95], v[72:75]
    ds_read_b64_tr_b16 v[142:143], v13 offset:37376
    v_mfma_f32_16x16x32_bf16 v[28:31], v[108:111], v[80:83], v[28:31]
    v_mfma_f32_16x16x32_bf16 v[44:47], v[108:111], v[84:87], v[44:47]
    v_mfma_f32_16x16x32_bf16 v[60:63], v[108:111], v[88:91], v[60:63]
    s_add_u32 s58, s58, 1
    v_mfma_f32_16x16x32_bf16 v[76:79], v[108:111], v[92:95], v[76:79]
    s_waitcnt lgkmcnt(0)
    s_barrier
    v_mfma_f32_16x16x32_bf16 v[16:19], v[128:131], v[112:115], v[16:19]
    ds_read_b64_tr_b16 v[96:97], v152 offset:0
    v_mfma_f32_16x16x32_bf16 v[32:35], v[128:131], v[116:119], v[32:35]
    ds_read_b64_tr_b16 v[98:99], v152 offset:512
    v_mfma_f32_16x16x32_bf16 v[48:51], v[128:131], v[120:123], v[48:51]
    ds_read_b128 v[80:83], v150 offset:0
    v_mfma_f32_16x16x32_bf16 v[64:67], v[128:131], v[124:127], v[64:67]
    ds_read_b128 v[84:87], v150 offset:2048
    v_mfma_f32_16x16x32_bf16 v[20:23], v[132:135], v[112:115], v[20:23]
    ds_read_b128 v[88:91], v150 offset:4096
    v_mfma_f32_16x16x32_bf16 v[36:39], v[132:135], v[116:119], v[36:39]
    ds_read_b128 v[92:95], v150 offset:6144
    v_mfma_f32_16x16x32_bf16 v[52:55], v[132:135], v[120:123], v[52:55]
    ds_read_b64_tr_b16 v[100:101], v153 offset:0
    v_mfma_f32_16x16x32_bf16 v[68:71], v[132:135], v[124:127], v[68:71]
    ds_read_b64_tr_b16 v[102:103], v153 offset:512
    v_mfma_f32_16x16x32_bf16 v[24:27], v[136:139], v[112:115], v[24:27]
    ds_read_b64_tr_b16 v[104:105], v154 offset:0
    v_mfma_f32_16x16x32_bf16 v[40:43], v[136:139], v[116:119], v[40:43]
    ds_read_b64_tr_b16 v[106:107], v154 offset:512
    v_mfma_f32_16x16x32_bf16 v[56:59], v[136:139], v[120:123], v[56:59]
    ds_read_b64_tr_b16 v[108:109], v155 offset:0
    v_mfma_f32_16x16x32_bf16 v[72:75], v[136:139], v[124:127], v[72:75]
    ds_read_b64_tr_b16 v[110:111], v155 offset:512
    v_mfma_f32_16x16x32_bf16 v[28:31], v[140:143], v[112:115], v[28:31]
    v_mfma_f32_16x16x32_bf16 v[44:47], v[140:143], v[116:119], v[44:47]
    v_mfma_f32_16x16x32_bf16 v[60:63], v[140:143], v[120:123], v[60:63]
    v_mfma_f32_16x16x32_bf16 v[76:79], v[140:143], v[124:127], v[76:79]
    s_waitcnt lgkmcnt(0)
    v_mfma_f32_16x16x32_bf16 v[16:19], v[96:99], v[80:83], v[16:19]
    ds_read_b64_tr_b16 v[128:129], v152 offset:4096
    v_mfma_f32_16x16x32_bf16 v[32:35], v[96:99], v[84:87], v[32:35]
    ds_read_b64_tr_b16 v[130:131], v152 offset:4608
    v_mfma_f32_16x16x32_bf16 v[48:51], v[96:99], v[88:91], v[48:51]
    ds_read_b128 v[112:115], v151 offset:0
    v_mfma_f32_16x16x32_bf16 v[64:67], v[96:99], v[92:95], v[64:67]
    ds_read_b128 v[116:119], v151 offset:2048
    v_mfma_f32_16x16x32_bf16 v[20:23], v[100:103], v[80:83], v[20:23]
    ds_read_b128 v[120:123], v151 offset:4096
    v_mfma_f32_16x16x32_bf16 v[36:39], v[100:103], v[84:87], v[36:39]
    ds_read_b128 v[124:127], v151 offset:6144
    v_mfma_f32_16x16x32_bf16 v[52:55], v[100:103], v[88:91], v[52:55]
    ds_read_b64_tr_b16 v[132:133], v153 offset:4096
    v_mfma_f32_16x16x32_bf16 v[68:71], v[100:103], v[92:95], v[68:71]
    ds_read_b64_tr_b16 v[134:135], v153 offset:4608
    v_mfma_f32_16x16x32_bf16 v[24:27], v[104:107], v[80:83], v[24:27]
    ds_read_b64_tr_b16 v[136:137], v154 offset:4096
    v_mfma_f32_16x16x32_bf16 v[40:43], v[104:107], v[84:87], v[40:43]
    ds_read_b64_tr_b16 v[138:139], v154 offset:4608
    v_mfma_f32_16x16x32_bf16 v[56:59], v[104:107], v[88:91], v[56:59]
    ds_read_b64_tr_b16 v[140:141], v155 offset:4096
    v_mfma_f32_16x16x32_bf16 v[72:75], v[104:107], v[92:95], v[72:75]
    ds_read_b64_tr_b16 v[142:143], v155 offset:4608
    v_mfma_f32_16x16x32_bf16 v[28:31], v[108:111], v[80:83], v[28:31]
    v_mfma_f32_16x16x32_bf16 v[44:47], v[108:111], v[84:87], v[44:47]
    v_mfma_f32_16x16x32_bf16 v[60:63], v[108:111], v[88:91], v[60:63]
    s_add_u32 s58, s58, 1
    v_mfma_f32_16x16x32_bf16 v[76:79], v[108:111], v[92:95], v[76:79]
    s_waitcnt lgkmcnt(0)
    s_barrier
    v_mfma_f32_16x16x32_bf16 v[16:19], v[128:131], v[112:115], v[16:19]
    ds_read_b64_tr_b16 v[96:97], v152 offset:32768
    v_mfma_f32_16x16x32_bf16 v[32:35], v[128:131], v[116:119], v[32:35]
    ds_read_b64_tr_b16 v[98:99], v152 offset:33280
    v_mfma_f32_16x16x32_bf16 v[48:51], v[128:131], v[120:123], v[48:51]
    ds_read_b128 v[80:83], v150 offset:32768
    v_mfma_f32_16x16x32_bf16 v[64:67], v[128:131], v[124:127], v[64:67]
    ds_read_b128 v[84:87], v150 offset:34816
    v_mfma_f32_16x16x32_bf16 v[20:23], v[132:135], v[112:115], v[20:23]
    ds_read_b128 v[88:91], v150 offset:36864
    v_mfma_f32_16x16x32_bf16 v[36:39], v[132:135], v[116:119], v[36:39]
    ds_read_b128 v[92:95], v150 offset:38912
    v_mfma_f32_16x16x32_bf16 v[52:55], v[132:135], v[120:123], v[52:55]
    ds_read_b64_tr_b16 v[100:101], v153 offset:32768
    v_mfma_f32_16x16x32_bf16 v[68:71], v[132:135], v[124:127], v[68:71]
    ds_read_b64_tr_b16 v[102:103], v153 offset:33280
    v_mfma_f32_16x16x32_bf16 v[24:27], v[136:139], v[112:115], v[24:27]
    ds_read_b64_tr_b16 v[104:105], v154 offset:32768
    v_mfma_f32_16x16x32_bf16 v[40:43], v[136:139], v[116:119], v[40:43]
    ds_read_b64_tr_b16 v[106:107], v154 offset:33280
    v_mfma_f32_16x16x32_bf16 v[56:59], v[136:139], v[120:123], v[56:59]
    ds_read_b64_tr_b16 v[108:109], v155 offset:32768
    v_mfma_f32_16x16x32_bf16 v[72:75], v[136:139], v[124:127], v[72:75]
    ds_read_b64_tr_b16 v[110:111], v155 offset:33280
    v_mfma_f32_16x16x32_bf16 v[28:31], v[140:143], v[112:115], v[28:31]
    v_mfma_f32_16x16x32_bf16 v[44:47], v[140:143], v[116:119], v[44:47]
    v_mfma_f32_16x16x32_bf16 v[60:63], v[140:143], v[120:123], v[60:63]
    v_mfma_f32_16x16x32_bf16 v[76:79], v[140:143], v[124:127], v[76:79]
    s_waitcnt lgkmcnt(0)
    v_mfma_f32_16x16x32_bf16 v[16:19], v[96:99], v[80:83], v[16:19]
    ds_read_b64_tr_b16 v[128:129], v152 offset:36864
    v_mfma_f32_16x16x32_bf16 v[32:35], v[96:99], v[84:87], v[32:35]
    ds_read_b64_tr_b16 v[130:131], v152 offset:37376
    v_mfma_f32_16x16x32_bf16 v[48:51], v[96:99], v[88:91], v[48:51]
    ds_read_b128 v[112:115], v151 offset:32768
    v_mfma_f32_16x16x32_bf16 v[64:67], v[96:99], v[92:95], v[64:67]
    ds_read_b128 v[116:119], v151 offset:34816
    v_mfma_f32_16x16x32_bf16 v[20:23], v[100:103], v[80:83], v[20:23]
    ds_read_b128 v[120:123], v151 offset:36864
    v_mfma_f32_16x16x32_bf16 v[36:39], v[100:103], v[84:87], v[36:39]
    ds_read_b128 v[124:127], v151 offset:38912
    v_mfma_f32_16x16x32_bf16 v[52:55], v[100:103], v[88:91], v[52:55]
    ds_read_b64_tr_b16 v[132:133], v153 offset:36864
    v_mfma_f32_16x16x32_bf16 v[68:71], v[100:103], v[92:95], v[68:71]
    ds_read_b64_tr_b16 v[134:135], v153 offset:37376
    v_mfma_f32_16x16x32_bf16 v[24:27], v[104:107], v[80:83], v[24:27]
    ds_read_b64_tr_b16 v[136:137], v154 offset:36864
    v_mfma_f32_16x16x32_bf16 v[40:43], v[104:107], v[84:87], v[40:43]
    ds_read_b64_tr_b16 v[138:139], v154 offset:37376
    v_mfma_f32_16x16x32_bf16 v[56:59], v[104:107], v[88:91], v[56:59]
    ds_read_b64_tr_b16 v[140:141], v155 offset:36864
    v_mfma_f32_16x16x32_bf16 v[72:75], v[104:107], v[92:95], v[72:75]
    ds_read_b64_tr_b16 v[142:143], v155 offset:37376
    v_mfma_f32_16x16x32_bf16 v[28:31], v[108:111], v[80:83], v[28:31]
    v_mfma_f32_16x16x32_bf16 v[44:47], v[108:111], v[84:87], v[44:47]
    v_mfma_f32_16x16x32_bf16 v[60:63], v[108:111], v[88:91], v[60:63]
    s_add_u32 s58, s58, 1
    v_mfma_f32_16x16x32_bf16 v[76:79], v[108:111], v[92:95], v[76:79]
    s_waitcnt lgkmcnt(0)
    s_barrier
    v_mfma_f32_16x16x32_bf16 v[16:19], v[128:131], v[112:115], v[16:19]
    ds_read_b64_tr_b16 v[96:97], v10 offset:0
    v_mfma_f32_16x16x32_bf16 v[32:35], v[128:131], v[116:119], v[32:35]
    ds_read_b64_tr_b16 v[98:99], v10 offset:512
    v_mfma_f32_16x16x32_bf16 v[48:51], v[128:131], v[120:123], v[48:51]
    ds_read_b128 v[80:83], v8 offset:0
    v_mfma_f32_16x16x32_bf16 v[64:67], v[128:131], v[124:127], v[64:67]
    ds_read_b128 v[84:87], v8 offset:2048
    v_mfma_f32_16x16x32_bf16 v[20:23], v[132:135], v[112:115], v[20:23]
    ds_read_b128 v[88:91], v8 offset:4096
    v_mfma_f32_16x16x32_bf16 v[36:39], v[132:135], v[116:119], v[36:39]
    ds_read_b128 v[92:95], v8 offset:6144
    v_mfma_f32_16x16x32_bf16 v[52:55], v[132:135], v[120:123], v[52:55]
    ds_read_b64_tr_b16 v[100:101], v11 offset:0
    v_mfma_f32_16x16x32_bf16 v[68:71], v[132:135], v[124:127], v[68:71]
    ds_read_b64_tr_b16 v[102:103], v11 offset:512
    v_mfma_f32_16x16x32_bf16 v[24:27], v[136:139], v[112:115], v[24:27]
    ds_read_b64_tr_b16 v[104:105], v12 offset:0
    v_mfma_f32_16x16x32_bf16 v[40:43], v[136:139], v[116:119], v[40:43]
    ds_read_b64_tr_b16 v[106:107], v12 offset:512
    v_mfma_f32_16x16x32_bf16 v[56:59], v[136:139], v[120:123], v[56:59]
    ds_read_b64_tr_b16 v[108:109], v13 offset:0
    v_mfma_f32_16x16x32_bf16 v[72:75], v[136:139], v[124:127], v[72:75]
    ds_read_b64_tr_b16 v[110:111], v13 offset:512
    v_mfma_f32_16x16x32_bf16 v[28:31], v[140:143], v[112:115], v[28:31]
    v_mfma_f32_16x16x32_bf16 v[44:47], v[140:143], v[116:119], v[44:47]
    v_mfma_f32_16x16x32_bf16 v[60:63], v[140:143], v[120:123], v[60:63]
    v_mfma_f32_16x16x32_bf16 v[76:79], v[140:143], v[124:127], v[76:79]
    s_waitcnt lgkmcnt(0)
    v_mfma_f32_16x16x32_bf16 v[16:19], v[96:99], v[80:83], v[16:19]
    ds_read_b64_tr_b16 v[128:129], v10 offset:4096
    v_mfma_f32_16x16x32_bf16 v[32:35], v[96:99], v[84:87], v[32:35]
    ds_read_b64_tr_b16 v[130:131], v10 offset:4608
    v_mfma_f32_16x16x32_bf16 v[48:51], v[96:99], v[88:91], v[48:51]
    ds_read_b128 v[112:115], v9 offset:0
    v_mfma_f32_16x16x32_bf16 v[64:67], v[96:99], v[92:95], v[64:67]
    ds_read_b128 v[116:119], v9 offset:2048
    v_mfma_f32_16x16x32_bf16 v[20:23], v[100:103], v[80:83], v[20:23]
    ds_read_b128 v[120:123], v9 offset:4096
    v_mfma_f32_16x16x32_bf16 v[36:39], v[100:103], v[84:87], v[36:39]
    ds_read_b128 v[124:127], v9 offset:6144
    v_mfma_f32_16x16x32_bf16 v[52:55], v[100:103], v[88:91], v[52:55]
    ds_read_b64_tr_b16 v[132:133], v11 offset:4096
    v_mfma_f32_16x16x32_bf16 v[68:71], v[100:103], v[92:95], v[68:71]
    ds_read_b64_tr_b16 v[134:135], v11 offset:4608
    v_mfma_f32_16x16x32_bf16 v[24:27], v[104:107], v[80:83], v[24:27]
    ds_read_b64_tr_b16 v[136:137], v12 offset:4096
    v_mfma_f32_16x16x32_bf16 v[40:43], v[104:107], v[84:87], v[40:43]
    ds_read_b64_tr_b16 v[138:139], v12 offset:4608
    v_mfma_f32_16x16x32_bf16 v[56:59], v[104:107], v[88:91], v[56:59]
    ds_read_b64_tr_b16 v[140:141], v13 offset:4096
    v_mfma_f32_16x16x32_bf16 v[72:75], v[104:107], v[92:95], v[72:75]
    ds_read_b64_tr_b16 v[142:143], v13 offset:4608
    v_mfma_f32_16x16x32_bf16 v[28:31], v[108:111], v[80:83], v[28:31]
    v_mfma_f32_16x16x32_bf16 v[44:47], v[108:111], v[84:87], v[44:47]
    v_mfma_f32_16x16x32_bf16 v[60:63], v[108:111], v[88:91], v[60:63]
    s_add_u32 s58, s58, 1
    v_mfma_f32_16x16x32_bf16 v[76:79], v[108:111], v[92:95], v[76:79]
    s_waitcnt lgkmcnt(0)
    s_barrier
    v_mfma_f32_16x16x32_bf16 v[16:19], v[128:131], v[112:115], v[16:19]
    ds_read_b64_tr_b16 v[96:97], v10 offset:32768
    v_mfma_f32_16x16x32_bf16 v[32:35], v[128:131], v[116:119], v[32:35]
    ds_read_b64_tr_b16 v[98:99], v10 offset:33280
    v_mfma_f32_16x16x32_bf16 v[48:51], v[128:131], v[120:123], v[48:51]
    ds_read_b128 v[80:83], v8 offset:32768
    v_mfma_f32_16x16x32_bf16 v[64:67], v[128:131], v[124:127], v[64:67]
    ds_read_b128 v[84:87], v8 offset:34816
    v_mfma_f32_16x16x32_bf16 v[20:23], v[132:135], v[112:115], v[20:23]
    ds_read_b128 v[88:91], v8 offset:36864
    v_mfma_f32_16x16x32_bf16 v[36:39], v[132:135], v[116:119], v[36:39]
    ds_read_b128 v[92:95], v8 offset:38912
    v_mfma_f32_16x16x32_bf16 v[52:55], v[132:135], v[120:123], v[52:55]
    ds_read_b64_tr_b16 v[100:101], v11 offset:32768
    v_mfma_f32_16x16x32_bf16 v[68:71], v[132:135], v[124:127], v[68:71]
    ds_read_b64_tr_b16 v[102:103], v11 offset:33280
    v_mfma_f32_16x16x32_bf16 v[24:27], v[136:139], v[112:115], v[24:27]
    ds_read_b64_tr_b16 v[104:105], v12 offset:32768
    v_mfma_f32_16x16x32_bf16 v[40:43], v[136:139], v[116:119], v[40:43]
    ds_read_b64_tr_b16 v[106:107], v12 offset:33280
    v_mfma_f32_16x16x32_bf16 v[56:59], v[136:139], v[120:123], v[56:59]
    ds_read_b64_tr_b16 v[108:109], v13 offset:32768
    v_mfma_f32_16x16x32_bf16 v[72:75], v[136:139], v[124:127], v[72:75]
    ds_read_b64_tr_b16 v[110:111], v13 offset:33280
    v_mfma_f32_16x16x32_bf16 v[28:31], v[140:143], v[112:115], v[28:31]
    v_mfma_f32_16x16x32_bf16 v[44:47], v[140:143], v[116:119], v[44:47]
    v_mfma_f32_16x16x32_bf16 v[60:63], v[140:143], v[120:123], v[60:63]
    s_cmp_lt_u32 s58, 28
    v_mfma_f32_16x16x32_bf16 v[76:79], v[140:143], v[124:127], v[76:79]
    s_waitcnt lgkmcnt(0)
    s_cbranch_scc1 Lcl_44
Lcx_45:
    s_cmp_eq_u32 s6, 0
    s_cbranch_scc0 P4_x1
    s_nop 4
    v_cvt_pk_bf16_f32 v80, v48, v49
    v_cvt_pk_bf16_f32 v81, v50, v51
    v_cvt_pk_bf16_f32 v82, v52, v53
    v_cvt_pk_bf16_f32 v83, v54, v55
    buffer_store_dwordx4 v[80:83], v15, s[20:23], s66 offen sc1
    v_cvt_pk_bf16_f32 v84, v56, v57
    v_cvt_pk_bf16_f32 v85, v58, v59
    v_cvt_pk_bf16_f32 v86, v60, v61
    v_cvt_pk_bf16_f32 v87, v62, v63
    s_add_u32 s66, s66, 32768
    buffer_store_dwordx4 v[84:87], v15, s[20:23], s66 offen sc1
    v_cvt_pk_bf16_f32 v88, v64, v65
    v_cvt_pk_bf16_f32 v89, v66, v67
    v_cvt_pk_bf16_f32 v90, v68, v69
    v_cvt_pk_bf16_f32 v91, v70, v71
    s_add_u32 s66, s66, 32768
    buffer_store_dwordx4 v[88:91], v15, s[20:23], s66 offen sc1
    v_cvt_pk_bf16_f32 v92, v72, v73
    v_cvt_pk_bf16_f32 v93, v74, v75
    v_cvt_pk_bf16_f32 v94, v76, v77
    v_cvt_pk_bf16_f32 v95, v78, v79
    s_add_u32 s66, s66, 32768
    buffer_store_dwordx4 v[92:95], v15, s[20:23], s66 offen sc1
    v_mov_b32 v3, s68
    v_mov_b32 v4, 1
    v_mov_b32 v5, s69
    s_waitcnt vmcnt(0)
    s_mov_b64 exec, 1
    buffer_store_dword v4, v3, s[32:35], 0 offen sc1
    s_mov_b64 exec, -1
    s_mov_b32 s58, 20000
Lpoll_46:
    buffer_load_dword v248, v5, s[32:35], 0 offen offset:0 sc1
    s_sub_u32 s58, s58, 1
    s_waitcnt vmcnt(0)
    v_readfirstlane_b32 s61, v248
    s_cmp_ge_u32 s61, 1
    s_cbranch_scc1 Lpok_47
    s_sleep 2
    s_cmp_lg_u32 s58, 0
    s_cbranch_scc1 Lpoll_46
Lpok_47:
    buffer_load_dwordx4 v[96:99], v15, s[20:23], s67 offen sc1
    s_add_u32 s67, s67, 32768
    buffer_load_dwordx4 v[100:103], v15, s[20:23], s67 offen sc1
    s_add_u32 s67, s67, 32768
    buffer_load_dwordx4 v[104:107], v15, s[20:23], s67 offen sc1
    s_add_u32 s67, s67, 32768
    buffer_load_dwordx4 v[108:111], v15, s[20:23], s67 offen sc1
    s_waitcnt vmcnt(3)
    v_lshlrev_b32 v112, 16, v96
    v_and_b32 v113, 0xffff0000, v96
    v_lshlrev_b32 v114, 16, v97
    v_and_b32 v115, 0xffff0000, v97
    v_pk_add_f32 v[16:17], v[16:17], v[112:113]
    v_pk_add_f32 v[18:19], v[18:19], v[114:115]
    ds_write_b128 v14, v[16:19] offset:32768
    v_lshlrev_b32 v112, 16, v98
    v_and_b32 v113, 0xffff0000, v98
    v_lshlrev_b32 v114, 16, v99
    v_and_b32 v115, 0xffff0000, v99
    v_pk_add_f32 v[20:21], v[20:21], v[112:113]
    v_pk_add_f32 v[22:23], v[22:23], v[114:115]
    ds_write_b128 v14, v[20:23] offset:32832
    s_waitcnt vmcnt(2)
    v_lshlrev_b32 v112, 16, v100
    v_and_b32 v113, 0xffff0000, v100
    v_lshlrev_b32 v114, 16, v101
    v_and_b32 v115, 0xffff0000, v101
    v_pk_add_f32 v[24:25], v[24:25], v[112:113]
    v_pk_add_f32 v[26:27], v[26:27], v[114:115]
    ds_write_b128 v14, v[24:27] offset:32896
    v_lshlrev_b32 v112, 16, v102
    v_and_b32 v113, 0xffff0000, v102
    v_lshlrev_b32 v114, 16, v103
    v_and_b32 v115, 0xffff0000, v103
    v_pk_add_f32 v[28:29], v[28:29], v[112:113]
    v_pk_add_f32 v[30:31], v[30:31], v[114:115]
    ds_write_b128 v14, v[28:31] offset:32960
    s_waitcnt vmcnt(1)
    v_lshlrev_b32 v112, 16, v104
    v_and_b32 v113, 0xffff0000, v104
    v_lshlrev_b32 v114, 16, v105
    v_and_b32 v115, 0xffff0000, v105
    v_pk_add_f32 v[32:33], v[32:33], v[112:113]
    v_pk_add_f32 v[34:35], v[34:35], v[114:115]
    ds_write_b128 v14, v[32:35] offset:41216
    v_lshlrev_b32 v112, 16, v106
    v_and_b32 v113, 0xffff0000, v106
    v_lshlrev_b32 v114, 16, v107
    v_and_b32 v115, 0xffff0000, v107
    v_pk_add_f32 v[36:37], v[36:37], v[112:113]
    v_pk_add_f32 v[38:39], v[38:39], v[114:115]
    ds_write_b128 v14, v[36:39] offset:41280
    s_waitcnt vmcnt(0)
    v_lshlrev_b32 v112, 16, v108
    v_and_b32 v113, 0xffff0000, v108
    v_lshlrev_b32 v114, 16, v109
    v_and_b32 v115, 0xffff0000, v109
    v_pk_add_f32 v[40:41], v[40:41], v[112:113]
    v_pk_add_f32 v[42:43], v[42:43], v[114:115]
    ds_write_b128 v14, v[40:43] offset:41344
    v_lshlrev_b32 v112, 16, v110
    v_and_b32 v113, 0xffff0000, v110
    v_lshlrev_b32 v114, 16, v111
    v_and_b32 v115, 0xffff0000, v111
    v_pk_add_f32 v[44:45], v[44:45], v[112:113]
    v_pk_add_f32 v[46:47], v[46:47], v[114:115]
    ds_write_b128 v14, v[44:47] offset:41408
    s_branch P4_epi
P4_x1:
    s_nop 4
    v_cvt_pk_bf16_f32 v80, v16, v17
    v_cvt_pk_bf16_f32 v81, v18, v19
    v_cvt_pk_bf16_f32 v82, v20, v21
    v_cvt_pk_bf16_f32 v83, v22, v23
    buffer_store_dwordx4 v[80:83], v15, s[20:23], s66 offen sc1
    v_cvt_pk_bf16_f32 v84, v24, v25
    v_cvt_pk_bf16_f32 v85, v26, v27
    v_cvt_pk_bf16_f32 v86, v28, v29
    v_cvt_pk_bf16_f32 v87, v30, v31
    s_add_u32 s66, s66, 32768
    buffer_store_dwordx4 v[84:87], v15, s[20:23], s66 offen sc1
    v_cvt_pk_bf16_f32 v88, v32, v33
    v_cvt_pk_bf16_f32 v89, v34, v35
    v_cvt_pk_bf16_f32 v90, v36, v37
    v_cvt_pk_bf16_f32 v91, v38, v39
    s_add_u32 s66, s66, 32768
    buffer_store_dwordx4 v[88:91], v15, s[20:23], s66 offen sc1
    v_cvt_pk_bf16_f32 v92, v40, v41
    v_cvt_pk_bf16_f32 v93, v42, v43
    v_cvt_pk_bf16_f32 v94, v44, v45
    v_cvt_pk_bf16_f32 v95, v46, v47
    s_add_u32 s66, s66, 32768
    buffer_store_dwordx4 v[92:95], v15, s[20:23], s66 offen sc1
    v_mov_b32 v3, s68
    v_mov_b32 v4, 1
    v_mov_b32 v5, s69
    s_waitcnt vmcnt(0)
    s_mov_b64 exec, 1
    buffer_store_dword v4, v3, s[32:35], 0 offen sc1
    s_mov_b64 exec, -1
    s_mov_b32 s58, 20000
Lpoll_48:
    buffer_load_dword v248, v5, s[32:35], 0 offen offset:0 sc1
    s_sub_u32 s58, s58, 1
    s_waitcnt vmcnt(0)
    v_readfirstlane_b32 s61, v248
    s_cmp_ge_u32 s61, 1
    s_cbranch_scc1 Lpok_49
    s_sleep 2
    s_cmp_lg_u32 s58, 0
    s_cbranch_scc1 Lpoll_48
Lpok_49:
    buffer_load_dwordx4 v[96:99], v15, s[20:23], s67 offen sc1
    s_add_u32 s67, s67, 32768
    buffer_load_dwordx4 v[100:103], v15, s[20:23], s67 offen sc1
    s_add_u32 s67, s67, 32768
    buffer_load_dwordx4 v[104:107], v15, s[20:23], s67 offen sc1
    s_add_u32 s67, s67, 32768
    buffer_load_dwordx4 v[108:111], v15, s[20:23], s67 offen sc1
    s_waitcnt vmcnt(3)
    v_lshlrev_b32 v112, 16, v96
    v_and_b32 v113, 0xffff0000, v96
    v_lshlrev_b32 v114, 16, v97
    v_and_b32 v115, 0xffff0000, v97
    v_pk_add_f32 v[48:49], v[48:49], v[112:113]
    v_pk_add_f32 v[50:51], v[50:51], v[114:115]
    ds_write_b128 v14, v[48:51] offset:32768
    v_lshlrev_b32 v112, 16, v98
    v_and_b32 v113, 0xffff0000, v98
    v_lshlrev_b32 v114, 16, v99
    v_and_b32 v115, 0xffff0000, v99
    v_pk_add_f32 v[52:53], v[52:53], v[112:113]
    v_pk_add_f32 v[54:55], v[54:55], v[114:115]
    ds_write_b128 v14, v[52:55] offset:32832
    s_waitcnt vmcnt(2)
    v_lshlrev_b32 v112, 16, v100
    v_and_b32 v113, 0xffff0000, v100
    v_lshlrev_b32 v114, 16, v101
    v_and_b32 v115, 0xffff0000, v101
    v_pk_add_f32 v[56:57], v[56:57], v[112:113]
    v_pk_add_f32 v[58:59], v[58:59], v[114:115]
    ds_write_b128 v14, v[56:59] offset:32896
    v_lshlrev_b32 v112, 16, v102
    v_and_b32 v113, 0xffff0000, v102
    v_lshlrev_b32 v114, 16, v103
    v_and_b32 v115, 0xffff0000, v103
    v_pk_add_f32 v[60:61], v[60:61], v[112:113]
    v_pk_add_f32 v[62:63], v[62:63], v[114:115]
    ds_write_b128 v14, v[60:63] offset:32960
    s_waitcnt vmcnt(1)
    v_lshlrev_b32 v112, 16, v104
    v_and_b32 v113, 0xffff0000, v104
    v_lshlrev_b32 v114, 16, v105
    v_and_b32 v115, 0xffff0000, v105
    v_pk_add_f32 v[64:65], v[64:65], v[112:113]
    v_pk_add_f32 v[66:67], v[66:67], v[114:115]
    ds_write_b128 v14, v[64:67] offset:41216
    v_lshlrev_b32 v112, 16, v106
    v_and_b32 v113, 0xffff0000, v106
    v_lshlrev_b32 v114, 16, v107
    v_and_b32 v115, 0xffff0000, v107
    v_pk_add_f32 v[68:69], v[68:69], v[112:113]
    v_pk_add_f32 v[70:71], v[70:71], v[114:115]
    ds_write_b128 v14, v[68:71] offset:41280
    s_waitcnt vmcnt(0)
    v_lshlrev_b32 v112, 16, v108
    v_and_b32 v113, 0xffff0000, v108
    v_lshlrev_b32 v114, 16, v109
    v_and_b32 v115, 0xffff0000, v109
    v_pk_add_f32 v[72:73], v[72:73], v[112:113]
    v_pk_add_f32 v[74:75], v[74:75], v[114:115]
    ds_write_b128 v14, v[72:75] offset:41344
    v_lshlrev_b32 v112, 16, v110
    v_and_b32 v113, 0xffff0000, v110
    v_lshlrev_b32 v114, 16, v111
    v_and_b32 v115, 0xffff0000, v111
    v_pk_add_f32 v[76:77], v[76:77], v[112:113]
    v_pk_add_f32 v[78:79], v[78:79], v[114:115]
    ds_write_b128 v14, v[76:79] offset:41408
    s_branch P4_epi
P4_D:
    s_barrier
    s_cmp_eq_u32 s71, 1
    s_cbranch_scc1 P4_D1
    s_mov_b32 s58, 20000
Lpoll_50:
    buffer_load_dword v248, v20, s[32:35], 0 offen offset:640 sc1
    s_sub_u32 s58, s58, 1
    s_waitcnt vmcnt(0)
    v_readfirstlane_b32 s61, v248
    s_cmp_ge_u32 s61, 16
    s_cbranch_scc1 Lpok_51
    s_sleep 2
    s_cmp_lg_u32 s58, 0
    s_cbranch_scc1 Lpoll_50
Lpok_51:
    v_add_u32 v240, 0, v236
    s_add_u32 m0, s80, 32768
    s_nop 0
    buffer_load_dwordx4 v240, s[8:11], 0 offen sc1 lds
    s_add_u32 m0, s80, 34816
    s_nop 0
    buffer_load_dwordx4 v240, s[8:11], s81 offen sc1 lds
    s_add_u32 m0, s80, 36864
    s_nop 0
    buffer_load_dwordx4 v240, s[8:11], s82 offen sc1 lds
    s_add_u32 m0, s80, 38912
    s_nop 0
    buffer_load_dwordx4 v240, s[8:11], s83 offen sc1 lds
    s_add_u32 m0, s80, 40960
    s_nop 0
    buffer_load_dwordx4 v240, s[8:11], s84 offen sc1 lds
    s_add_u32 m0, s80, 43008
    s_nop 0
    buffer_load_dwordx4 v240, s[8:11], s85 offen sc1 lds
    s_add_u32 m0, s80, 45056
    s_nop 0
    buffer_load_dwordx4 v240, s[8:11], s86 offen sc1 lds
    s_add_u32 m0, s80, 47104
    s_nop 0
    buffer_load_dwordx4 v240, s[8:11], s87 offen sc1 lds
    v_add_u32 v241, 393216, v237
    s_add_u32 m0, s80, 49152
    s_nop 0
    buffer_load_dwordx4 v241, s[12:15], 0 offen  lds
    s_add_u32 m0, s80, 51200
    s_nop 0
    buffer_load_dwordx4 v241, s[12:15], s88 offen  lds
    s_add_u32 m0, s80, 53248
    s_nop 0
    buffer_load_dwordx4 v241, s[12:15], s89 offen  lds
    s_add_u32 m0, s80, 55296
    s_nop 0
    buffer_load_dwordx4 v241, s[12:15], s90 offen  lds
    s_add_u32 m0, s80, 57344
    s_nop 0
    buffer_load_dwordx4 v241, s[12:15], s91 offen  lds
    s_add_u32 m0, s80, 59392
    s_nop 0
    buffer_load_dwordx4 v241, s[12:15], s67 offen  lds
    s_add_u32 m0, s80, 61440
    s_nop 0
    buffer_load_dwordx4 v241, s[12:15], s68 offen  lds
    s_add_u32 m0, s80, 63488
    s_nop 0
    buffer_load_dwordx4 v241, s[12:15], s69 offen  lds
P4_D1:
    s_barrier
    v_add_u32 v240, 128, v236
    s_add_u32 m0, s80, 65536
    s_nop 0
    buffer_load_dwordx4 v240, s[8:11], 0 offen sc1 lds
    s_add_u32 m0, s80, 67584
    s_nop 0
    buffer_load_dwordx4 v240, s[8:11], s81 offen sc1 lds
    s_add_u32 m0, s80, 69632
    s_nop 0
    buffer_load_dwordx4 v240, s[8:11], s82 offen sc1 lds
    s_add_u32 m0, s80, 71680
    s_nop 0
    buffer_load_dwordx4 v240, s[8:11], s83 offen sc1 lds
    s_add_u32 m0, s80, 73728
    s_nop 0
    buffer_load_dwordx4 v240, s[8:11], s84 offen sc1 lds
    s_add_u32 m0, s80, 75776
    s_nop 0
    buffer_load_dwordx4 v240, s[8:11], s85 offen sc1 lds
    s_add_u32 m0, s80, 77824
    s_nop 0
    buffer_load_dwordx4 v240, s[8:11], s86 offen sc1 lds
    s_add_u32 m0, s80, 79872
    s_nop 0
    buffer_load_dwordx4 v240, s[8:11], s87 offen sc1 lds
    v_add_u32 v241, 1310720, v237
    s_add_u32 m0, s80, 81920
    s_nop 0
    buffer_load_dwordx4 v241, s[12:15], 0 offen  lds
    s_add_u32 m0, s80, 83968
    s_nop 0
    buffer_load_dwordx4 v241, s[12:15], s88 offen  lds
    s_add_u32 m0, s80, 86016
    s_nop 0
    buffer_load_dwordx4 v241, s[12:15], s89 offen  lds
    s_add_u32 m0, s80, 88064
    s_nop 0
    buffer_load_dwordx4 v241, s[12:15], s90 offen  lds
    s_add_u32 m0, s80, 90112
    s_nop 0
    buffer_load_dwordx4 v241, s[12:15], s91 offen  lds
    s_add_u32 m0, s80, 92160
    s_nop 0
    buffer_load_dwordx4 v241, s[12:15], s67 offen  lds
    s_add_u32 m0, s80, 94208
    s_nop 0
    buffer_load_dwordx4 v241, s[12:15], s68 offen  lds
    s_add_u32 m0, s80, 96256
    s_nop 0
    buffer_load_dwordx4 v241, s[12:15], s69 offen  lds
    s_barrier
    v_add_u32 v240, 256, v236
    s_add_u32 m0, s80, 98304
    s_nop 0
    buffer_load_dwordx4 v240, s[8:11], 0 offen sc1 lds
    s_add_u32 m0, s80, 100352
    s_nop 0
    buffer_load_dwordx4 v240, s[8:11], s81 offen sc1 lds
    s_add_u32 m0, s80, 102400
    s_nop 0
    buffer_load_dwordx4 v240, s[8:11], s82 offen sc1 lds
    s_add_u32 m0, s80, 104448
    s_nop 0
    buffer_load_dwordx4 v240, s[8:11], s83 offen sc1 lds
    s_add_u32 m0, s80, 106496
    s_nop 0
    buffer_load_dwordx4 v240, s[8:11], s84 offen sc1 lds
    s_add_u32 m0, s80, 108544
    s_nop 0
    buffer_load_dwordx4 v240, s[8:11], s85 offen sc1 lds
    s_add_u32 m0, s80, 110592
    s_nop 0
    buffer_load_dwordx4 v240, s[8:11], s86 offen sc1 lds
    s_add_u32 m0, s80, 112640
    s_nop 0
    buffer_load_dwordx4 v240, s[8:11], s87 offen sc1 lds
    v_add_u32 v241, 2228224, v237
    s_add_u32 m0, s80, 114688
    s_nop 0
    buffer_load_dwordx4 v241, s[12:15], 0 offen  lds
    s_add_u32 m0, s80, 116736
    s_nop 0
    buffer_load_dwordx4 v241, s[12:15], s88 offen  lds
    s_add_u32 m0, s80, 118784
    s_nop 0
    buffer_load_dwordx4 v241, s[12:15], s89 offen  lds
    s_add_u32 m0, s80, 120832
    s_nop 0
    buffer_load_dwordx4 v241, s[12:15], s90 offen  lds
    s_add_u32 m0, s80, 122880
    s_nop 0
    buffer_load_dwordx4 v241, s[12:15], s91 offen  lds
    s_add_u32 m0, s80, 124928
    s_nop 0
    buffer_load_dwordx4 v241, s[12:15], s67 offen  lds
    s_add_u32 m0, s80, 126976
    s_nop 0
    buffer_load_dwordx4 v241, s[12:15], s68 offen  lds
    s_add_u32 m0, s80, 129024
    s_nop 0
    buffer_load_dwordx4 v241, s[12:15], s69 offen  lds
    buffer_load_dword v21, v20, s[32:35], 0 offen offset:256 sc1
    s_waitcnt vmcnt(33)
    s_barrier
    v_add_u32 v240, 512, v236
    s_add_u32 m0, s80, 131072
    s_nop 0
    buffer_load_dwordx4 v240, s[8:11], 0 offen sc1 lds
    s_add_u32 m0, s80, 133120
    s_nop 0
    buffer_load_dwordx4 v240, s[8:11], s81 offen sc1 lds
    s_add_u32 m0, s80, 135168
    s_nop 0
    buffer_load_dwordx4 v240, s[8:11], s82 offen sc1 lds
    s_add_u32 m0, s80, 137216
    s_nop 0
    buffer_load_dwordx4 v240, s[8:11], s83 offen sc1 lds
    s_add_u32 m0, s80, 139264
    s_nop 0
    buffer_load_dwordx4 v240, s[8:11], s84 offen sc1 lds
    s_add_u32 m0, s80, 141312
    s_nop 0
    buffer_load_dwordx4 v240, s[8:11], s85 offen sc1 lds
    s_add_u32 m0, s80, 143360
    s_nop 0
    buffer_load_dwordx4 v240, s[8:11], s86 offen sc1 lds
    s_add_u32 m0, s80, 145408
    s_nop 0
    buffer_load_dwordx4 v240, s[8:11], s87 offen sc1 lds
    v_add_u32 v241, 3145728, v237
    s_add_u32 m0, s80, 147456
    s_nop 0
    buffer_load_dwordx4 v241, s[12:15], 0 offen  lds
    s_add_u32 m0, s80, 149504
    s_nop 0
    buffer_load_dwordx4 v241, s[12:15], s88 offen  lds
    s_add_u32 m0, s80, 151552
    s_nop 0
    buffer_load_dwordx4 v241, s[12:15], s89 offen  lds
    s_add_u32 m0, s80, 153600
    s_nop 0
    buffer_load_dwordx4 v241, s[12:15], s90 offen  lds
    s_add_u32 m0, s80, 155648
    s_nop 0
    buffer_load_dwordx4 v241, s[12:15], s91 offen  lds
    s_add_u32 m0, s80, 157696
    s_nop 0
    buffer_load_dwordx4 v241, s[12:15], s67 offen  lds
    s_add_u32 m0, s80, 159744
    s_nop 0
    buffer_load_dwordx4 v241, s[12:15], s68 offen  lds
    s_add_u32 m0, s80, 161792
    s_nop 0
    buffer_load_dwordx4 v241, s[12:15], s69 offen  lds
    s_waitcnt vmcnt(33)
    s_barrier
    s_waitcnt vmcnt(16)
    v_readfirstlane_b32 s61, v21
    s_cmp_ge_u32 s61, 16
    s_cbranch_scc1 Lck_52
    s_mov_b32 s58, 20000
Lpoll_53:
    buffer_load_dword v248, v20, s[32:35], 0 offen offset:256 sc1
    s_sub_u32 s58, s58, 1
    s_waitcnt vmcnt(0)
    v_readfirstlane_b32 s61, v248
    s_cmp_ge_u32 s61, 16
    s_cbranch_scc1 Lpok_54
    s_sleep 2
    s_cmp_lg_u32 s58, 0
    s_cbranch_scc1 Lpoll_53
Lpok_54:
Lck_52:
    s_add_u32 s61, s7, 1
    s_and_b32 s61, s61, 7
    s_add_u32 s61, s61, 4
    s_add_u32 s62, s61, 4
    s_mul_i32 s62, s62, 147
    s_lshr_b32 s62, s62, 10
    s_add_u32 s61, s61, s62
    s_lshl_b32 s61, s61, 7
    v_add_u32 v240, s61, v236
    s_add_u32 m0, s80, 32768
    s_nop 0
    buffer_load_dwordx4 v240, s[8:11], 0 offen sc1 lds
    s_add_u32 m0, s80, 34816
    s_nop 0
    buffer_load_dwordx4 v240, s[8:11], s81 offen sc1 lds
    s_add_u32 m0, s80, 36864
    s_nop 0
    buffer_load_dwordx4 v240, s[8:11], s82 offen sc1 lds
    s_add_u32 m0, s80, 38912
    s_nop 0
    buffer_load_dwordx4 v240, s[8:11], s83 offen sc1 lds
    s_add_u32 m0, s80, 40960
    s_nop 0
    buffer_load_dwordx4 v240, s[8:11], s84 offen sc1 lds
    s_add_u32 m0, s80, 43008
    s_nop 0
    buffer_load_dwordx4 v240, s[8:11], s85 offen sc1 lds
    s_add_u32 m0, s80, 45056
    s_nop 0
    buffer_load_dwordx4 v240, s[8:11], s86 offen sc1 lds
    s_add_u32 m0, s80, 47104
    s_nop 0
    buffer_load_dwordx4 v240, s[8:11], s87 offen sc1 lds
    s_add_u32 s61, s7, 1
    s_and_b32 s61, s61, 7
    s_mul_i32 s61, s61, 7
    s_add_u32 s61, s61, 1
    s_lshr_b32 s61, s61, 1
    s_lshl_b32 s61, s61, 17
    v_add_u32 v241, s61, v237
    s_add_u32 m0, s80, 49152
    s_nop 0
    buffer_load_dwordx4 v241, s[12:15], 0 offen  lds
    s_add_u32 m0, s80, 51200
    s_nop 0
    buffer_load_dwordx4 v241, s[12:15], s88 offen  lds
    s_add_u32 m0, s80, 53248
    s_nop 0
    buffer_load_dwordx4 v241, s[12:15], s89 offen  lds
    s_add_u32 m0, s80, 55296
    s_nop 0
    buffer_load_dwordx4 v241, s[12:15], s90 offen  lds
    s_add_u32 m0, s80, 57344
    s_nop 0
    buffer_load_dwordx4 v241, s[12:15], s91 offen  lds
    s_add_u32 m0, s80, 59392
    s_nop 0
    buffer_load_dwordx4 v241, s[12:15], s67 offen  lds
    s_add_u32 m0, s80, 61440
    s_nop 0
    buffer_load_dwordx4 v241, s[12:15], s68 offen  lds
    s_add_u32 m0, s80, 63488
    s_nop 0
    buffer_load_dwordx4 v241, s[12:15], s69 offen  lds
    s_barrier
    s_add_u32 s61, s7, 2
    s_and_b32 s61, s61, 7
    s_add_u32 s61, s61, 4
    s_add_u32 s62, s61, 4
    s_mul_i32 s62, s62, 147
    s_lshr_b32 s62, s62, 10
    s_add_u32 s61, s61, s62
    s_lshl_b32 s61, s61, 7
    v_add_u32 v240, s61, v236
    s_add_u32 m0, s80, 65536
    s_nop 0
    buffer_load_dwordx4 v240, s[8:11], 0 offen sc1 lds
    s_add_u32 m0, s80, 67584
    s_nop 0
    buffer_load_dwordx4 v240, s[8:11], s81 offen sc1 lds
    s_add_u32 m0, s80, 69632
    s_nop 0
    buffer_load_dwordx4 v240, s[8:11], s82 offen sc1 lds
    s_add_u32 m0, s80, 71680
    s_nop 0
    buffer_load_dwordx4 v240, s[8:11], s83 offen sc1 lds
    s_add_u32 m0, s80, 73728
    s_nop 0
    buffer_load_dwordx4 v240, s[8:11], s84 offen sc1 lds
    s_add_u32 m0, s80, 75776
    s_nop 0
    buffer_load_dwordx4 v240, s[8:11], s85 offen sc1 lds
    s_add_u32 m0, s80, 77824
    s_nop 0
    buffer_load_dwordx4 v240, s[8:11], s86 offen sc1 lds
    s_add_u32 m0, s80, 79872
    s_nop 0
    buffer_load_dwordx4 v240, s[8:11], s87 offen sc1 lds
    s_add_u32 s61, s7, 2
    s_and_b32 s61, s61, 7
    s_mul_i32 s61, s61, 7
    s_add_u32 s61, s61, 1
    s_lshr_b32 s61, s61, 1
    s_lshl_b32 s61, s61, 17
    v_add_u32 v241, s61, v237
    s_add_u32 m0, s80, 81920
    s_nop 0
    buffer_load_dwordx4 v241, s[12:15], 0 offen  lds
    s_add_u32 m0, s80, 83968
    s_nop 0
    buffer_load_dwordx4 v241, s[12:15], s88 offen  lds
    s_add_u32 m0, s80, 86016
    s_nop 0
    buffer_load_dwordx4 v241, s[12:15], s89 offen  lds
    s_add_u32 m0, s80, 88064
    s_nop 0
    buffer_load_dwordx4 v241, s[12:15], s90 offen  lds
    s_add_u32 m0, s80, 90112
    s_nop 0
    buffer_load_dwordx4 v241, s[12:15], s91 offen  lds
    s_add_u32 m0, s80, 92160
    s_nop 0
    buffer_load_dwordx4 v241, s[12:15], s67 offen  lds
    s_add_u32 m0, s80, 94208
    s_nop 0
    buffer_load_dwordx4 v241, s[12:15], s68 offen  lds
    s_add_u32 m0, s80, 96256
    s_nop 0
    buffer_load_dwordx4 v241, s[12:15], s69 offen  lds
    s_waitcnt vmcnt(32)
    s_barrier
    s_add_u32 s61, s7, 3
    s_and_b32 s61, s61, 7
    s_add_u32 s61, s61, 4
    s_add_u32 s62, s61, 4
    s_mul_i32 s62, s62, 147
    s_lshr_b32 s62, s62, 10
    s_add_u32 s61, s61, s62
    s_lshl_b32 s61, s61, 7
    v_add_u32 v240, s61, v236
    s_add_u32 m0, s80, 98304
    s_nop 0
    buffer_load_dwordx4 v240, s[8:11], 0 offen sc1 lds
    s_add_u32 m0, s80, 100352
    s_nop 0
    buffer_load_dwordx4 v240, s[8:11], s81 offen sc1 lds
    s_add_u32 m0, s80, 102400
    s_nop 0
    buffer_load_dwordx4 v240, s[8:11], s82 offen sc1 lds
    s_add_u32 m0, s80, 104448
    s_nop 0
    buffer_load_dwordx4 v240, s[8:11], s83 offen sc1 lds
    s_add_u32 m0, s80, 106496
    s_nop 0
    buffer_load_dwordx4 v240, s[8:11], s84 offen sc1 lds
    s_add_u32 m0, s80, 108544
    s_nop 0
    buffer_load_dwordx4 v240, s[8:11], s85 offen sc1 lds
    s_add_u32 m0, s80, 110592
    s_nop 0
    buffer_load_dwordx4 v240, s[8:11], s86 offen sc1 lds
    s_add_u32 m0, s80, 112640
    s_nop 0
    buffer_load_dwordx4 v240, s[8:11], s87 offen sc1 lds
    s_add_u32 s61, s7, 3
    s_and_b32 s61, s61, 7
    s_mul_i32 s61, s61, 7
    s_add_u32 s61, s61, 1
    s_lshr_b32 s61, s61, 1
    s_lshl_b32 s61, s61, 17
    v_add_u32 v241, s61, v237
    s_add_u32 m0, s80, 114688
    s_nop 0
    buffer_load_dwordx4 v241, s[12:15], 0 offen  lds
    s_add_u32 m0, s80, 116736
    s_nop 0
    buffer_load_dwordx4 v241, s[12:15], s88 offen  lds
    s_add_u32 m0, s80, 118784
    s_nop 0
    buffer_load_dwordx4 v241, s[12:15], s89 offen  lds
    s_add_u32 m0, s80, 120832
    s_nop 0
    buffer_load_dwordx4 v241, s[12:15], s90 offen  lds
    s_add_u32 m0, s80, 122880
    s_nop 0
    buffer_load_dwordx4 v241, s[12:15], s91 offen  lds
    s_add_u32 m0, s80, 124928
    s_nop 0
    buffer_load_dwordx4 v241, s[12:15], s67 offen  lds
    s_add_u32 m0, s80, 126976
    s_nop 0
    buffer_load_dwordx4 v241, s[12:15], s68 offen  lds
    s_add_u32 m0, s80, 129024
    s_nop 0
    buffer_load_dwordx4 v241, s[12:15], s69 offen  lds
    s_waitcnt vmcnt(32)
    s_barrier
    s_add_u32 s61, s7, 4
    s_and_b32 s61, s61, 7
    s_add_u32 s61, s61, 4
    s_add_u32 s62, s61, 4
    s_mul_i32 s62, s62, 147
    s_lshr_b32 s62, s62, 10
    s_add_u32 s61, s61, s62
    s_lshl_b32 s61, s61, 7
    v_add_u32 v240, s61, v236
    s_add_u32 m0, s80, 131072
    s_nop 0
    buffer_load_dwordx4 v240, s[8:11], 0 offen sc1 lds
    s_add_u32 m0, s80, 133120
    s_nop 0
    buffer_load_dwordx4 v240, s[8:11], s81 offen sc1 lds
    s_add_u32 m0, s80, 135168
    s_nop 0
    buffer_load_dwordx4 v240, s[8:11], s82 offen sc1 lds
    s_add_u32 m0, s80, 137216
    s_nop 0
    buffer_load_dwordx4 v240, s[8:11], s83 offen sc1 lds
    s_add_u32 m0, s80, 139264
    s_nop 0
    buffer_load_dwordx4 v240, s[8:11], s84 offen sc1 lds
    s_add_u32 m0, s80, 141312
    s_nop 0
    buffer_load_dwordx4 v240, s[8:11], s85 offen sc1 lds
    s_add_u32 m0, s80, 143360
    s_nop 0
    buffer_load_dwordx4 v240, s[8:11], s86 offen sc1 lds
    s_add_u32 m0, s80, 145408
    s_nop 0
    buffer_load_dwordx4 v240, s[8:11], s87 offen sc1 lds
    s_add_u32 s61, s7, 4
    s_and_b32 s61, s61, 7
    s_mul_i32 s61, s61, 7
    s_add_u32 s61, s61, 1
    s_lshr_b32 s61, s61, 1
    s_lshl_b32 s61, s61, 17
    v_add_u32 v241, s61, v237
    s_add_u32 m0, s80, 147456
    s_nop 0
    buffer_load_dwordx4 v241, s[12:15], 0 offen  lds
    s_add_u32 m0, s80, 149504
    s_nop 0
    buffer_load_dwordx4 v241, s[12:15], s88 offen  lds
    s_add_u32 m0, s80, 151552
    s_nop 0
    buffer_load_dwordx4 v241, s[12:15], s89 offen  lds
    s_add_u32 m0, s80, 153600
    s_nop 0
    buffer_load_dwordx4 v241, s[12:15], s90 offen  lds
    s_add_u32 m0, s80, 155648
    s_nop 0
    buffer_load_dwordx4 v241, s[12:15], s91 offen  lds
    s_add_u32 m0, s80, 157696
    s_nop 0
    buffer_load_dwordx4 v241, s[12:15], s67 offen  lds
    s_add_u32 m0, s80, 159744
    s_nop 0
    buffer_load_dwordx4 v241, s[12:15], s68 offen  lds
    s_add_u32 m0, s80, 161792
    s_nop 0
    buffer_load_dwordx4 v241, s[12:15], s69 offen  lds
    s_waitcnt vmcnt(32)
    s_barrier
    s_add_u32 s61, s7, 5
    s_and_b32 s61, s61, 7
    s_add_u32 s61, s61, 4
    s_add_u32 s62, s61, 4
    s_mul_i32 s62, s62, 147
    s_lshr_b32 s62, s62, 10
    s_add_u32 s61, s61, s62
    s_lshl_b32 s61, s61, 7
    v_add_u32 v240, s61, v236
    s_add_u32 m0, s80, 32768
    s_nop 0
    buffer_load_dwordx4 v240, s[8:11], 0 offen sc1 lds
    s_add_u32 m0, s80, 34816
    s_nop 0
    buffer_load_dwordx4 v240, s[8:11], s81 offen sc1 lds
    s_add_u32 m0, s80, 36864
    s_nop 0
    buffer_load_dwordx4 v240, s[8:11], s82 offen sc1 lds
    s_add_u32 m0, s80, 38912
    s_nop 0
    buffer_load_dwordx4 v240, s[8:11], s83 offen sc1 lds
    s_add_u32 m0, s80, 40960
    s_nop 0
    buffer_load_dwordx4 v240, s[8:11], s84 offen sc1 lds
    s_add_u32 m0, s80, 43008
    s_nop 0
    buffer_load_dwordx4 v240, s[8:11], s85 offen sc1 lds
    s_add_u32 m0, s80, 45056
    s_nop 0
    buffer_load_dwordx4 v240, s[8:11], s86 offen sc1 lds
    s_add_u32 m0, s80, 47104
    s_nop 0
    buffer_load_dwordx4 v240, s[8:11], s87 offen sc1 lds
    s_add_u32 s61, s7, 5
    s_and_b32 s61, s61, 7
    s_mul_i32 s61, s61, 7
    s_add_u32 s61, s61, 1
    s_lshr_b32 s61, s61, 1
    s_lshl_b32 s61, s61, 17
    v_add_u32 v241, s61, v237
    s_add_u32 m0, s80, 49152
    s_nop 0
    buffer_load_dwordx4 v241, s[12:15], 0 offen  lds
    s_add_u32 m0, s80, 51200
    s_nop 0
    buffer_load_dwordx4 v241, s[12:15], s88 offen  lds
    s_add_u32 m0, s80, 53248
    s_nop 0
    buffer_load_dwordx4 v241, s[12:15], s89 offen  lds
    s_add_u32 m0, s80, 55296
    s_nop 0
    buffer_load_dwordx4 v241, s[12:15], s90 offen  lds
    s_add_u32 m0, s80, 57344
    s_nop 0
    buffer_load_dwordx4 v241, s[12:15], s91 offen  lds
    s_add_u32 m0, s80, 59392
    s_nop 0
    buffer_load_dwordx4 v241, s[12:15], s67 offen  lds
    s_add_u32 m0, s80, 61440
    s_nop 0
    buffer_load_dwordx4 v241, s[12:15], s68 offen  lds
    s_add_u32 m0, s80, 63488
    s_nop 0
    buffer_load_dwordx4 v241, s[12:15], s69 offen  lds
    s_waitcnt vmcnt(32)
    s_barrier
    s_add_u32 s61, s7, 6
    s_and_b32 s61, s61, 7
    s_add_u32 s61, s61, 4
    s_add_u32 s62, s61, 4
    s_mul_i32 s62, s62, 147
    s_lshr_b32 s62, s62, 10
    s_add_u32 s61, s61, s62
    s_lshl_b32 s61, s61, 7
    v_add_u32 v240, s61, v236
    s_add_u32 m0, s80, 65536
    s_nop 0
    buffer_load_dwordx4 v240, s[8:11], 0 offen sc1 lds
    s_add_u32 m0, s80, 67584
    s_nop 0
    buffer_load_dwordx4 v240, s[8:11], s81 offen sc1 lds
    s_add_u32 m0, s80, 69632
    s_nop 0
    buffer_load_dwordx4 v240, s[8:11], s82 offen sc1 lds
    s_add_u32 m0, s80, 71680
    s_nop 0
    buffer_load_dwordx4 v240, s[8:11], s83 offen sc1 lds
    s_add_u32 m0, s80, 73728
    s_nop 0
    buffer_load_dwordx4 v240, s[8:11], s84 offen sc1 lds
    s_add_u32 m0, s80, 75776
    s_nop 0
    buffer_load_dwordx4 v240, s[8:11], s85 offen sc1 lds
    s_add_u32 m0, s80, 77824
    s_nop 0
    buffer_load_dwordx4 v240, s[8:11], s86 offen sc1 lds
    s_add_u32 m0, s80, 79872
    s_nop 0
    buffer_load_dwordx4 v240, s[8:11], s87 offen sc1 lds
    s_add_u32 s61, s7, 6
    s_and_b32 s61, s61, 7
    s_mul_i32 s61, s61, 7
    s_add_u32 s61, s61, 1
    s_lshr_b32 s61, s61, 1
    s_lshl_b32 s61, s61, 17
    v_add_u32 v241, s61, v237
    s_add_u32 m0, s80, 81920
    s_nop 0
    buffer_load_dwordx4 v241, s[12:15], 0 offen  lds
    s_add_u32 m0, s80, 83968
    s_nop 0
    buffer_load_dwordx4 v241, s[12:15], s88 offen  lds
    s_add_u32 m0, s80, 86016
    s_nop 0
    buffer_load_dwordx4 v241, s[12:15], s89 offen  lds
    s_add_u32 m0, s80, 88064
    s_nop 0
    buffer_load_dwordx4 v241, s[12:15], s90 offen  lds
    s_add_u32 m0, s80, 90112
    s_nop 0
    buffer_load_dwordx4 v241, s[12:15], s91 offen  lds
    s_add_u32 m0, s80, 92160
    s_nop 0
    buffer_load_dwordx4 v241, s[12:15], s67 offen  lds
    s_add_u32 m0, s80, 94208
    s_nop 0
    buffer_load_dwordx4 v241, s[12:15], s68 offen  lds
    s_add_u32 m0, s80, 96256
    s_nop 0
    buffer_load_dwordx4 v241, s[12:15], s69 offen  lds
    buffer_load_dword v21, v20, s[32:35], 0 offen offset:384 sc1
    s_waitcnt vmcnt(33)
    s_barrier
    s_add_u32 s61, s7, 7
    s_and_b32 s61, s61, 7
    s_add_u32 s61, s61, 4
    s_add_u32 s62, s61, 4
    s_mul_i32 s62, s62, 147
    s_lshr_b32 s62, s62, 10
    s_add_u32 s61, s61, s62
    s_lshl_b32 s61, s61, 7
    v_add_u32 v240, s61, v236
    s_add_u32 m0, s80, 98304
    s_nop 0
    buffer_load_dwordx4 v240, s[8:11], 0 offen sc1 lds
    s_add_u32 m0, s80, 100352
    s_nop 0
    buffer_load_dwordx4 v240, s[8:11], s81 offen sc1 lds
    s_add_u32 m0, s80, 102400
    s_nop 0
    buffer_load_dwordx4 v240, s[8:11], s82 offen sc1 lds
    s_add_u32 m0, s80, 104448
    s_nop 0
    buffer_load_dwordx4 v240, s[8:11], s83 offen sc1 lds
    s_add_u32 m0, s80, 106496
    s_nop 0
    buffer_load_dwordx4 v240, s[8:11], s84 offen sc1 lds
    s_add_u32 m0, s80, 108544
    s_nop 0
    buffer_load_dwordx4 v240, s[8:11], s85 offen sc1 lds
    s_add_u32 m0, s80, 110592
    s_nop 0
    buffer_load_dwordx4 v240, s[8:11], s86 offen sc1 lds
    s_add_u32 m0, s80, 112640
    s_nop 0
    buffer_load_dwordx4 v240, s[8:11], s87 offen sc1 lds
    s_add_u32 s61, s7, 7
    s_and_b32 s61, s61, 7
    s_mul_i32 s61, s61, 7
    s_add_u32 s61, s61, 1
    s_lshr_b32 s61, s61, 1
    s_lshl_b32 s61, s61, 17
    v_add_u32 v241, s61, v237
    s_add_u32 m0, s80, 114688
    s_nop 0
    buffer_load_dwordx4 v241, s[12:15], 0 offen  lds
    s_add_u32 m0, s80, 116736
    s_nop 0
    buffer_load_dwordx4 v241, s[12:15], s88 offen  lds
    s_add_u32 m0, s80, 118784
    s_nop 0
    buffer_load_dwordx4 v241, s[12:15], s89 offen  lds
    s_add_u32 m0, s80, 120832
    s_nop 0
    buffer_load_dwordx4 v241, s[12:15], s90 offen  lds
    s_add_u32 m0, s80, 122880
    s_nop 0
    buffer_load_dwordx4 v241, s[12:15], s91 offen  lds
    s_add_u32 m0, s80, 124928
    s_nop 0
    buffer_load_dwordx4 v241, s[12:15], s67 offen  lds
    s_add_u32 m0, s80, 126976
    s_nop 0
    buffer_load_dwordx4 v241, s[12:15], s68 offen  lds
    s_add_u32 m0, s80, 129024
    s_nop 0
    buffer_load_dwordx4 v241, s[12:15], s69 offen  lds
    s_waitcnt vmcnt(33)
    s_barrier
    s_waitcnt vmcnt(16)
    v_readfirstlane_b32 s61, v21
    s_cmp_ge_u32 s61, 16
    s_cbranch_scc1 Lck_55
    s_mov_b32 s58, 20000
Lpoll_56:
    buffer_load_dword v248, v20, s[32:35], 0 offen offset:384 sc1
    s_sub_u32 s58, s58, 1
    s_waitcnt vmcnt(0)
    v_readfirstlane_b32 s61, v248
    s_cmp_ge_u32 s61, 16
    s_cbranch_scc1 Lpok_57
    s_sleep 2
    s_cmp_lg_u32 s58, 0
    s_cbranch_scc1 Lpoll_56
Lpok_57:
Lck_55:
    s_add_u32 s61, s7, 1
    s_and_b32 s61, s61, 7
    s_add_u32 s61, s61, 12
    s_add_u32 s62, s61, 4
    s_mul_i32 s62, s62, 147
    s_lshr_b32 s62, s62, 10
    s_add_u32 s61, s61, s62
    s_lshl_b32 s61, s61, 7
    v_add_u32 v240, s61, v236
    s_add_u32 m0, s80, 131072
    s_nop 0
    buffer_load_dwordx4 v240, s[8:11], 0 offen sc1 lds
    s_add_u32 m0, s80, 133120
    s_nop 0
    buffer_load_dwordx4 v240, s[8:11], s81 offen sc1 lds
    s_add_u32 m0, s80, 135168
    s_nop 0
    buffer_load_dwordx4 v240, s[8:11], s82 offen sc1 lds
    s_add_u32 m0, s80, 137216
    s_nop 0
    buffer_load_dwordx4 v240, s[8:11], s83 offen sc1 lds
    s_add_u32 m0, s80, 139264
    s_nop 0
    buffer_load_dwordx4 v240, s[8:11], s84 offen sc1 lds
    s_add_u32 m0, s80, 141312
    s_nop 0
    buffer_load_dwordx4 v240, s[8:11], s85 offen sc1 lds
    s_add_u32 m0, s80, 143360
    s_nop 0
    buffer_load_dwordx4 v240, s[8:11], s86 offen sc1 lds
    s_add_u32 m0, s80, 145408
    s_nop 0
    buffer_load_dwordx4 v240, s[8:11], s87 offen sc1 lds
    s_add_u32 s61, s7, 1
    s_and_b32 s61, s61, 7
    s_mul_i32 s61, s61, 7
    s_add_u32 s61, s61, 3
    s_lshr_b32 s61, s61, 1
    s_lshl_b32 s61, s61, 17
    v_add_u32 v241, s61, v237
    s_add_u32 m0, s80, 147456
    s_nop 0
    buffer_load_dwordx4 v241, s[12:15], 0 offen  lds
    s_add_u32 m0, s80, 149504
    s_nop 0
    buffer_load_dwordx4 v241, s[12:15], s88 offen  lds
    s_add_u32 m0, s80, 151552
    s_nop 0
    buffer_load_dwordx4 v241, s[12:15], s89 offen  lds
    s_add_u32 m0, s80, 153600
    s_nop 0
    buffer_load_dwordx4 v241, s[12:15], s90 offen  lds
    s_add_u32 m0, s80, 155648
    s_nop 0
    buffer_load_dwordx4 v241, s[12:15], s91 offen  lds
    s_add_u32 m0, s80, 157696
    s_nop 0
    buffer_load_dwordx4 v241, s[12:15], s67 offen  lds
    s_add_u32 m0, s80, 159744
    s_nop 0
    buffer_load_dwordx4 v241, s[12:15], s68 offen  lds
    s_add_u32 m0, s80, 161792
    s_nop 0
    buffer_load_dwordx4 v241, s[12:15], s69 offen  lds
    s_barrier
    s_add_u32 s61, s7, 2
    s_and_b32 s61, s61, 7
    s_add_u32 s61, s61, 12
    s_add_u32 s62, s61, 4
    s_mul_i32 s62, s62, 147
    s_lshr_b32 s62, s62, 10
    s_add_u32 s61, s61, s62
    s_lshl_b32 s61, s61, 7
    v_add_u32 v240, s61, v236
    s_add_u32 m0, s80, 32768
    s_nop 0
    buffer_load_dwordx4 v240, s[8:11], 0 offen sc1 lds
    s_add_u32 m0, s80, 34816
    s_nop 0
    buffer_load_dwordx4 v240, s[8:11], s81 offen sc1 lds
    s_add_u32 m0, s80, 36864
    s_nop 0
    buffer_load_dwordx4 v240, s[8:11], s82 offen sc1 lds
    s_add_u32 m0, s80, 38912
    s_nop 0
    buffer_load_dwordx4 v240, s[8:11], s83 offen sc1 lds
    s_add_u32 m0, s80, 40960
    s_nop 0
    buffer_load_dwordx4 v240, s[8:11], s84 offen sc1 lds
    s_add_u32 m0, s80, 43008
    s_nop 0
    buffer_load_dwordx4 v240, s[8:11], s85 offen sc1 lds
    s_add_u32 m0, s80, 45056
    s_nop 0
    buffer_load_dwordx4 v240, s[8:11], s86 offen sc1 lds
    s_add_u32 m0, s80, 47104
    s_nop 0
    buffer_load_dwordx4 v240, s[8:11], s87 offen sc1 lds
    s_add_u32 s61, s7, 2
    s_and_b32 s61, s61, 7
    s_mul_i32 s61, s61, 7
    s_add_u32 s61, s61, 3
    s_lshr_b32 s61, s61, 1
    s_lshl_b32 s61, s61, 17
    v_add_u32 v241, s61, v237
    s_add_u32 m0, s80, 49152
    s_nop 0
    buffer_load_dwordx4 v241, s[12:15], 0 offen  lds
    s_add_u32 m0, s80, 51200
    s_nop 0
    buffer_load_dwordx4 v241, s[12:15], s88 offen  lds
    s_add_u32 m0, s80, 53248
    s_nop 0
    buffer_load_dwordx4 v241, s[12:15], s89 offen  lds
    s_add_u32 m0, s80, 55296
    s_nop 0
    buffer_load_dwordx4 v241, s[12:15], s90 offen  lds
    s_add_u32 m0, s80, 57344
    s_nop 0
    buffer_load_dwordx4 v241, s[12:15], s91 offen  lds
    s_add_u32 m0, s80, 59392
    s_nop 0
    buffer_load_dwordx4 v241, s[12:15], s67 offen  lds
    s_add_u32 m0, s80, 61440
    s_nop 0
    buffer_load_dwordx4 v241, s[12:15], s68 offen  lds
    s_add_u32 m0, s80, 63488
    s_nop 0
    buffer_load_dwordx4 v241, s[12:15], s69 offen  lds
    s_waitcnt vmcnt(32)
    s_barrier
    s_add_u32 s61, s7, 3
    s_and_b32 s61, s61, 7
    s_add_u32 s61, s61, 12
    s_add_u32 s62, s61, 4
    s_mul_i32 s62, s62, 147
    s_lshr_b32 s62, s62, 10
    s_add_u32 s61, s61, s62
    s_lshl_b32 s61, s61, 7
    v_add_u32 v240, s61, v236
    s_add_u32 m0, s80, 65536
    s_nop 0
    buffer_load_dwordx4 v240, s[8:11], 0 offen sc1 lds
    s_add_u32 m0, s80, 67584
    s_nop 0
    buffer_load_dwordx4 v240, s[8:11], s81 offen sc1 lds
    s_add_u32 m0, s80, 69632
    s_nop 0
    buffer_load_dwordx4 v240, s[8:11], s82 offen sc1 lds
    s_add_u32 m0, s80, 71680
    s_nop 0
    buffer_load_dwordx4 v240, s[8:11], s83 offen sc1 lds
    s_add_u32 m0, s80, 73728
    s_nop 0
    buffer_load_dwordx4 v240, s[8:11], s84 offen sc1 lds
    s_add_u32 m0, s80, 75776
    s_nop 0
    buffer_load_dwordx4 v240, s[8:11], s85 offen sc1 lds
    s_add_u32 m0, s80, 77824
    s_nop 0
    buffer_load_dwordx4 v240, s[8:11], s86 offen sc1 lds
    s_add_u32 m0, s80, 79872
    s_nop 0
    buffer_load_dwordx4 v240, s[8:11], s87 offen sc1 lds
    s_add_u32 s61, s7, 3
    s_and_b32 s61, s61, 7
    s_mul_i32 s61, s61, 7
    s_add_u32 s61, s61, 3
    s_lshr_b32 s61, s61, 1
    s_lshl_b32 s61, s61, 17
    v_add_u32 v241, s61, v237
    s_add_u32 m0, s80, 81920
    s_nop 0
    buffer_load_dwordx4 v241, s[12:15], 0 offen  lds
    s_add_u32 m0, s80, 83968
    s_nop 0
    buffer_load_dwordx4 v241, s[12:15], s88 offen  lds
    s_add_u32 m0, s80, 86016
    s_nop 0
    buffer_load_dwordx4 v241, s[12:15], s89 offen  lds
    s_add_u32 m0, s80, 88064
    s_nop 0
    buffer_load_dwordx4 v241, s[12:15], s90 offen  lds
    s_add_u32 m0, s80, 90112
    s_nop 0
    buffer_load_dwordx4 v241, s[12:15], s91 offen  lds
    s_add_u32 m0, s80, 92160
    s_nop 0
    buffer_load_dwordx4 v241, s[12:15], s67 offen  lds
    s_add_u32 m0, s80, 94208
    s_nop 0
    buffer_load_dwordx4 v241, s[12:15], s68 offen  lds
    s_add_u32 m0, s80, 96256
    s_nop 0
    buffer_load_dwordx4 v241, s[12:15], s69 offen  lds
    s_waitcnt vmcnt(32)
    s_barrier
    s_add_u32 s61, s7, 4
    s_and_b32 s61, s61, 7
    s_add_u32 s61, s61, 12
    s_add_u32 s62, s61, 4
    s_mul_i32 s62, s62, 147
    s_lshr_b32 s62, s62, 10
    s_add_u32 s61, s61, s62
    s_lshl_b32 s61, s61, 7
    v_add_u32 v240, s61, v236
    s_add_u32 m0, s80, 98304
    s_nop 0
    buffer_load_dwordx4 v240, s[8:11], 0 offen sc1 lds
    s_add_u32 m0, s80, 100352
    s_nop 0
    buffer_load_dwordx4 v240, s[8:11], s81 offen sc1 lds
    s_add_u32 m0, s80, 102400
    s_nop 0
    buffer_load_dwordx4 v240, s[8:11], s82 offen sc1 lds
    s_add_u32 m0, s80, 104448
    s_nop 0
    buffer_load_dwordx4 v240, s[8:11], s83 offen sc1 lds
    s_add_u32 m0, s80, 106496
    s_nop 0
    buffer_load_dwordx4 v240, s[8:11], s84 offen sc1 lds
    s_add_u32 m0, s80, 108544
    s_nop 0
    buffer_load_dwordx4 v240, s[8:11], s85 offen sc1 lds
    s_add_u32 m0, s80, 110592
    s_nop 0
    buffer_load_dwordx4 v240, s[8:11], s86 offen sc1 lds
    s_add_u32 m0, s80, 112640
    s_nop 0
    buffer_load_dwordx4 v240, s[8:11], s87 offen sc1 lds
    s_add_u32 s61, s7, 4
    s_and_b32 s61, s61, 7
    s_mul_i32 s61, s61, 7
    s_add_u32 s61, s61, 3
    s_lshr_b32 s61, s61, 1
    s_lshl_b32 s61, s61, 17
    v_add_u32 v241, s61, v237
    s_add_u32 m0, s80, 114688
    s_nop 0
    buffer_load_dwordx4 v241, s[12:15], 0 offen  lds
    s_add_u32 m0, s80, 116736
    s_nop 0
    buffer_load_dwordx4 v241, s[12:15], s88 offen  lds
    s_add_u32 m0, s80, 118784
    s_nop 0
    buffer_load_dwordx4 v241, s[12:15], s89 offen  lds
    s_add_u32 m0, s80, 120832
    s_nop 0
    buffer_load_dwordx4 v241, s[12:15], s90 offen  lds
    s_add_u32 m0, s80, 122880
    s_nop 0
    buffer_load_dwordx4 v241, s[12:15], s91 offen  lds
    s_add_u32 m0, s80, 124928
    s_nop 0
    buffer_load_dwordx4 v241, s[12:15], s67 offen  lds
    s_add_u32 m0, s80, 126976
    s_nop 0
    buffer_load_dwordx4 v241, s[12:15], s68 offen  lds
    s_add_u32 m0, s80, 129024
    s_nop 0
    buffer_load_dwordx4 v241, s[12:15], s69 offen  lds
    s_waitcnt vmcnt(32)
    s_barrier
    s_add_u32 s61, s7, 5
    s_and_b32 s61, s61, 7
    s_add_u32 s61, s61, 12
    s_add_u32 s62, s61, 4
    s_mul_i32 s62, s62, 147
    s_lshr_b32 s62, s62, 10
    s_add_u32 s61, s61, s62
    s_lshl_b32 s61, s61, 7
    v_add_u32 v240, s61, v236
    s_add_u32 m0, s80, 131072
    s_nop 0
    buffer_load_dwordx4 v240, s[8:11], 0 offen sc1 lds
    s_add_u32 m0, s80, 133120
    s_nop 0
    buffer_load_dwordx4 v240, s[8:11], s81 offen sc1 lds
    s_add_u32 m0, s80, 135168
    s_nop 0
    buffer_load_dwordx4 v240, s[8:11], s82 offen sc1 lds
    s_add_u32 m0, s80, 137216
    s_nop 0
    buffer_load_dwordx4 v240, s[8:11], s83 offen sc1 lds
    s_add_u32 m0, s80, 139264
    s_nop 0
    buffer_load_dwordx4 v240, s[8:11], s84 offen sc1 lds
    s_add_u32 m0, s80, 141312
    s_nop 0
    buffer_load_dwordx4 v240, s[8:11], s85 offen sc1 lds
    s_add_u32 m0, s80, 143360
    s_nop 0
    buffer_load_dwordx4 v240, s[8:11], s86 offen sc1 lds
    s_add_u32 m0, s80, 145408
    s_nop 0
    buffer_load_dwordx4 v240, s[8:11], s87 offen sc1 lds
    s_add_u32 s61, s7, 5
    s_and_b32 s61, s61, 7
    s_mul_i32 s61, s61, 7
    s_add_u32 s61, s61, 3
    s_lshr_b32 s61, s61, 1
    s_lshl_b32 s61, s61, 17
    v_add_u32 v241, s61, v237
    s_add_u32 m0, s80, 147456
    s_nop 0
    buffer_load_dwordx4 v241, s[12:15], 0 offen  lds
    s_add_u32 m0, s80, 149504
    s_nop 0
    buffer_load_dwordx4 v241, s[12:15], s88 offen  lds
    s_add_u32 m0, s80, 151552
    s_nop 0
    buffer_load_dwordx4 v241, s[12:15], s89 offen  lds
    s_add_u32 m0, s80, 153600
    s_nop 0
    buffer_load_dwordx4 v241, s[12:15], s90 offen  lds
    s_add_u32 m0, s80, 155648
    s_nop 0
    buffer_load_dwordx4 v241, s[12:15], s91 offen  lds
    s_add_u32 m0, s80, 157696
    s_nop 0
    buffer_load_dwordx4 v241, s[12:15], s67 offen  lds
    s_add_u32 m0, s80, 159744
    s_nop 0
    buffer_load_dwordx4 v241, s[12:15], s68 offen  lds
    s_add_u32 m0, s80, 161792
    s_nop 0
    buffer_load_dwordx4 v241, s[12:15], s69 offen  lds
    s_waitcnt vmcnt(32)
    s_barrier
    s_add_u32 s61, s7, 6
    s_and_b32 s61, s61, 7
    s_add_u32 s61, s61, 12
    s_add_u32 s62, s61, 4
    s_mul_i32 s62, s62, 147
    s_lshr_b32 s62, s62, 10
    s_add_u32 s61, s61, s62
    s_lshl_b32 s61, s61, 7
    v_add_u32 v240, s61, v236
    s_add_u32 m0, s80, 32768
    s_nop 0
    buffer_load_dwordx4 v240, s[8:11], 0 offen sc1 lds
    s_add_u32 m0, s80, 34816
    s_nop 0
    buffer_load_dwordx4 v240, s[8:11], s81 offen sc1 lds
    s_add_u32 m0, s80, 36864
    s_nop 0
    buffer_load_dwordx4 v240, s[8:11], s82 offen sc1 lds
    s_add_u32 m0, s80, 38912
    s_nop 0
    buffer_load_dwordx4 v240, s[8:11], s83 offen sc1 lds
    s_add_u32 m0, s80, 40960
    s_nop 0
    buffer_load_dwordx4 v240, s[8:11], s84 offen sc1 lds
    s_add_u32 m0, s80, 43008
    s_nop 0
    buffer_load_dwordx4 v240, s[8:11], s85 offen sc1 lds
    s_add_u32 m0, s80, 45056
    s_nop 0
    buffer_load_dwordx4 v240, s[8:11], s86 offen sc1 lds
    s_add_u32 m0, s80, 47104
    s_nop 0
    buffer_load_dwordx4 v240, s[8:11], s87 offen sc1 lds
    s_add_u32 s61, s7, 6
    s_and_b32 s61, s61, 7
    s_mul_i32 s61, s61, 7
    s_add_u32 s61, s61, 3
    s_lshr_b32 s61, s61, 1
    s_lshl_b32 s61, s61, 17
    v_add_u32 v241, s61, v237
    s_add_u32 m0, s80, 49152
    s_nop 0
    buffer_load_dwordx4 v241, s[12:15], 0 offen  lds
    s_add_u32 m0, s80, 51200
    s_nop 0
    buffer_load_dwordx4 v241, s[12:15], s88 offen  lds
    s_add_u32 m0, s80, 53248
    s_nop 0
    buffer_load_dwordx4 v241, s[12:15], s89 offen  lds
    s_add_u32 m0, s80, 55296
    s_nop 0
    buffer_load_dwordx4 v241, s[12:15], s90 offen  lds
    s_add_u32 m0, s80, 57344
    s_nop 0
    buffer_load_dwordx4 v241, s[12:15], s91 offen  lds
    s_add_u32 m0, s80, 59392
    s_nop 0
    buffer_load_dwordx4 v241, s[12:15], s67 offen  lds
    s_add_u32 m0, s80, 61440
    s_nop 0
    buffer_load_dwordx4 v241, s[12:15], s68 offen  lds
    s_add_u32 m0, s80, 63488
    s_nop 0
    buffer_load_dwordx4 v241, s[12:15], s69 offen  lds
    buffer_load_dword v21, v20, s[32:35], 0 offen offset:512 sc1
    s_waitcnt vmcnt(33)
    s_barrier
    s_add_u32 s61, s7, 7
    s_and_b32 s61, s61, 7
    s_add_u32 s61, s61, 12
    s_add_u32 s62, s61, 4
    s_mul_i32 s62, s62, 147
    s_lshr_b32 s62, s62, 10
    s_add_u32 s61, s61, s62
    s_lshl_b32 s61, s61, 7
    v_add_u32 v240, s61, v236
    s_add_u32 m0, s80, 65536
    s_nop 0
    buffer_load_dwordx4 v240, s[8:11], 0 offen sc1 lds
    s_add_u32 m0, s80, 67584
    s_nop 0
    buffer_load_dwordx4 v240, s[8:11], s81 offen sc1 lds
    s_add_u32 m0, s80, 69632
    s_nop 0
    buffer_load_dwordx4 v240, s[8:11], s82 offen sc1 lds
    s_add_u32 m0, s80, 71680
    s_nop 0
    buffer_load_dwordx4 v240, s[8:11], s83 offen sc1 lds
    s_add_u32 m0, s80, 73728
    s_nop 0
    buffer_load_dwordx4 v240, s[8:11], s84 offen sc1 lds
    s_add_u32 m0, s80, 75776
    s_nop 0
    buffer_load_dwordx4 v240, s[8:11], s85 offen sc1 lds
    s_add_u32 m0, s80, 77824
    s_nop 0
    buffer_load_dwordx4 v240, s[8:11], s86 offen sc1 lds
    s_add_u32 m0, s80, 79872
    s_nop 0
    buffer_load_dwordx4 v240, s[8:11], s87 offen sc1 lds
    s_add_u32 s61, s7, 7
    s_and_b32 s61, s61, 7
    s_mul_i32 s61, s61, 7
    s_add_u32 s61, s61, 3
    s_lshr_b32 s61, s61, 1
    s_lshl_b32 s61, s61, 17
    v_add_u32 v241, s61, v237
    s_add_u32 m0, s80, 81920
    s_nop 0
    buffer_load_dwordx4 v241, s[12:15], 0 offen  lds
    s_add_u32 m0, s80, 83968
    s_nop 0
    buffer_load_dwordx4 v241, s[12:15], s88 offen  lds
    s_add_u32 m0, s80, 86016
    s_nop 0
    buffer_load_dwordx4 v241, s[12:15], s89 offen  lds
    s_add_u32 m0, s80, 88064
    s_nop 0
    buffer_load_dwordx4 v241, s[12:15], s90 offen  lds
    s_add_u32 m0, s80, 90112
    s_nop 0
    buffer_load_dwordx4 v241, s[12:15], s91 offen  lds
    s_add_u32 m0, s80, 92160
    s_nop 0
    buffer_load_dwordx4 v241, s[12:15], s67 offen  lds
    s_add_u32 m0, s80, 94208
    s_nop 0
    buffer_load_dwordx4 v241, s[12:15], s68 offen  lds
    s_add_u32 m0, s80, 96256
    s_nop 0
    buffer_load_dwordx4 v241, s[12:15], s69 offen  lds
    s_waitcnt vmcnt(33)
    s_barrier
    s_waitcnt vmcnt(16)
    v_readfirstlane_b32 s61, v21
    s_cmp_ge_u32 s61, 16
    s_cbranch_scc1 Lck_58
    s_mov_b32 s58, 20000
Lpoll_59:
    buffer_load_dword v248, v20, s[32:35], 0 offen offset:512 sc1
    s_sub_u32 s58, s58, 1
    s_waitcnt vmcnt(0)
    v_readfirstlane_b32 s61, v248
    s_cmp_ge_u32 s61, 16
    s_cbranch_scc1 Lpok_60
    s_sleep 2
    s_cmp_lg_u32 s58, 0
    s_cbranch_scc1 Lpoll_59
Lpok_60:
Lck_58:
    s_add_u32 s61, s7, 1
    s_and_b32 s61, s61, 7
    s_add_u32 s61, s61, 20
    s_add_u32 s62, s61, 4
    s_mul_i32 s62, s62, 147
    s_lshr_b32 s62, s62, 10
    s_add_u32 s61, s61, s62
    s_lshl_b32 s61, s61, 7
    v_add_u32 v240, s61, v236
    s_add_u32 m0, s80, 98304
    s_nop 0
    buffer_load_dwordx4 v240, s[8:11], 0 offen sc1 lds
    s_add_u32 m0, s80, 100352
    s_nop 0
    buffer_load_dwordx4 v240, s[8:11], s81 offen sc1 lds
    s_add_u32 m0, s80, 102400
    s_nop 0
    buffer_load_dwordx4 v240, s[8:11], s82 offen sc1 lds
    s_add_u32 m0, s80, 104448
    s_nop 0
    buffer_load_dwordx4 v240, s[8:11], s83 offen sc1 lds
    s_add_u32 m0, s80, 106496
    s_nop 0
    buffer_load_dwordx4 v240, s[8:11], s84 offen sc1 lds
    s_add_u32 m0, s80, 108544
    s_nop 0
    buffer_load_dwordx4 v240, s[8:11], s85 offen sc1 lds
    s_add_u32 m0, s80, 110592
    s_nop 0
    buffer_load_dwordx4 v240, s[8:11], s86 offen sc1 lds
    s_add_u32 m0, s80, 112640
    s_nop 0
    buffer_load_dwordx4 v240, s[8:11], s87 offen sc1 lds
    s_add_u32 s61, s7, 1
    s_and_b32 s61, s61, 7
    s_mul_i32 s61, s61, 7
    s_add_u32 s61, s61, 5
    s_lshr_b32 s61, s61, 1
    s_lshl_b32 s61, s61, 17
    v_add_u32 v241, s61, v237
    s_add_u32 m0, s80, 114688
    s_nop 0
    buffer_load_dwordx4 v241, s[12:15], 0 offen  lds
    s_add_u32 m0, s80, 116736
    s_nop 0
    buffer_load_dwordx4 v241, s[12:15], s88 offen  lds
    s_add_u32 m0, s80, 118784
    s_nop 0
    buffer_load_dwordx4 v241, s[12:15], s89 offen  lds
    s_add_u32 m0, s80, 120832
    s_nop 0
    buffer_load_dwordx4 v241, s[12:15], s90 offen  lds
    s_add_u32 m0, s80, 122880
    s_nop 0
    buffer_load_dwordx4 v241, s[12:15], s91 offen  lds
    s_add_u32 m0, s80, 124928
    s_nop 0
    buffer_load_dwordx4 v241, s[12:15], s67 offen  lds
    s_add_u32 m0, s80, 126976
    s_nop 0
    buffer_load_dwordx4 v241, s[12:15], s68 offen  lds
    s_add_u32 m0, s80, 129024
    s_nop 0
    buffer_load_dwordx4 v241, s[12:15], s69 offen  lds
    s_barrier
    s_add_u32 s61, s7, 2
    s_and_b32 s61, s61, 7
    s_add_u32 s61, s61, 20
    s_add_u32 s62, s61, 4
    s_mul_i32 s62, s62, 147
    s_lshr_b32 s62, s62, 10
    s_add_u32 s61, s61, s62
    s_lshl_b32 s61, s61, 7
    v_add_u32 v240, s61, v236
    s_add_u32 m0, s80, 131072
    s_nop 0
    buffer_load_dwordx4 v240, s[8:11], 0 offen sc1 lds
    s_add_u32 m0, s80, 133120
    s_nop 0
    buffer_load_dwordx4 v240, s[8:11], s81 offen sc1 lds
    s_add_u32 m0, s80, 135168
    s_nop 0
    buffer_load_dwordx4 v240, s[8:11], s82 offen sc1 lds
    s_add_u32 m0, s80, 137216
    s_nop 0
    buffer_load_dwordx4 v240, s[8:11], s83 offen sc1 lds
    s_add_u32 m0, s80, 139264
    s_nop 0
    buffer_load_dwordx4 v240, s[8:11], s84 offen sc1 lds
    s_add_u32 m0, s80, 141312
    s_nop 0
    buffer_load_dwordx4 v240, s[8:11], s85 offen sc1 lds
    s_add_u32 m0, s80, 143360
    s_nop 0
    buffer_load_dwordx4 v240, s[8:11], s86 offen sc1 lds
    s_add_u32 m0, s80, 145408
    s_nop 0
    buffer_load_dwordx4 v240, s[8:11], s87 offen sc1 lds
    s_add_u32 s61, s7, 2
    s_and_b32 s61, s61, 7
    s_mul_i32 s61, s61, 7
    s_add_u32 s61, s61, 5
    s_lshr_b32 s61, s61, 1
    s_lshl_b32 s61, s61, 17
    v_add_u32 v241, s61, v237
    s_add_u32 m0, s80, 147456
    s_nop 0
    buffer_load_dwordx4 v241, s[12:15], 0 offen  lds
    s_add_u32 m0, s80, 149504
    s_nop 0
    buffer_load_dwordx4 v241, s[12:15], s88 offen  lds
    s_add_u32 m0, s80, 151552
    s_nop 0
    buffer_load_dwordx4 v241, s[12:15], s89 offen  lds
    s_add_u32 m0, s80, 153600
    s_nop 0
    buffer_load_dwordx4 v241, s[12:15], s90 offen  lds
    s_add_u32 m0, s80, 155648
    s_nop 0
    buffer_load_dwordx4 v241, s[12:15], s91 offen  lds
    s_add_u32 m0, s80, 157696
    s_nop 0
    buffer_load_dwordx4 v241, s[12:15], s67 offen  lds
    s_add_u32 m0, s80, 159744
    s_nop 0
    buffer_load_dwordx4 v241, s[12:15], s68 offen  lds
    s_add_u32 m0, s80, 161792
    s_nop 0
    buffer_load_dwordx4 v241, s[12:15], s69 offen  lds
    s_waitcnt vmcnt(32)
    s_barrier
    s_add_u32 s61, s7, 3
    s_and_b32 s61, s61, 7
    s_add_u32 s61, s61, 20
    s_add_u32 s62, s61, 4
    s_mul_i32 s62, s62, 147
    s_lshr_b32 s62, s62, 10
    s_add_u32 s61, s61, s62
    s_lshl_b32 s61, s61, 7
    v_add_u32 v240, s61, v236
    s_add_u32 m0, s80, 32768
    s_nop 0
    buffer_load_dwordx4 v240, s[8:11], 0 offen sc1 lds
    s_add_u32 m0, s80, 34816
    s_nop 0
    buffer_load_dwordx4 v240, s[8:11], s81 offen sc1 lds
    s_add_u32 m0, s80, 36864
    s_nop 0
    buffer_load_dwordx4 v240, s[8:11], s82 offen sc1 lds
    s_add_u32 m0, s80, 38912
    s_nop 0
    buffer_load_dwordx4 v240, s[8:11], s83 offen sc1 lds
    s_add_u32 m0, s80, 40960
    s_nop 0
    buffer_load_dwordx4 v240, s[8:11], s84 offen sc1 lds
    s_add_u32 m0, s80, 43008
    s_nop 0
    buffer_load_dwordx4 v240, s[8:11], s85 offen sc1 lds
    s_add_u32 m0, s80, 45056
    s_nop 0
    buffer_load_dwordx4 v240, s[8:11], s86 offen sc1 lds
    s_add_u32 m0, s80, 47104
    s_nop 0
    buffer_load_dwordx4 v240, s[8:11], s87 offen sc1 lds
    s_add_u32 s61, s7, 3
    s_and_b32 s61, s61, 7
    s_mul_i32 s61, s61, 7
    s_add_u32 s61, s61, 5
    s_lshr_b32 s61, s61, 1
    s_lshl_b32 s61, s61, 17
    v_add_u32 v241, s61, v237
    s_add_u32 m0, s80, 49152
    s_nop 0
    buffer_load_dwordx4 v241, s[12:15], 0 offen  lds
    s_add_u32 m0, s80, 51200
    s_nop 0
    buffer_load_dwordx4 v241, s[12:15], s88 offen  lds
    s_add_u32 m0, s80, 53248
    s_nop 0
    buffer_load_dwordx4 v241, s[12:15], s89 offen  lds
    s_add_u32 m0, s80, 55296
    s_nop 0
    buffer_load_dwordx4 v241, s[12:15], s90 offen  lds
    s_add_u32 m0, s80, 57344
    s_nop 0
    buffer_load_dwordx4 v241, s[12:15], s91 offen  lds
    s_add_u32 m0, s80, 59392
    s_nop 0
    buffer_load_dwordx4 v241, s[12:15], s67 offen  lds
    s_add_u32 m0, s80, 61440
    s_nop 0
    buffer_load_dwordx4 v241, s[12:15], s68 offen  lds
    s_add_u32 m0, s80, 63488
    s_nop 0
    buffer_load_dwordx4 v241, s[12:15], s69 offen  lds
    s_waitcnt vmcnt(32)
    s_barrier
    s_add_u32 s61, s7, 4
    s_and_b32 s61, s61, 7
    s_add_u32 s61, s61, 20
    s_add_u32 s62, s61, 4
    s_mul_i32 s62, s62, 147
    s_lshr_b32 s62, s62, 10
    s_add_u32 s61, s61, s62
    s_lshl_b32 s61, s61, 7
    v_add_u32 v240, s61, v236
    s_add_u32 m0, s80, 65536
    s_nop 0
    buffer_load_dwordx4 v240, s[8:11], 0 offen sc1 lds
    s_add_u32 m0, s80, 67584
    s_nop 0
    buffer_load_dwordx4 v240, s[8:11], s81 offen sc1 lds
    s_add_u32 m0, s80, 69632
    s_nop 0
    buffer_load_dwordx4 v240, s[8:11], s82 offen sc1 lds
    s_add_u32 m0, s80, 71680
    s_nop 0
    buffer_load_dwordx4 v240, s[8:11], s83 offen sc1 lds
    s_add_u32 m0, s80, 73728
    s_nop 0
    buffer_load_dwordx4 v240, s[8:11], s84 offen sc1 lds
    s_add_u32 m0, s80, 75776
    s_nop 0
    buffer_load_dwordx4 v240, s[8:11], s85 offen sc1 lds
    s_add_u32 m0, s80, 77824
    s_nop 0
    buffer_load_dwordx4 v240, s[8:11], s86 offen sc1 lds
    s_add_u32 m0, s80, 79872
    s_nop 0
    buffer_load_dwordx4 v240, s[8:11], s87 offen sc1 lds
    s_add_u32 s61, s7, 4
    s_and_b32 s61, s61, 7
    s_mul_i32 s61, s61, 7
    s_add_u32 s61, s61, 5
    s_lshr_b32 s61, s61, 1
    s_lshl_b32 s61, s61, 17
    v_add_u32 v241, s61, v237
    s_add_u32 m0, s80, 81920
    s_nop 0
    buffer_load_dwordx4 v241, s[12:15], 0 offen  lds
    s_add_u32 m0, s80, 83968
    s_nop 0
    buffer_load_dwordx4 v241, s[12:15], s88 offen  lds
    s_add_u32 m0, s80, 86016
    s_nop 0
    buffer_load_dwordx4 v241, s[12:15], s89 offen  lds
    s_add_u32 m0, s80, 88064
    s_nop 0
    buffer_load_dwordx4 v241, s[12:15], s90 offen  lds
    s_add_u32 m0, s80, 90112
    s_nop 0
    buffer_load_dwordx4 v241, s[12:15], s91 offen  lds
    s_add_u32 m0, s80, 92160
    s_nop 0
    buffer_load_dwordx4 v241, s[12:15], s67 offen  lds
    s_add_u32 m0, s80, 94208
    s_nop 0
    buffer_load_dwordx4 v241, s[12:15], s68 offen  lds
    s_add_u32 m0, s80, 96256
    s_nop 0
    buffer_load_dwordx4 v241, s[12:15], s69 offen  lds
    s_waitcnt vmcnt(32)
    s_barrier
    s_add_u32 s61, s7, 5
    s_and_b32 s61, s61, 7
    s_add_u32 s61, s61, 20
    s_add_u32 s62, s61, 4
    s_mul_i32 s62, s62, 147
    s_lshr_b32 s62, s62, 10
    s_add_u32 s61, s61, s62
    s_lshl_b32 s61, s61, 7
    v_add_u32 v240, s61, v236
    s_add_u32 m0, s80, 98304
    s_nop 0
    buffer_load_dwordx4 v240, s[8:11], 0 offen sc1 lds
    s_add_u32 m0, s80, 100352
    s_nop 0
    buffer_load_dwordx4 v240, s[8:11], s81 offen sc1 lds
    s_add_u32 m0, s80, 102400
    s_nop 0
    buffer_load_dwordx4 v240, s[8:11], s82 offen sc1 lds
    s_add_u32 m0, s80, 104448
    s_nop 0
    buffer_load_dwordx4 v240, s[8:11], s83 offen sc1 lds
    s_add_u32 m0, s80, 106496
    s_nop 0
    buffer_load_dwordx4 v240, s[8:11], s84 offen sc1 lds
    s_add_u32 m0, s80, 108544
    s_nop 0
    buffer_load_dwordx4 v240, s[8:11], s85 offen sc1 lds
    s_add_u32 m0, s80, 110592
    s_nop 0
    buffer_load_dwordx4 v240, s[8:11], s86 offen sc1 lds
    s_add_u32 m0, s80, 112640
    s_nop 0
    buffer_load_dwordx4 v240, s[8:11], s87 offen sc1 lds
    s_add_u32 s61, s7, 5
    s_and_b32 s61, s61, 7
    s_mul_i32 s61, s61, 7
    s_add_u32 s61, s61, 5
    s_lshr_b32 s61, s61, 1
    s_lshl_b32 s61, s61, 17
    v_add_u32 v241, s61, v237
    s_add_u32 m0, s80, 114688
    s_nop 0
    buffer_load_dwordx4 v241, s[12:15], 0 offen  lds
    s_add_u32 m0, s80, 116736
    s_nop 0
    buffer_load_dwordx4 v241, s[12:15], s88 offen  lds
    s_add_u32 m0, s80, 118784
    s_nop 0
    buffer_load_dwordx4 v241, s[12:15], s89 offen  lds
    s_add_u32 m0, s80, 120832
    s_nop 0
    buffer_load_dwordx4 v241, s[12:15], s90 offen  lds
    s_add_u32 m0, s80, 122880
    s_nop 0
    buffer_load_dwordx4 v241, s[12:15], s91 offen  lds
    s_add_u32 m0, s80, 124928
    s_nop 0
    buffer_load_dwordx4 v241, s[12:15], s67 offen  lds
    s_add_u32 m0, s80, 126976
    s_nop 0
    buffer_load_dwordx4 v241, s[12:15], s68 offen  lds
    s_add_u32 m0, s80, 129024
    s_nop 0
    buffer_load_dwordx4 v241, s[12:15], s69 offen  lds
    s_waitcnt vmcnt(32)
    s_barrier
    s_add_u32 s61, s7, 6
    s_and_b32 s61, s61, 7
    s_add_u32 s61, s61, 20
    s_add_u32 s62, s61, 4
    s_mul_i32 s62, s62, 147
    s_lshr_b32 s62, s62, 10
    s_add_u32 s61, s61, s62
    s_lshl_b32 s61, s61, 7
    v_add_u32 v240, s61, v236
    s_add_u32 m0, s80, 131072
    s_nop 0
    buffer_load_dwordx4 v240, s[8:11], 0 offen sc1 lds
    s_add_u32 m0, s80, 133120
    s_nop 0
    buffer_load_dwordx4 v240, s[8:11], s81 offen sc1 lds
    s_add_u32 m0, s80, 135168
    s_nop 0
    buffer_load_dwordx4 v240, s[8:11], s82 offen sc1 lds
    s_add_u32 m0, s80, 137216
    s_nop 0
    buffer_load_dwordx4 v240, s[8:11], s83 offen sc1 lds
    s_add_u32 m0, s80, 139264
    s_nop 0
    buffer_load_dwordx4 v240, s[8:11], s84 offen sc1 lds
    s_add_u32 m0, s80, 141312
    s_nop 0
    buffer_load_dwordx4 v240, s[8:11], s85 offen sc1 lds
    s_add_u32 m0, s80, 143360
    s_nop 0
    buffer_load_dwordx4 v240, s[8:11], s86 offen sc1 lds
    s_add_u32 m0, s80, 145408
    s_nop 0
    buffer_load_dwordx4 v240, s[8:11], s87 offen sc1 lds
    s_add_u32 s61, s7, 6
    s_and_b32 s61, s61, 7
    s_mul_i32 s61, s61, 7
    s_add_u32 s61, s61, 5
    s_lshr_b32 s61, s61, 1
    s_lshl_b32 s61, s61, 17
    v_add_u32 v241, s61, v237
    s_add_u32 m0, s80, 147456
    s_nop 0
    buffer_load_dwordx4 v241, s[12:15], 0 offen  lds
    s_add_u32 m0, s80, 149504
    s_nop 0
    buffer_load_dwordx4 v241, s[12:15], s88 offen  lds
    s_add_u32 m0, s80, 151552
    s_nop 0
    buffer_load_dwordx4 v241, s[12:15], s89 offen  lds
    s_add_u32 m0, s80, 153600
    s_nop 0
    buffer_load_dwordx4 v241, s[12:15], s90 offen  lds
    s_add_u32 m0, s80, 155648
    s_nop 0
    buffer_load_dwordx4 v241, s[12:15], s91 offen  lds
    s_add_u32 m0, s80, 157696
    s_nop 0
    buffer_load_dwordx4 v241, s[12:15], s67 offen  lds
    s_add_u32 m0, s80, 159744
    s_nop 0
    buffer_load_dwordx4 v241, s[12:15], s68 offen  lds
    s_add_u32 m0, s80, 161792
    s_nop 0
    buffer_load_dwordx4 v241, s[12:15], s69 offen  lds
    s_waitcnt vmcnt(32)
    s_barrier
    s_add_u32 s61, s7, 7
    s_and_b32 s61, s61, 7
    s_add_u32 s61, s61, 20
    s_add_u32 s62, s61, 4
    s_mul_i32 s62, s62, 147
    s_lshr_b32 s62, s62, 10
    s_add_u32 s61, s61, s62
    s_lshl_b32 s61, s61, 7
    v_add_u32 v240, s61, v236
    s_add_u32 m0, s80, 32768
    s_nop 0
    buffer_load_dwordx4 v240, s[8:11], 0 offen sc1 lds
    s_add_u32 m0, s80, 34816
    s_nop 0
    buffer_load_dwordx4 v240, s[8:11], s81 offen sc1 lds
    s_add_u32 m0, s80, 36864
    s_nop 0
    buffer_load_dwordx4 v240, s[8:11], s82 offen sc1 lds
    s_add_u32 m0, s80, 38912
    s_nop 0
    buffer_load_dwordx4 v240, s[8:11], s83 offen sc1 lds
    s_add_u32 m0, s80, 40960
    s_nop 0
    buffer_load_dwordx4 v240, s[8:11], s84 offen sc1 lds
    s_add_u32 m0, s80, 43008
    s_nop 0
    buffer_load_dwordx4 v240, s[8:11], s85 offen sc1 lds
    s_add_u32 m0, s80, 45056
    s_nop 0
    buffer_load_dwordx4 v240, s[8:11], s86 offen sc1 lds
    s_add_u32 m0, s80, 47104
    s_nop 0
    buffer_load_dwordx4 v240, s[8:11], s87 offen sc1 lds
    s_add_u32 s61, s7, 7
    s_and_b32 s61, s61, 7
    s_mul_i32 s61, s61, 7
    s_add_u32 s61, s61, 5
    s_lshr_b32 s61, s61, 1
    s_lshl_b32 s61, s61, 17
    v_add_u32 v241, s61, v237
    s_add_u32 m0, s80, 49152
    s_nop 0
    buffer_load_dwordx4 v241, s[12:15], 0 offen  lds
    s_add_u32 m0, s80, 51200
    s_nop 0
    buffer_load_dwordx4 v241, s[12:15], s88 offen  lds
    s_add_u32 m0, s80, 53248
    s_nop 0
    buffer_load_dwordx4 v241, s[12:15], s89 offen  lds
    s_add_u32 m0, s80, 55296
    s_nop 0
    buffer_load_dwordx4 v241, s[12:15], s90 offen  lds
    s_add_u32 m0, s80, 57344
    s_nop 0
    buffer_load_dwordx4 v241, s[12:15], s91 offen  lds
    s_add_u32 m0, s80, 59392
    s_nop 0
    buffer_load_dwordx4 v241, s[12:15], s67 offen  lds
    s_add_u32 m0, s80, 61440
    s_nop 0
    buffer_load_dwordx4 v241, s[12:15], s68 offen  lds
    s_add_u32 m0, s80, 63488
    s_nop 0
    buffer_load_dwordx4 v241, s[12:15], s69 offen  lds
    s_waitcnt vmcnt(32)
    s_barrier
    s_waitcnt vmcnt(16)
    s_barrier
    s_waitcnt vmcnt(0)
    s_barrier
    s_barrier
    s_branch P4_epi
P4_S:
    s_barrier
    s_barrier
    s_waitcnt vmcnt(9)
    s_mov_b64 exec, 1
    buffer_atomic_add v13, v12, s[32:35], 0 offen offset:384 sc1
    s_mov_b64 exec, -1
    s_barrier
    s_barrier
    s_barrier
    s_waitcnt vmcnt(1)
    s_mov_b64 exec, 1
    buffer_atomic_add v13, v12, s[32:35], 0 offen offset:512 sc1
    s_mov_b64 exec, -1
    s_barrier
    s_barrier
    s_barrier
    s_barrier
    s_barrier
    s_barrier
    s_barrier
    s_barrier
    s_barrier
    s_barrier
    s_barrier
    s_barrier
    s_barrier
    s_barrier
    s_barrier
    s_barrier
    s_barrier
    s_barrier
    s_barrier
    s_barrier
    s_add_u32 s20, s56, 8388608
    s_addc_u32 s21, s57, 0
    s_mov_b32 s22, 8388608
    s_mov_b32 s23, 0x20000
    s_lshl_b32 s66, s7, 1
    s_add_u32 s67, s66, 1
    s_cmp_ge_u32 s66, 3
    s_addc_u32 s61, s66, 0
    s_cmp_ge_u32 s66, 10
    s_addc_u32 s66, s61, 0
    s_cmp_ge_u32 s67, 3
    s_addc_u32 s61, s67, 0
    s_cmp_ge_u32 s67, 10
    s_addc_u32 s67, s61, 0
    s_lshl_b32 s61, s4, 7
    s_lshl_b32 s62, s6, 5
    s_add_u32 s61, s61, s62
    s_lshl_b32 s62, s63, 2
    s_add_u32 s61, s61, s62
    v_lshrrev_b32 v3, 4, v0
    v_add_u32 v3, s61, v3
    v_lshlrev_b32 v3, 12, v3
    v_and_b32 v4, 7, v0
    v_lshl_add_u32 v3, v4, 4, v3
    v_and_b32 v4, 8, v0
    v_cmp_eq_u32 vcc, 0, v4
    v_mov_b32 v4, s67
    v_mov_b32 v5, s66
    v_cndmask_b32 v4, v4, v5, vcc
    v_lshl_add_u32 v3, v4, 7, v3
    s_lshl_b32 s62, s63, 10
    s_add_u32 m0, s62, 0
    s_mov_b32 s61, 0
    buffer_load_dwordx4 v3, s[20:23], s61 offen sc1 lds
    s_add_u32 m0, s62, 2048
    s_mov_b32 s61, 32768
    buffer_load_dwordx4 v3, s[20:23], s61 offen sc1 lds
    s_add_u32 m0, s62, 4096
    s_mov_b32 s61, 65536
    buffer_load_dwordx4 v3, s[20:23], s61 offen sc1 lds
    s_add_u32 m0, s62, 6144
    s_mov_b32 s61, 98304
    buffer_load_dwordx4 v3, s[20:23], s61 offen sc1 lds
    s_add_u32 m0, s62, 8192
    s_mov_b32 s61, 262144
    buffer_load_dwordx4 v3, s[20:23], s61 offen sc1 lds
    s_add_u32 m0, s62, 10240
    s_mov_b32 s61, 294912
    buffer_load_dwordx4 v3, s[20:23], s61 offen sc1 lds
    s_add_u32 m0, s62, 12288
    s_mov_b32 s61, 327680
    buffer_load_dwordx4 v3, s[20:23], s61 offen sc1 lds
    s_add_u32 m0, s62, 14336
    s_mov_b32 s61, 360448
    buffer_load_dwordx4 v3, s[20:23], s61 offen sc1 lds
    s_barrier
    s_barrier
    s_barrier
    s_barrier
    s_waitcnt vmcnt(0)
P4_epi:
    s_mov_b32 s16, s52
    s_mov_b32 s17, s53
    s_mov_b32 s18, 4194304
    s_mov_b32 s19, 0x20000
    v_lshl_add_u32 v5, s3, 6, v0
    v_lshrrev_b32 v6, 4, v5
    v_and_b32 v7, 15, v5
    s_lshl_b32 s61, s4, 7
    s_lshl_b32 s62, s6, 5
    s_add_u32 s61, s61, s62
    v_add_u32 v8, s61, v6
    v_lshlrev_b32 v9, 11, v8
    v_lshl_add_u32 v9, v7, 4, v9
    s_lshl_b32 s61, s7, 8
    v_add_u32 v9, s61, v9
    v_mul_u32_u24 v6, 528, v6
    v_lshl_add_u32 v10, v7, 5, v6
    v_lshlrev_b32 v11, 4, v5
    s_mov_b32 s66, 131072
    s_mov_b32 s61, 0xffff0000
    s_waitcnt lgkmcnt(0)
    s_barrier
    ds_read_b128 v[64:67], v11 offset:0
    ds_read_b128 v[16:19], v10 offset:32768
    ds_read_b128 v[20:23], v10 offset:32784
    ds_read_b128 v[68:71], v11 offset:8192
    ds_read_b128 v[24:27], v10 offset:49664
    ds_read_b128 v[28:31], v10 offset:49680
    s_waitcnt lgkmcnt(5)
    v_lshlrev_b32 v32, 16, v64
    v_and_b32 v33, s61, v64
    v_lshlrev_b32 v34, 16, v65
    v_and_b32 v35, s61, v65
    v_lshlrev_b32 v36, 16, v66
    v_and_b32 v37, s61, v66
    v_lshlrev_b32 v38, 16, v67
    v_and_b32 v39, s61, v67
    s_waitcnt lgkmcnt(3)
    v_pk_add_f32 v[16:17], v[16:17], v[32:33]
    v_pk_add_f32 v[18:19], v[18:19], v[34:35]
    v_pk_add_f32 v[20:21], v[20:21], v[36:37]
    v_pk_add_f32 v[22:23], v[22:23], v[38:39]
    v_cvt_pk_bf16_f32 v48, v16, v17
    v_cvt_pk_bf16_f32 v49, v18, v19
    v_cvt_pk_bf16_f32 v50, v20, v21
    v_cvt_pk_bf16_f32 v51, v22, v23
    buffer_store_dwordx4 v[48:51], v9, s[16:19], 0 offen
    s_waitcnt lgkmcnt(2)
    v_lshlrev_b32 v40, 16, v68
    v_and_b32 v41, s61, v68
    v_lshlrev_b32 v42, 16, v69
    v_and_b32 v43, s61, v69
    v_lshlrev_b32 v44, 16, v70
    v_and_b32 v45, s61, v70
    v_lshlrev_b32 v46, 16, v71
    v_and_b32 v47, s61, v71
    s_waitcnt lgkmcnt(0)
    v_pk_add_f32 v[24:25], v[24:25], v[40:41]
    v_pk_add_f32 v[26:27], v[26:27], v[42:43]
    v_pk_add_f32 v[28:29], v[28:29], v[44:45]
    v_pk_add_f32 v[30:31], v[30:31], v[46:47]
    v_cvt_pk_bf16_f32 v52, v24, v25
    v_cvt_pk_bf16_f32 v53, v26, v27
    v_cvt_pk_bf16_f32 v54, v28, v29
    v_cvt_pk_bf16_f32 v55, v30, v31
    buffer_store_dwordx4 v[52:55], v9, s[16:19], s66 offen
L_end:
    s_endpgm
.fill (66560 - (. - sequential_preLN__sliding_local_dilated__dense_activation_silu__prompt_kernel))/4, 4, 0xbf800000
.section .rodata,"a"
.p2align 6
.amdhsa_kernel sequential_preLN__sliding_local_dilated__dense_activation_silu__prompt_kernel
  .amdhsa_next_free_vgpr 256
  .amdhsa_next_free_sgpr 102
  .amdhsa_accum_offset 256
  .amdhsa_group_segment_fixed_size 0
  .amdhsa_kernarg_size 72
  .amdhsa_user_sgpr_count 2
  .amdhsa_user_sgpr_kernarg_segment_ptr 1
  .amdhsa_system_sgpr_workgroup_id_x 1
.end_amdhsa_kernel
```
